```python
import torch

def _softmax(x, axis=-1):
    return torch.softmax(x, dim=axis)
def _gelu(x):
    return torch.nn.functional.gelu(x, approximate="tanh")
def _silu(x):
    return torch.nn.functional.silu(x)
def _sigmoid(x):
    return torch.sigmoid(x)
def _layernorm(x, axis=-1, eps=1e-5):
    m = x.mean(dim=axis, keepdim=True)
    v = x.var(dim=axis, keepdim=True, unbiased=False)
    return (x - m) / torch.sqrt(v + eps)
def _scatter_add(tgt, idx, src, axis=0):
    return tgt.clone().index_add_(axis, idx, src)
def _segment_sum(src, seg, n):
    out = torch.zeros((n,) + src.shape[1:], dtype=src.dtype)
    return out.index_add_(0, seg, src)
def _pad(x, pw):
    flat = tuple(v for pair in reversed(pw) for v in pair)
    return torch.nn.functional.pad(x, flat)

kernel_name = 'standalone__mha_block_cached__near_ridge'

def setup_inputs():

    _w = (lambda a: (lambda t: t.to(torch.bfloat16) if t.is_floating_point() else t)(torch.as_tensor(a)))
    B, Sq, D = 8, 128, 576
    H, Sk, Dh = 32, 1024, 128
    return {
        "x": _w((lambda *s: torch.randn(*s, dtype=torch.bfloat16) * 0.8)(B, Sq, D)),
        "k_cache": _w((lambda *s: torch.randn(*s, dtype=torch.bfloat16) * 0.8)(B, H, Sk, Dh)),
        "v_cache": _w((lambda *s: torch.randn(*s, dtype=torch.bfloat16) * 0.05)(B, H, Sk, Dh)),
        "wq": _w((lambda *s: torch.randn(*s, dtype=torch.bfloat16) * 0.8)(D, H * Dh) * (D ** -0.5)),
        "wo": _w((lambda *s: torch.randn(*s, dtype=torch.bfloat16) * 0.05)(H * Dh, D) * ((H * Dh) ** -0.5)),
    }

def reference(x, k_cache, v_cache, wq, wo):
    B, Sq, D = x.shape
    H, Dh = 32, 128
    q = (lambda x, *d: x.permute(*d))((x @ wq).reshape(B, Sq, H, Dh), 0, 2, 1, 3)
    scores = torch.einsum("bhqd,bhkd->bhqk", q, k_cache) * (Dh ** -0.5)
    p = _softmax(scores, axis=-1)
    o = torch.einsum("bhqk,bhkd->bhqd", p, v_cache)
    return (lambda x, *d: x.permute(*d))(o, 0, 2, 1, 3).reshape(B, Sq, H * Dh) @ wo
```

```asm
; @launch kernel=attn_kernel grid=(256,1,1) block=(256,1,1) lds=163840
; @launch kernel=oproj_kernel grid=(192,1,1) block=(256,1,1) lds=163840
; @launch kernel=reduce_kernel grid=(576,1,1) block=(256,1,1) lds=0
.amdgcn_target "amdgcn-amd-amdhsa--gfx950"
.text
.globl attn_kernel
.p2align 8
.type attn_kernel,@function
attn_kernel:
    s_cmp_ge_u32 s2, 256
    s_cbranch_scc1 L_attn_done
    s_load_dwordx16 s[32:47], s[0:1], 0
    v_lshrrev_b32 v1, 6, v0
    s_nop 0
    v_readfirstlane_b32 s3, v1
    v_and_b32 v0, 63, v0
    s_and_b32 s4, s2, 6
    s_lshr_b32 s5, s2, 7
    s_or_b32 s4, s4, s5
    s_and_b32 s5, s2, 1
    s_lshl_b32 s5, s5, 4
    s_bfe_u32 s6, s2, 0x40003
    s_or_b32 s5, s5, s6
    s_lshl_b32 s6, s4, 5
    s_or_b32 s53, s6, s5
    s_waitcnt lgkmcnt(0)
    s_mul_i32 s6, s4, 147456
    s_add_u32 s8, s32, s6
    s_addc_u32 s9, s33, 0
    s_mov_b32 s10, 147456
    s_mov_b32 s11, 0x00020000
    s_lshl_b32 s6, s5, 8
    s_add_u32 s12, s38, s6
    s_addc_u32 s13, s39, 0
    s_mov_b32 s14, 4710656
    s_mov_b32 s15, 0x00020000
    s_lshl_b32 s6, s53, 18
    s_add_u32 s16, s34, s6
    s_addc_u32 s17, s35, 0
    s_mov_b32 s18, 262144
    s_mov_b32 s19, 0x00020000
    s_add_u32 s20, s36, s6
    s_addc_u32 s21, s37, 0
    s_mov_b32 s22, 262144
    s_mov_b32 s23, 0x00020000
    s_lshl_b32 s6, s4, 20
    s_lshr_b32 s7, s5, 2
    s_lshl_b32 s7, s7, 17
    s_add_u32 s6, s6, s7
    s_and_b32 s7, s5, 3
    s_lshl_b32 s7, s7, 8
    s_add_u32 s6, s6, s7
    s_add_u32 s24, s46, s6
    s_addc_u32 s25, s47, 0
    s_mov_b32 s26, 130304
    s_mov_b32 s27, 0x00020000
    s_and_b32 s51, s2, 15
    s_lshl_b32 s51, s51, 14
    s_mov_b32 s49, 0x3e0293ee
    s_mov_b32 s50, 0xbe0293ee
    s_mov_b32 s56, 0x3e0293ee
    s_mov_b32 s57, 0x3e0293ee
    v_and_b32 v96, 31, v0
    v_lshrrev_b32 v97, 5, v0
    v_lshrrev_b32 v99, 4, v0
    v_and_b32 v100, 15, v0
    v_lshlrev_b32 v101, 2, v99
    v_xor_b32 v101, v101, v100
    v_lshlrev_b32 v101, 4, v101
    v_lshl_add_u32 v17, v99, 8, v101
    v_lshl_add_u32 v30, v99, 13, v101
    v_add_u32 v102, 0, v99
    v_xor_b32 v102, v102, v100
    v_lshlrev_b32 v102, 4, v102
    v_lshl_add_u32 v13, v99, 8, v102
    v_add_u32 v102, 4, v99
    v_xor_b32 v102, v102, v100
    v_lshlrev_b32 v102, 4, v102
    v_lshl_add_u32 v14, v99, 8, v102
    v_add_u32 v102, 8, v99
    v_xor_b32 v102, v102, v100
    v_lshlrev_b32 v102, 4, v102
    v_lshl_add_u32 v15, v99, 8, v102
    v_add_u32 v102, 12, v99
    v_xor_b32 v102, v102, v100
    v_lshlrev_b32 v102, 4, v102
    v_lshl_add_u32 v16, v99, 8, v102
    v_lshrrev_b32 v102, 3, v0
    v_and_b32 v103, 7, v0
    v_xor_b32 v103, v103, v102
    v_lshlrev_b32 v103, 4, v103
    s_movk_i32 s7, 1152
    v_mul_lo_u32 v102, v102, s7
    v_add_u32 v29, v102, v103
    s_and_b32 s52, s3, 1
    s_lshl_b32 s52, s52, 13
    s_and_b32 s54, s3, 1
    s_mul_i32 s55, s54, 262144
    s_mul_i32 s54, s54, 73728
    s_cmp_lt_u32 s3, 2
    s_cbranch_scc0 L_role_1
    s_add_u32 s48, s52, 49152
    s_mov_b32 m0, s48
    s_add_u32 s48, s54, 0
    buffer_load_dwordx4 v29, s[8:11], s48 offen  lds
    s_add_u32 s48, s52, 50176
    s_mov_b32 m0, s48
    s_add_u32 s48, s54, 9216
    buffer_load_dwordx4 v29, s[8:11], s48 offen  lds
    s_add_u32 s48, s52, 51200
    s_mov_b32 m0, s48
    s_add_u32 s48, s54, 18432
    buffer_load_dwordx4 v29, s[8:11], s48 offen  lds
    s_add_u32 s48, s52, 52224
    s_mov_b32 m0, s48
    s_add_u32 s48, s54, 27648
    buffer_load_dwordx4 v29, s[8:11], s48 offen  lds
    s_add_u32 s48, s52, 53248
    s_mov_b32 m0, s48
    s_add_u32 s48, s54, 36864
    buffer_load_dwordx4 v29, s[8:11], s48 offen  lds
    s_add_u32 s48, s52, 54272
    s_mov_b32 m0, s48
    s_add_u32 s48, s54, 46080
    buffer_load_dwordx4 v29, s[8:11], s48 offen  lds
    s_add_u32 s48, s52, 55296
    s_mov_b32 m0, s48
    s_add_u32 s48, s54, 55296
    buffer_load_dwordx4 v29, s[8:11], s48 offen  lds
    s_add_u32 s48, s52, 56320
    s_mov_b32 m0, s48
    s_add_u32 s48, s54, 64512
    buffer_load_dwordx4 v29, s[8:11], s48 offen  lds
    s_add_u32 s48, s52, 81920
    s_mov_b32 m0, s48
    s_add_u32 s48, s55, 0
    buffer_load_dwordx4 v30, s[12:15], s48 offen  lds
    s_add_u32 s48, s52, 82944
    s_mov_b32 m0, s48
    s_add_u32 s48, s55, 32768
    buffer_load_dwordx4 v30, s[12:15], s48 offen  lds
    s_add_u32 s48, s52, 83968
    s_mov_b32 m0, s48
    s_add_u32 s48, s55, 65536
    buffer_load_dwordx4 v30, s[12:15], s48 offen  lds
    s_add_u32 s48, s52, 84992
    s_mov_b32 m0, s48
    s_add_u32 s48, s55, 98304
    buffer_load_dwordx4 v30, s[12:15], s48 offen  lds
    s_add_u32 s48, s52, 86016
    s_mov_b32 m0, s48
    s_add_u32 s48, s55, 131072
    buffer_load_dwordx4 v30, s[12:15], s48 offen  lds
    s_add_u32 s48, s52, 87040
    s_mov_b32 m0, s48
    s_add_u32 s48, s55, 163840
    buffer_load_dwordx4 v30, s[12:15], s48 offen  lds
    s_add_u32 s48, s52, 88064
    s_mov_b32 m0, s48
    s_add_u32 s48, s55, 196608
    buffer_load_dwordx4 v30, s[12:15], s48 offen  lds
    s_add_u32 s48, s52, 89088
    s_mov_b32 m0, s48
    s_add_u32 s48, s55, 229376
    buffer_load_dwordx4 v30, s[12:15], s48 offen  lds
    s_add_u32 s48, s52, 98304
    s_mov_b32 m0, s48
    s_add_u32 s48, s54, 128
    buffer_load_dwordx4 v29, s[8:11], s48 offen  lds
    s_add_u32 s48, s52, 99328
    s_mov_b32 m0, s48
    s_add_u32 s48, s54, 9344
    buffer_load_dwordx4 v29, s[8:11], s48 offen  lds
    s_add_u32 s48, s52, 100352
    s_mov_b32 m0, s48
    s_add_u32 s48, s54, 18560
    buffer_load_dwordx4 v29, s[8:11], s48 offen  lds
    s_add_u32 s48, s52, 101376
    s_mov_b32 m0, s48
    s_add_u32 s48, s54, 27776
    buffer_load_dwordx4 v29, s[8:11], s48 offen  lds
    s_add_u32 s48, s52, 102400
    s_mov_b32 m0, s48
    s_add_u32 s48, s54, 36992
    buffer_load_dwordx4 v29, s[8:11], s48 offen  lds
    s_add_u32 s48, s52, 103424
    s_mov_b32 m0, s48
    s_add_u32 s48, s54, 46208
    buffer_load_dwordx4 v29, s[8:11], s48 offen  lds
    s_add_u32 s48, s52, 104448
    s_mov_b32 m0, s48
    s_add_u32 s48, s54, 55424
    buffer_load_dwordx4 v29, s[8:11], s48 offen  lds
    s_add_u32 s48, s52, 105472
    s_mov_b32 m0, s48
    s_add_u32 s48, s54, 64640
    buffer_load_dwordx4 v29, s[8:11], s48 offen  lds
    s_add_u32 s48, s52, 114688
    s_mov_b32 m0, s48
    s_add_u32 s48, s55, 524288
    buffer_load_dwordx4 v30, s[12:15], s48 offen  lds
    s_add_u32 s48, s52, 115712
    s_mov_b32 m0, s48
    s_add_u32 s48, s55, 557056
    buffer_load_dwordx4 v30, s[12:15], s48 offen  lds
    s_add_u32 s48, s52, 116736
    s_mov_b32 m0, s48
    s_add_u32 s48, s55, 589824
    buffer_load_dwordx4 v30, s[12:15], s48 offen  lds
    s_add_u32 s48, s52, 117760
    s_mov_b32 m0, s48
    s_add_u32 s48, s55, 622592
    buffer_load_dwordx4 v30, s[12:15], s48 offen  lds
    s_add_u32 s48, s52, 118784
    s_mov_b32 m0, s48
    s_add_u32 s48, s55, 655360
    buffer_load_dwordx4 v30, s[12:15], s48 offen  lds
    s_add_u32 s48, s52, 119808
    s_mov_b32 m0, s48
    s_add_u32 s48, s55, 688128
    buffer_load_dwordx4 v30, s[12:15], s48 offen  lds
    s_add_u32 s48, s52, 120832
    s_mov_b32 m0, s48
    s_add_u32 s48, s55, 720896
    buffer_load_dwordx4 v30, s[12:15], s48 offen  lds
    s_add_u32 s48, s52, 121856
    s_mov_b32 m0, s48
    s_add_u32 s48, s55, 753664
    buffer_load_dwordx4 v30, s[12:15], s48 offen  lds
    s_add_u32 s48, s52, 131072
    s_mov_b32 m0, s48
    s_add_u32 s48, s54, 256
    buffer_load_dwordx4 v29, s[8:11], s48 offen  lds
    s_add_u32 s48, s52, 132096
    s_mov_b32 m0, s48
    s_add_u32 s48, s54, 9472
    buffer_load_dwordx4 v29, s[8:11], s48 offen  lds
    s_add_u32 s48, s52, 133120
    s_mov_b32 m0, s48
    s_add_u32 s48, s54, 18688
    buffer_load_dwordx4 v29, s[8:11], s48 offen  lds
    s_add_u32 s48, s52, 134144
    s_mov_b32 m0, s48
    s_add_u32 s48, s54, 27904
    buffer_load_dwordx4 v29, s[8:11], s48 offen  lds
    s_add_u32 s48, s52, 135168
    s_mov_b32 m0, s48
    s_add_u32 s48, s54, 37120
    buffer_load_dwordx4 v29, s[8:11], s48 offen  lds
    s_add_u32 s48, s52, 136192
    s_mov_b32 m0, s48
    s_add_u32 s48, s54, 46336
    buffer_load_dwordx4 v29, s[8:11], s48 offen  lds
    s_add_u32 s48, s52, 137216
    s_mov_b32 m0, s48
    s_add_u32 s48, s54, 55552
    buffer_load_dwordx4 v29, s[8:11], s48 offen  lds
    s_add_u32 s48, s52, 138240
    s_mov_b32 m0, s48
    s_add_u32 s48, s54, 64768
    buffer_load_dwordx4 v29, s[8:11], s48 offen  lds
    s_add_u32 s48, s52, 147456
    s_mov_b32 m0, s48
    s_add_u32 s48, s55, 1048576
    buffer_load_dwordx4 v30, s[12:15], s48 offen  lds
    s_add_u32 s48, s52, 148480
    s_mov_b32 m0, s48
    s_add_u32 s48, s55, 1081344
    buffer_load_dwordx4 v30, s[12:15], s48 offen  lds
    s_add_u32 s48, s52, 149504
    s_mov_b32 m0, s48
    s_add_u32 s48, s55, 1114112
    buffer_load_dwordx4 v30, s[12:15], s48 offen  lds
    s_add_u32 s48, s52, 150528
    s_mov_b32 m0, s48
    s_add_u32 s48, s55, 1146880
    buffer_load_dwordx4 v30, s[12:15], s48 offen  lds
    s_add_u32 s48, s52, 151552
    s_mov_b32 m0, s48
    s_add_u32 s48, s55, 1179648
    buffer_load_dwordx4 v30, s[12:15], s48 offen  lds
    s_add_u32 s48, s52, 152576
    s_mov_b32 m0, s48
    s_add_u32 s48, s55, 1212416
    buffer_load_dwordx4 v30, s[12:15], s48 offen  lds
    s_add_u32 s48, s52, 153600
    s_mov_b32 m0, s48
    s_add_u32 s48, s55, 1245184
    buffer_load_dwordx4 v30, s[12:15], s48 offen  lds
    s_add_u32 s48, s52, 154624
    s_mov_b32 m0, s48
    s_add_u32 s48, s55, 1277952
    buffer_load_dwordx4 v30, s[12:15], s48 offen  lds
L_role_1:
    v_and_b32 v102, 15, v96
    v_or_b32 v103, 0, v97
    v_xor_b32 v103, v103, v102
    v_lshlrev_b32 v103, 4, v103
    v_lshl_add_u32 v1, v96, 8, v103
    v_or_b32 v103, 2, v97
    v_xor_b32 v103, v103, v102
    v_lshlrev_b32 v103, 4, v103
    v_lshl_add_u32 v2, v96, 8, v103
    v_or_b32 v103, 4, v97
    v_xor_b32 v103, v103, v102
    v_lshlrev_b32 v103, 4, v103
    v_lshl_add_u32 v3, v96, 8, v103
    v_or_b32 v103, 6, v97
    v_xor_b32 v103, v103, v102
    v_lshlrev_b32 v103, 4, v103
    v_lshl_add_u32 v4, v96, 8, v103
    v_or_b32 v103, 8, v97
    v_xor_b32 v103, v103, v102
    v_lshlrev_b32 v103, 4, v103
    v_lshl_add_u32 v5, v96, 8, v103
    v_or_b32 v103, 10, v97
    v_xor_b32 v103, v103, v102
    v_lshlrev_b32 v103, 4, v103
    v_lshl_add_u32 v6, v96, 8, v103
    v_or_b32 v103, 12, v97
    v_xor_b32 v103, v103, v102
    v_lshlrev_b32 v103, 4, v103
    v_lshl_add_u32 v7, v96, 8, v103
    v_or_b32 v103, 14, v97
    v_xor_b32 v103, v103, v102
    v_lshlrev_b32 v103, 4, v103
    v_lshl_add_u32 v8, v96, 8, v103
    s_lshl_b32 s6, s3, 5
    v_add_u32 v102, s6, v96
    v_and_b32 v104, 7, v96
    v_or_b32 v103, 0, v97
    v_xor_b32 v103, v103, v104
    v_lshlrev_b32 v103, 4, v103
    v_lshl_add_u32 v164, v102, 7, v103
    v_or_b32 v103, 2, v97
    v_xor_b32 v103, v103, v104
    v_lshlrev_b32 v103, 4, v103
    v_lshl_add_u32 v165, v102, 7, v103
    v_or_b32 v103, 4, v97
    v_xor_b32 v103, v103, v104
    v_lshlrev_b32 v103, 4, v103
    v_lshl_add_u32 v166, v102, 7, v103
    v_or_b32 v103, 6, v97
    v_xor_b32 v103, v103, v104
    v_lshlrev_b32 v103, 4, v103
    v_lshl_add_u32 v167, v102, 7, v103
    v_bfe_u32 v103, v0, 2, 2
    v_bfe_u32 v104, v0, 4, 1
    v_and_b32 v105, 3, v0
    v_lshlrev_b32 v106, 5, v104
    v_lshrrev_b32 v107, 1, v105
    v_lshl_add_u32 v106, v107, 4, v106
    v_and_b32 v107, 1, v105
    v_lshl_add_u32 v106, v107, 3, v106
    v_lshl_add_u32 v107, v97, 2, v103
    v_lshl_add_u32 v108, v107, 8, v106
    v_add_u32 v108, 65536, v108
    v_xor_b32 v109, 0, v103
    v_lshl_add_u32 v9, v109, 6, v108
    v_xor_b32 v109, 1, v103
    v_lshl_add_u32 v10, v109, 6, v108
    v_xor_b32 v109, 2, v103
    v_lshl_add_u32 v11, v109, 6, v108
    v_xor_b32 v109, 3, v103
    v_lshl_add_u32 v12, v109, 6, v108
    v_lshl_add_u32 v107, v97, 3, v103
    v_lshl_add_u32 v108, v107, 8, v106
    v_xor_b32 v109, 0, v103
    v_lshl_add_u32 v25, v109, 6, v108
    v_xor_b32 v109, 1, v103
    v_lshl_add_u32 v26, v109, 6, v108
    v_xor_b32 v109, 2, v103
    v_lshl_add_u32 v27, v109, 6, v108
    v_xor_b32 v109, 3, v103
    v_lshl_add_u32 v28, v109, 6, v108
    v_add_u32 v168, 49152, v164
    v_add_u32 v172, 81920, v25
    v_add_u32 v169, 49152, v165
    v_add_u32 v173, 81920, v26
    v_add_u32 v170, 49152, v166
    v_add_u32 v174, 81920, v27
    v_add_u32 v171, 49152, v167
    v_add_u32 v175, 81920, v28
    s_cmp_lt_u32 s3, 2
    s_cbranch_scc0 L_role_2
    s_waitcnt vmcnt(16)
L_role_2:
    s_barrier
    s_cmp_lt_u32 s3, 2
    s_cbranch_scc1 L_role_3
    s_add_u32 s48, s52, 0
    s_mov_b32 m0, s48
    s_add_u32 s48, s51, 0
    s_and_b32 s48, s48, 0x3ffff
    s_add_u32 s48, s48, s52
    buffer_load_dwordx4 v13, s[16:19], s48 offen offset:0 nt lds
    buffer_load_dwordx4 v14, s[16:19], s48 offen offset:1024 nt lds
    buffer_load_dwordx4 v15, s[16:19], s48 offen offset:2048 nt lds
    buffer_load_dwordx4 v16, s[16:19], s48 offen offset:3072 nt lds
    s_add_u32 s48, s52, 4096
    s_mov_b32 m0, s48
    s_add_u32 s48, s51, 0
    s_and_b32 s48, s48, 0x3ffff
    s_add_u32 s48, s48, s52
    s_add_u32 s48, s48, 4096
    buffer_load_dwordx4 v13, s[16:19], s48 offen offset:0 nt lds
    buffer_load_dwordx4 v14, s[16:19], s48 offen offset:1024 nt lds
    buffer_load_dwordx4 v15, s[16:19], s48 offen offset:2048 nt lds
    buffer_load_dwordx4 v16, s[16:19], s48 offen offset:3072 nt lds
    s_add_u32 s48, s52, 16384
    s_mov_b32 m0, s48
    s_add_u32 s48, s51, 16384
    s_and_b32 s48, s48, 0x3ffff
    s_add_u32 s48, s48, s52
    buffer_load_dwordx4 v13, s[16:19], s48 offen offset:0 nt lds
    buffer_load_dwordx4 v14, s[16:19], s48 offen offset:1024 nt lds
    buffer_load_dwordx4 v15, s[16:19], s48 offen offset:2048 nt lds
    buffer_load_dwordx4 v16, s[16:19], s48 offen offset:3072 nt lds
    s_add_u32 s48, s52, 20480
    s_mov_b32 m0, s48
    s_add_u32 s48, s51, 16384
    s_and_b32 s48, s48, 0x3ffff
    s_add_u32 s48, s48, s52
    s_add_u32 s48, s48, 4096
    buffer_load_dwordx4 v13, s[16:19], s48 offen offset:0 nt lds
    buffer_load_dwordx4 v14, s[16:19], s48 offen offset:1024 nt lds
    buffer_load_dwordx4 v15, s[16:19], s48 offen offset:2048 nt lds
    buffer_load_dwordx4 v16, s[16:19], s48 offen offset:3072 nt lds
    s_add_u32 s48, s52, 32768
    s_mov_b32 m0, s48
    s_add_u32 s48, s51, 32768
    s_and_b32 s48, s48, 0x3ffff
    s_add_u32 s48, s48, s52
    buffer_load_dwordx4 v13, s[16:19], s48 offen offset:0 nt lds
    buffer_load_dwordx4 v14, s[16:19], s48 offen offset:1024 nt lds
    buffer_load_dwordx4 v15, s[16:19], s48 offen offset:2048 nt lds
    buffer_load_dwordx4 v16, s[16:19], s48 offen offset:3072 nt lds
    s_add_u32 s48, s52, 36864
    s_mov_b32 m0, s48
    s_add_u32 s48, s51, 32768
    s_and_b32 s48, s48, 0x3ffff
    s_add_u32 s48, s48, s52
    s_add_u32 s48, s48, 4096
    buffer_load_dwordx4 v13, s[16:19], s48 offen offset:0 nt lds
    buffer_load_dwordx4 v14, s[16:19], s48 offen offset:1024 nt lds
    buffer_load_dwordx4 v15, s[16:19], s48 offen offset:2048 nt lds
    buffer_load_dwordx4 v16, s[16:19], s48 offen offset:3072 nt lds
    s_add_u32 s48, s52, 65536
    s_mov_b32 m0, s48
    s_add_u32 s48, s51, 0
    s_and_b32 s48, s48, 0x3ffff
    s_add_u32 s48, s48, s52
    buffer_load_dwordx4 v17, s[20:23], s48 offen offset:0 nt lds
    buffer_load_dwordx4 v17, s[20:23], s48 offen offset:1024 nt lds
    buffer_load_dwordx4 v17, s[20:23], s48 offen offset:2048 nt lds
    buffer_load_dwordx4 v17, s[20:23], s48 offen offset:3072 nt lds
    s_add_u32 s48, s52, 69632
    s_mov_b32 m0, s48
    s_add_u32 s48, s51, 0
    s_and_b32 s48, s48, 0x3ffff
    s_add_u32 s48, s48, s52
    s_add_u32 s48, s48, 4096
    buffer_load_dwordx4 v17, s[20:23], s48 offen offset:0 nt lds
    buffer_load_dwordx4 v17, s[20:23], s48 offen offset:1024 nt lds
    buffer_load_dwordx4 v17, s[20:23], s48 offen offset:2048 nt lds
    buffer_load_dwordx4 v17, s[20:23], s48 offen offset:3072 nt lds
L_role_3:
    ds_read_b128 a[96:99], v168
    ds_read_b64_tr_b16 v[96:97], v172 offset:0
    ds_read_b64_tr_b16 v[98:99], v172 offset:1024
    ds_read_b64_tr_b16 v[100:101], v173 offset:0
    ds_read_b64_tr_b16 v[102:103], v173 offset:1024
    ds_read_b64_tr_b16 v[104:105], v174 offset:0
    ds_read_b64_tr_b16 v[106:107], v174 offset:1024
    ds_read_b64_tr_b16 v[108:109], v175 offset:0
    ds_read_b64_tr_b16 v[110:111], v175 offset:1024
    ds_read_b128 a[100:103], v169
    ds_read_b64_tr_b16 v[112:113], v172 offset:4096
    ds_read_b64_tr_b16 v[114:115], v172 offset:5120
    ds_read_b64_tr_b16 v[116:117], v173 offset:4096
    ds_read_b64_tr_b16 v[118:119], v173 offset:5120
    s_waitcnt lgkmcnt(11)
    v_mfma_f32_32x32x16_bf16 v[32:47], v[96:99], a[96:99], 0
    ds_read_b64_tr_b16 v[120:121], v174 offset:4096
    ds_read_b64_tr_b16 v[122:123], v174 offset:5120
    s_waitcnt lgkmcnt(11)
    v_mfma_f32_32x32x16_bf16 v[48:63], v[100:103], a[96:99], 0
    ds_read_b64_tr_b16 v[124:125], v175 offset:4096
    ds_read_b64_tr_b16 v[126:127], v175 offset:5120
    s_waitcnt lgkmcnt(11)
    v_mfma_f32_32x32x16_bf16 v[64:79], v[104:107], a[96:99], 0
    ds_read_b128 a[104:107], v170
    ds_read_b64_tr_b16 v[128:129], v172 offset:8192
    ds_read_b64_tr_b16 v[130:131], v172 offset:9216
    s_waitcnt lgkmcnt(12)
    v_mfma_f32_32x32x16_bf16 v[80:95], v[108:111], a[96:99], 0
    ds_read_b64_tr_b16 v[132:133], v173 offset:8192
    ds_read_b64_tr_b16 v[134:135], v173 offset:9216
    s_waitcnt lgkmcnt(11)
    v_mfma_f32_32x32x16_bf16 v[32:47], v[112:115], a[100:103], v[32:47]
    ds_read_b64_tr_b16 v[136:137], v174 offset:8192
    ds_read_b64_tr_b16 v[138:139], v174 offset:9216
    s_waitcnt lgkmcnt(11)
    v_mfma_f32_32x32x16_bf16 v[48:63], v[116:119], a[100:103], v[48:63]
    ds_read_b64_tr_b16 v[140:141], v175 offset:8192
    ds_read_b64_tr_b16 v[142:143], v175 offset:9216
    s_waitcnt lgkmcnt(11)
    v_mfma_f32_32x32x16_bf16 v[64:79], v[120:123], a[100:103], v[64:79]
    ds_read_b128 a[108:111], v171
    ds_read_b64_tr_b16 v[144:145], v172 offset:12288
    ds_read_b64_tr_b16 v[146:147], v172 offset:13312
    s_waitcnt lgkmcnt(12)
    v_mfma_f32_32x32x16_bf16 v[80:95], v[124:127], a[100:103], v[80:95]
    ds_read_b64_tr_b16 v[148:149], v173 offset:12288
    ds_read_b64_tr_b16 v[150:151], v173 offset:13312
    s_waitcnt lgkmcnt(11)
    v_mfma_f32_32x32x16_bf16 v[32:47], v[128:131], a[104:107], v[32:47]
    ds_read_b64_tr_b16 v[152:153], v174 offset:12288
    ds_read_b64_tr_b16 v[154:155], v174 offset:13312
    s_waitcnt lgkmcnt(11)
    v_mfma_f32_32x32x16_bf16 v[48:63], v[132:135], a[104:107], v[48:63]
    ds_read_b64_tr_b16 v[156:157], v175 offset:12288
    ds_read_b64_tr_b16 v[158:159], v175 offset:13312
    s_waitcnt lgkmcnt(11)
    v_mfma_f32_32x32x16_bf16 v[64:79], v[136:139], a[104:107], v[64:79]
    s_waitcnt lgkmcnt(9)
    v_mfma_f32_32x32x16_bf16 v[80:95], v[140:143], a[104:107], v[80:95]
    s_waitcnt lgkmcnt(6)
    v_mfma_f32_32x32x16_bf16 v[32:47], v[144:147], a[108:111], v[32:47]
    s_waitcnt lgkmcnt(4)
    v_mfma_f32_32x32x16_bf16 v[48:63], v[148:151], a[108:111], v[48:63]
    s_waitcnt lgkmcnt(2)
    v_mfma_f32_32x32x16_bf16 v[64:79], v[152:155], a[108:111], v[64:79]
    s_waitcnt lgkmcnt(0)
    v_mfma_f32_32x32x16_bf16 v[80:95], v[156:159], a[108:111], v[80:95]
    v_add_u32 v168, 98304, v164
    v_add_u32 v172, 114688, v25
    v_add_u32 v169, 98304, v165
    v_add_u32 v173, 114688, v26
    v_add_u32 v170, 98304, v166
    v_add_u32 v174, 114688, v27
    v_add_u32 v171, 98304, v167
    v_add_u32 v175, 114688, v28
    s_cmp_lt_u32 s3, 2
    s_cbranch_scc0 L_role_4
    s_waitcnt vmcnt(16)
L_role_4:
    s_barrier
    s_cmp_lt_u32 s3, 2
    s_cbranch_scc0 L_role_5
    s_add_u32 s48, s52, 49152
    s_mov_b32 m0, s48
    s_add_u32 s48, s54, 384
    buffer_load_dwordx4 v29, s[8:11], s48 offen  lds
    s_add_u32 s48, s52, 50176
    s_mov_b32 m0, s48
    s_add_u32 s48, s54, 9600
    buffer_load_dwordx4 v29, s[8:11], s48 offen  lds
    s_add_u32 s48, s52, 51200
    s_mov_b32 m0, s48
    s_add_u32 s48, s54, 18816
    buffer_load_dwordx4 v29, s[8:11], s48 offen  lds
    s_add_u32 s48, s52, 52224
    s_mov_b32 m0, s48
    s_add_u32 s48, s54, 28032
    buffer_load_dwordx4 v29, s[8:11], s48 offen  lds
    s_add_u32 s48, s52, 53248
    s_mov_b32 m0, s48
    s_add_u32 s48, s54, 37248
    buffer_load_dwordx4 v29, s[8:11], s48 offen  lds
    s_add_u32 s48, s52, 54272
    s_mov_b32 m0, s48
    s_add_u32 s48, s54, 46464
    buffer_load_dwordx4 v29, s[8:11], s48 offen  lds
    s_add_u32 s48, s52, 55296
    s_mov_b32 m0, s48
    s_add_u32 s48, s54, 55680
    buffer_load_dwordx4 v29, s[8:11], s48 offen  lds
    s_add_u32 s48, s52, 56320
    s_mov_b32 m0, s48
    s_add_u32 s48, s54, 64896
    buffer_load_dwordx4 v29, s[8:11], s48 offen  lds
    s_add_u32 s48, s52, 81920
    s_mov_b32 m0, s48
    s_add_u32 s48, s55, 1572864
    buffer_load_dwordx4 v30, s[12:15], s48 offen  lds
    s_add_u32 s48, s52, 82944
    s_mov_b32 m0, s48
    s_add_u32 s48, s55, 1605632
    buffer_load_dwordx4 v30, s[12:15], s48 offen  lds
    s_add_u32 s48, s52, 83968
    s_mov_b32 m0, s48
    s_add_u32 s48, s55, 1638400
    buffer_load_dwordx4 v30, s[12:15], s48 offen  lds
    s_add_u32 s48, s52, 84992
    s_mov_b32 m0, s48
    s_add_u32 s48, s55, 1671168
    buffer_load_dwordx4 v30, s[12:15], s48 offen  lds
    s_add_u32 s48, s52, 86016
    s_mov_b32 m0, s48
    s_add_u32 s48, s55, 1703936
    buffer_load_dwordx4 v30, s[12:15], s48 offen  lds
    s_add_u32 s48, s52, 87040
    s_mov_b32 m0, s48
    s_add_u32 s48, s55, 1736704
    buffer_load_dwordx4 v30, s[12:15], s48 offen  lds
    s_add_u32 s48, s52, 88064
    s_mov_b32 m0, s48
    s_add_u32 s48, s55, 1769472
    buffer_load_dwordx4 v30, s[12:15], s48 offen  lds
    s_add_u32 s48, s52, 89088
    s_mov_b32 m0, s48
    s_add_u32 s48, s55, 1802240
    buffer_load_dwordx4 v30, s[12:15], s48 offen  lds
L_role_5:
    ds_read_b128 a[96:99], v168
    ds_read_b64_tr_b16 v[96:97], v172 offset:0
    ds_read_b64_tr_b16 v[98:99], v172 offset:1024
    ds_read_b64_tr_b16 v[100:101], v173 offset:0
    ds_read_b64_tr_b16 v[102:103], v173 offset:1024
    ds_read_b64_tr_b16 v[104:105], v174 offset:0
    ds_read_b64_tr_b16 v[106:107], v174 offset:1024
    ds_read_b64_tr_b16 v[108:109], v175 offset:0
    ds_read_b64_tr_b16 v[110:111], v175 offset:1024
    ds_read_b128 a[100:103], v169
    ds_read_b64_tr_b16 v[112:113], v172 offset:4096
    ds_read_b64_tr_b16 v[114:115], v172 offset:5120
    ds_read_b64_tr_b16 v[116:117], v173 offset:4096
    ds_read_b64_tr_b16 v[118:119], v173 offset:5120
    s_waitcnt lgkmcnt(11)
    v_mfma_f32_32x32x16_bf16 v[32:47], v[96:99], a[96:99], v[32:47]
    ds_read_b64_tr_b16 v[120:121], v174 offset:4096
    ds_read_b64_tr_b16 v[122:123], v174 offset:5120
    s_waitcnt lgkmcnt(11)
    v_mfma_f32_32x32x16_bf16 v[48:63], v[100:103], a[96:99], v[48:63]
    ds_read_b64_tr_b16 v[124:125], v175 offset:4096
    ds_read_b64_tr_b16 v[126:127], v175 offset:5120
    s_waitcnt lgkmcnt(11)
    v_mfma_f32_32x32x16_bf16 v[64:79], v[104:107], a[96:99], v[64:79]
    ds_read_b128 a[104:107], v170
    ds_read_b64_tr_b16 v[128:129], v172 offset:8192
    ds_read_b64_tr_b16 v[130:131], v172 offset:9216
    s_waitcnt lgkmcnt(12)
    v_mfma_f32_32x32x16_bf16 v[80:95], v[108:111], a[96:99], v[80:95]
    ds_read_b64_tr_b16 v[132:133], v173 offset:8192
    ds_read_b64_tr_b16 v[134:135], v173 offset:9216
    s_waitcnt lgkmcnt(11)
    v_mfma_f32_32x32x16_bf16 v[32:47], v[112:115], a[100:103], v[32:47]
    ds_read_b64_tr_b16 v[136:137], v174 offset:8192
    ds_read_b64_tr_b16 v[138:139], v174 offset:9216
    s_waitcnt lgkmcnt(11)
    v_mfma_f32_32x32x16_bf16 v[48:63], v[116:119], a[100:103], v[48:63]
    ds_read_b64_tr_b16 v[140:141], v175 offset:8192
    ds_read_b64_tr_b16 v[142:143], v175 offset:9216
    s_waitcnt lgkmcnt(11)
    v_mfma_f32_32x32x16_bf16 v[64:79], v[120:123], a[100:103], v[64:79]
    ds_read_b128 a[108:111], v171
    ds_read_b64_tr_b16 v[144:145], v172 offset:12288
    ds_read_b64_tr_b16 v[146:147], v172 offset:13312
    s_waitcnt lgkmcnt(12)
    v_mfma_f32_32x32x16_bf16 v[80:95], v[124:127], a[100:103], v[80:95]
    ds_read_b64_tr_b16 v[148:149], v173 offset:12288
    ds_read_b64_tr_b16 v[150:151], v173 offset:13312
    s_waitcnt lgkmcnt(11)
    v_mfma_f32_32x32x16_bf16 v[32:47], v[128:131], a[104:107], v[32:47]
    ds_read_b64_tr_b16 v[152:153], v174 offset:12288
    ds_read_b64_tr_b16 v[154:155], v174 offset:13312
    s_waitcnt lgkmcnt(11)
    v_mfma_f32_32x32x16_bf16 v[48:63], v[132:135], a[104:107], v[48:63]
    ds_read_b64_tr_b16 v[156:157], v175 offset:12288
    ds_read_b64_tr_b16 v[158:159], v175 offset:13312
    s_waitcnt lgkmcnt(11)
    v_mfma_f32_32x32x16_bf16 v[64:79], v[136:139], a[104:107], v[64:79]
    s_waitcnt lgkmcnt(9)
    v_mfma_f32_32x32x16_bf16 v[80:95], v[140:143], a[104:107], v[80:95]
    s_waitcnt lgkmcnt(6)
    v_mfma_f32_32x32x16_bf16 v[32:47], v[144:147], a[108:111], v[32:47]
    s_waitcnt lgkmcnt(4)
    v_mfma_f32_32x32x16_bf16 v[48:63], v[148:151], a[108:111], v[48:63]
    s_waitcnt lgkmcnt(2)
    v_mfma_f32_32x32x16_bf16 v[64:79], v[152:155], a[108:111], v[64:79]
    s_waitcnt lgkmcnt(0)
    v_mfma_f32_32x32x16_bf16 v[80:95], v[156:159], a[108:111], v[80:95]
    v_add_u32 v168, 131072, v164
    v_add_u32 v172, 147456, v25
    v_add_u32 v169, 131072, v165
    v_add_u32 v173, 147456, v26
    v_add_u32 v170, 131072, v166
    v_add_u32 v174, 147456, v27
    v_add_u32 v171, 131072, v167
    v_add_u32 v175, 147456, v28
    s_cmp_lt_u32 s3, 2
    s_cbranch_scc0 L_role_6
    s_waitcnt vmcnt(16)
L_role_6:
    s_barrier
    s_cmp_lt_u32 s3, 2
    s_cbranch_scc0 L_role_7
    s_add_u32 s48, s52, 98304
    s_mov_b32 m0, s48
    s_add_u32 s48, s54, 512
    buffer_load_dwordx4 v29, s[8:11], s48 offen  lds
    s_add_u32 s48, s52, 99328
    s_mov_b32 m0, s48
    s_add_u32 s48, s54, 9728
    buffer_load_dwordx4 v29, s[8:11], s48 offen  lds
    s_add_u32 s48, s52, 100352
    s_mov_b32 m0, s48
    s_add_u32 s48, s54, 18944
    buffer_load_dwordx4 v29, s[8:11], s48 offen  lds
    s_add_u32 s48, s52, 101376
    s_mov_b32 m0, s48
    s_add_u32 s48, s54, 28160
    buffer_load_dwordx4 v29, s[8:11], s48 offen  lds
    s_add_u32 s48, s52, 102400
    s_mov_b32 m0, s48
    s_add_u32 s48, s54, 37376
    buffer_load_dwordx4 v29, s[8:11], s48 offen  lds
    s_add_u32 s48, s52, 103424
    s_mov_b32 m0, s48
    s_add_u32 s48, s54, 46592
    buffer_load_dwordx4 v29, s[8:11], s48 offen  lds
    s_add_u32 s48, s52, 104448
    s_mov_b32 m0, s48
    s_add_u32 s48, s54, 55808
    buffer_load_dwordx4 v29, s[8:11], s48 offen  lds
    s_add_u32 s48, s52, 105472
    s_mov_b32 m0, s48
    s_add_u32 s48, s54, 65024
    buffer_load_dwordx4 v29, s[8:11], s48 offen  lds
    s_add_u32 s48, s52, 114688
    s_mov_b32 m0, s48
    s_add_u32 s48, s55, 2097152
    buffer_load_dwordx4 v30, s[12:15], s48 offen  lds
    s_add_u32 s48, s52, 115712
    s_mov_b32 m0, s48
    s_add_u32 s48, s55, 2129920
    buffer_load_dwordx4 v30, s[12:15], s48 offen  lds
    s_add_u32 s48, s52, 116736
    s_mov_b32 m0, s48
    s_add_u32 s48, s55, 2162688
    buffer_load_dwordx4 v30, s[12:15], s48 offen  lds
    s_add_u32 s48, s52, 117760
    s_mov_b32 m0, s48
    s_add_u32 s48, s55, 2195456
    buffer_load_dwordx4 v30, s[12:15], s48 offen  lds
    s_add_u32 s48, s52, 118784
    s_mov_b32 m0, s48
    s_add_u32 s48, s55, 2228224
    buffer_load_dwordx4 v30, s[12:15], s48 offen  lds
    s_add_u32 s48, s52, 119808
    s_mov_b32 m0, s48
    s_add_u32 s48, s55, 2260992
    buffer_load_dwordx4 v30, s[12:15], s48 offen  lds
    s_add_u32 s48, s52, 120832
    s_mov_b32 m0, s48
    s_add_u32 s48, s55, 2293760
    buffer_load_dwordx4 v30, s[12:15], s48 offen  lds
    s_add_u32 s48, s52, 121856
    s_mov_b32 m0, s48
    s_add_u32 s48, s55, 2326528
    buffer_load_dwordx4 v30, s[12:15], s48 offen  lds
L_role_7:
    ds_read_b128 a[96:99], v168
    ds_read_b64_tr_b16 v[96:97], v172 offset:0
    ds_read_b64_tr_b16 v[98:99], v172 offset:1024
    ds_read_b64_tr_b16 v[100:101], v173 offset:0
    ds_read_b64_tr_b16 v[102:103], v173 offset:1024
    ds_read_b64_tr_b16 v[104:105], v174 offset:0
    ds_read_b64_tr_b16 v[106:107], v174 offset:1024
    ds_read_b64_tr_b16 v[108:109], v175 offset:0
    ds_read_b64_tr_b16 v[110:111], v175 offset:1024
    ds_read_b128 a[100:103], v169
    ds_read_b64_tr_b16 v[112:113], v172 offset:4096
    ds_read_b64_tr_b16 v[114:115], v172 offset:5120
    ds_read_b64_tr_b16 v[116:117], v173 offset:4096
    ds_read_b64_tr_b16 v[118:119], v173 offset:5120
    s_waitcnt lgkmcnt(11)
    v_mfma_f32_32x32x16_bf16 v[32:47], v[96:99], a[96:99], v[32:47]
    ds_read_b64_tr_b16 v[120:121], v174 offset:4096
    ds_read_b64_tr_b16 v[122:123], v174 offset:5120
    s_waitcnt lgkmcnt(11)
    v_mfma_f32_32x32x16_bf16 v[48:63], v[100:103], a[96:99], v[48:63]
    ds_read_b64_tr_b16 v[124:125], v175 offset:4096
    ds_read_b64_tr_b16 v[126:127], v175 offset:5120
    s_waitcnt lgkmcnt(11)
    v_mfma_f32_32x32x16_bf16 v[64:79], v[104:107], a[96:99], v[64:79]
    ds_read_b128 a[104:107], v170
    ds_read_b64_tr_b16 v[128:129], v172 offset:8192
    ds_read_b64_tr_b16 v[130:131], v172 offset:9216
    s_waitcnt lgkmcnt(12)
    v_mfma_f32_32x32x16_bf16 v[80:95], v[108:111], a[96:99], v[80:95]
    ds_read_b64_tr_b16 v[132:133], v173 offset:8192
    ds_read_b64_tr_b16 v[134:135], v173 offset:9216
    s_waitcnt lgkmcnt(11)
    v_mfma_f32_32x32x16_bf16 v[32:47], v[112:115], a[100:103], v[32:47]
    ds_read_b64_tr_b16 v[136:137], v174 offset:8192
    ds_read_b64_tr_b16 v[138:139], v174 offset:9216
    s_waitcnt lgkmcnt(11)
    v_mfma_f32_32x32x16_bf16 v[48:63], v[116:119], a[100:103], v[48:63]
    ds_read_b64_tr_b16 v[140:141], v175 offset:8192
    ds_read_b64_tr_b16 v[142:143], v175 offset:9216
    s_waitcnt lgkmcnt(11)
    v_mfma_f32_32x32x16_bf16 v[64:79], v[120:123], a[100:103], v[64:79]
    ds_read_b128 a[108:111], v171
    ds_read_b64_tr_b16 v[144:145], v172 offset:12288
    ds_read_b64_tr_b16 v[146:147], v172 offset:13312
    s_waitcnt lgkmcnt(12)
    v_mfma_f32_32x32x16_bf16 v[80:95], v[124:127], a[100:103], v[80:95]
    ds_read_b64_tr_b16 v[148:149], v173 offset:12288
    ds_read_b64_tr_b16 v[150:151], v173 offset:13312
    s_waitcnt lgkmcnt(11)
    v_mfma_f32_32x32x16_bf16 v[32:47], v[128:131], a[104:107], v[32:47]
    ds_read_b64_tr_b16 v[152:153], v174 offset:12288
    ds_read_b64_tr_b16 v[154:155], v174 offset:13312
    s_waitcnt lgkmcnt(11)
    v_mfma_f32_32x32x16_bf16 v[48:63], v[132:135], a[104:107], v[48:63]
    ds_read_b64_tr_b16 v[156:157], v175 offset:12288
    ds_read_b64_tr_b16 v[158:159], v175 offset:13312
    s_waitcnt lgkmcnt(11)
    v_mfma_f32_32x32x16_bf16 v[64:79], v[136:139], a[104:107], v[64:79]
    s_waitcnt lgkmcnt(9)
    v_mfma_f32_32x32x16_bf16 v[80:95], v[140:143], a[104:107], v[80:95]
    s_waitcnt lgkmcnt(6)
    v_mfma_f32_32x32x16_bf16 v[32:47], v[144:147], a[108:111], v[32:47]
    s_waitcnt lgkmcnt(4)
    v_mfma_f32_32x32x16_bf16 v[48:63], v[148:151], a[108:111], v[48:63]
    s_waitcnt lgkmcnt(2)
    v_mfma_f32_32x32x16_bf16 v[64:79], v[152:155], a[108:111], v[64:79]
    s_waitcnt lgkmcnt(0)
    v_mfma_f32_32x32x16_bf16 v[80:95], v[156:159], a[108:111], v[80:95]
    v_add_u32 v168, 49152, v164
    v_add_u32 v172, 81920, v25
    v_add_u32 v169, 49152, v165
    v_add_u32 v173, 81920, v26
    v_add_u32 v170, 49152, v166
    v_add_u32 v174, 81920, v27
    v_add_u32 v171, 49152, v167
    v_add_u32 v175, 81920, v28
    s_cmp_lt_u32 s3, 2
    s_cbranch_scc0 L_role_8
    s_waitcnt vmcnt(16)
L_role_8:
    s_barrier
    s_cmp_lt_u32 s3, 2
    s_cbranch_scc0 L_role_9
    s_add_u32 s48, s52, 131072
    s_mov_b32 m0, s48
    s_add_u32 s48, s54, 640
    buffer_load_dwordx4 v29, s[8:11], s48 offen  lds
    s_add_u32 s48, s52, 132096
    s_mov_b32 m0, s48
    s_add_u32 s48, s54, 9856
    buffer_load_dwordx4 v29, s[8:11], s48 offen  lds
    s_add_u32 s48, s52, 133120
    s_mov_b32 m0, s48
    s_add_u32 s48, s54, 19072
    buffer_load_dwordx4 v29, s[8:11], s48 offen  lds
    s_add_u32 s48, s52, 134144
    s_mov_b32 m0, s48
    s_add_u32 s48, s54, 28288
    buffer_load_dwordx4 v29, s[8:11], s48 offen  lds
    s_add_u32 s48, s52, 135168
    s_mov_b32 m0, s48
    s_add_u32 s48, s54, 37504
    buffer_load_dwordx4 v29, s[8:11], s48 offen  lds
    s_add_u32 s48, s52, 136192
    s_mov_b32 m0, s48
    s_add_u32 s48, s54, 46720
    buffer_load_dwordx4 v29, s[8:11], s48 offen  lds
    s_add_u32 s48, s52, 137216
    s_mov_b32 m0, s48
    s_add_u32 s48, s54, 55936
    buffer_load_dwordx4 v29, s[8:11], s48 offen  lds
    s_add_u32 s48, s52, 138240
    s_mov_b32 m0, s48
    s_add_u32 s48, s54, 65152
    buffer_load_dwordx4 v29, s[8:11], s48 offen  lds
    s_add_u32 s48, s52, 147456
    s_mov_b32 m0, s48
    s_add_u32 s48, s55, 2621440
    buffer_load_dwordx4 v30, s[12:15], s48 offen  lds
    s_add_u32 s48, s52, 148480
    s_mov_b32 m0, s48
    s_add_u32 s48, s55, 2654208
    buffer_load_dwordx4 v30, s[12:15], s48 offen  lds
    s_add_u32 s48, s52, 149504
    s_mov_b32 m0, s48
    s_add_u32 s48, s55, 2686976
    buffer_load_dwordx4 v30, s[12:15], s48 offen  lds
    s_add_u32 s48, s52, 150528
    s_mov_b32 m0, s48
    s_add_u32 s48, s55, 2719744
    buffer_load_dwordx4 v30, s[12:15], s48 offen  lds
    s_add_u32 s48, s52, 151552
    s_mov_b32 m0, s48
    s_add_u32 s48, s55, 2752512
    buffer_load_dwordx4 v30, s[12:15], s48 offen  lds
    s_add_u32 s48, s52, 152576
    s_mov_b32 m0, s48
    s_add_u32 s48, s55, 2785280
    buffer_load_dwordx4 v30, s[12:15], s48 offen  lds
    s_add_u32 s48, s52, 153600
    s_mov_b32 m0, s48
    s_add_u32 s48, s55, 2818048
    buffer_load_dwordx4 v30, s[12:15], s48 offen  lds
    s_add_u32 s48, s52, 154624
    s_mov_b32 m0, s48
    s_add_u32 s48, s55, 2850816
    buffer_load_dwordx4 v30, s[12:15], s48 offen  lds
L_role_9:
    ds_read_b128 a[96:99], v168
    ds_read_b64_tr_b16 v[96:97], v172 offset:0
    ds_read_b64_tr_b16 v[98:99], v172 offset:1024
    ds_read_b64_tr_b16 v[100:101], v173 offset:0
    ds_read_b64_tr_b16 v[102:103], v173 offset:1024
    ds_read_b64_tr_b16 v[104:105], v174 offset:0
    ds_read_b64_tr_b16 v[106:107], v174 offset:1024
    ds_read_b64_tr_b16 v[108:109], v175 offset:0
    ds_read_b64_tr_b16 v[110:111], v175 offset:1024
    ds_read_b128 a[100:103], v169
    ds_read_b64_tr_b16 v[112:113], v172 offset:4096
    ds_read_b64_tr_b16 v[114:115], v172 offset:5120
    ds_read_b64_tr_b16 v[116:117], v173 offset:4096
    ds_read_b64_tr_b16 v[118:119], v173 offset:5120
    s_waitcnt lgkmcnt(11)
    v_mfma_f32_32x32x16_bf16 v[32:47], v[96:99], a[96:99], v[32:47]
    ds_read_b64_tr_b16 v[120:121], v174 offset:4096
    ds_read_b64_tr_b16 v[122:123], v174 offset:5120
    s_waitcnt lgkmcnt(11)
    v_mfma_f32_32x32x16_bf16 v[48:63], v[100:103], a[96:99], v[48:63]
    ds_read_b64_tr_b16 v[124:125], v175 offset:4096
    ds_read_b64_tr_b16 v[126:127], v175 offset:5120
    s_waitcnt lgkmcnt(11)
    v_mfma_f32_32x32x16_bf16 v[64:79], v[104:107], a[96:99], v[64:79]
    ds_read_b128 a[104:107], v170
    ds_read_b64_tr_b16 v[128:129], v172 offset:8192
    ds_read_b64_tr_b16 v[130:131], v172 offset:9216
    s_waitcnt lgkmcnt(12)
    v_mfma_f32_32x32x16_bf16 v[80:95], v[108:111], a[96:99], v[80:95]
    ds_read_b64_tr_b16 v[132:133], v173 offset:8192
    ds_read_b64_tr_b16 v[134:135], v173 offset:9216
    s_waitcnt lgkmcnt(11)
    v_mfma_f32_32x32x16_bf16 v[32:47], v[112:115], a[100:103], v[32:47]
    ds_read_b64_tr_b16 v[136:137], v174 offset:8192
    ds_read_b64_tr_b16 v[138:139], v174 offset:9216
    s_waitcnt lgkmcnt(11)
    v_mfma_f32_32x32x16_bf16 v[48:63], v[116:119], a[100:103], v[48:63]
    ds_read_b64_tr_b16 v[140:141], v175 offset:8192
    ds_read_b64_tr_b16 v[142:143], v175 offset:9216
    s_waitcnt lgkmcnt(11)
    v_mfma_f32_32x32x16_bf16 v[64:79], v[120:123], a[100:103], v[64:79]
    ds_read_b128 a[108:111], v171
    ds_read_b64_tr_b16 v[144:145], v172 offset:12288
    ds_read_b64_tr_b16 v[146:147], v172 offset:13312
    s_waitcnt lgkmcnt(12)
    v_mfma_f32_32x32x16_bf16 v[80:95], v[124:127], a[100:103], v[80:95]
    ds_read_b64_tr_b16 v[148:149], v173 offset:12288
    ds_read_b64_tr_b16 v[150:151], v173 offset:13312
    s_waitcnt lgkmcnt(11)
    v_mfma_f32_32x32x16_bf16 v[32:47], v[128:131], a[104:107], v[32:47]
    ds_read_b64_tr_b16 v[152:153], v174 offset:12288
    ds_read_b64_tr_b16 v[154:155], v174 offset:13312
    s_waitcnt lgkmcnt(11)
    v_mfma_f32_32x32x16_bf16 v[48:63], v[132:135], a[104:107], v[48:63]
    ds_read_b64_tr_b16 v[156:157], v175 offset:12288
    ds_read_b64_tr_b16 v[158:159], v175 offset:13312
    s_waitcnt lgkmcnt(11)
    v_mfma_f32_32x32x16_bf16 v[64:79], v[136:139], a[104:107], v[64:79]
    s_waitcnt lgkmcnt(9)
    v_mfma_f32_32x32x16_bf16 v[80:95], v[140:143], a[104:107], v[80:95]
    s_waitcnt lgkmcnt(6)
    v_mfma_f32_32x32x16_bf16 v[32:47], v[144:147], a[108:111], v[32:47]
    s_waitcnt lgkmcnt(4)
    v_mfma_f32_32x32x16_bf16 v[48:63], v[148:151], a[108:111], v[48:63]
    s_waitcnt lgkmcnt(2)
    v_mfma_f32_32x32x16_bf16 v[64:79], v[152:155], a[108:111], v[64:79]
    s_waitcnt lgkmcnt(0)
    v_mfma_f32_32x32x16_bf16 v[80:95], v[156:159], a[108:111], v[80:95]
    v_add_u32 v168, 98304, v164
    v_add_u32 v172, 114688, v25
    v_add_u32 v169, 98304, v165
    v_add_u32 v173, 114688, v26
    v_add_u32 v170, 98304, v166
    v_add_u32 v174, 114688, v27
    v_add_u32 v171, 98304, v167
    v_add_u32 v175, 114688, v28
    s_cmp_lt_u32 s3, 2
    s_cbranch_scc0 L_role_10
    s_waitcnt vmcnt(16)
L_role_10:
    s_barrier
    s_cmp_lt_u32 s3, 2
    s_cbranch_scc0 L_role_11
    s_add_u32 s48, s52, 49152
    s_mov_b32 m0, s48
    s_add_u32 s48, s54, 768
    buffer_load_dwordx4 v29, s[8:11], s48 offen  lds
    s_add_u32 s48, s52, 50176
    s_mov_b32 m0, s48
    s_add_u32 s48, s54, 9984
    buffer_load_dwordx4 v29, s[8:11], s48 offen  lds
    s_add_u32 s48, s52, 51200
    s_mov_b32 m0, s48
    s_add_u32 s48, s54, 19200
    buffer_load_dwordx4 v29, s[8:11], s48 offen  lds
    s_add_u32 s48, s52, 52224
    s_mov_b32 m0, s48
    s_add_u32 s48, s54, 28416
    buffer_load_dwordx4 v29, s[8:11], s48 offen  lds
    s_add_u32 s48, s52, 53248
    s_mov_b32 m0, s48
    s_add_u32 s48, s54, 37632
    buffer_load_dwordx4 v29, s[8:11], s48 offen  lds
    s_add_u32 s48, s52, 54272
    s_mov_b32 m0, s48
    s_add_u32 s48, s54, 46848
    buffer_load_dwordx4 v29, s[8:11], s48 offen  lds
    s_add_u32 s48, s52, 55296
    s_mov_b32 m0, s48
    s_add_u32 s48, s54, 56064
    buffer_load_dwordx4 v29, s[8:11], s48 offen  lds
    s_add_u32 s48, s52, 56320
    s_mov_b32 m0, s48
    s_add_u32 s48, s54, 65280
    buffer_load_dwordx4 v29, s[8:11], s48 offen  lds
    s_add_u32 s48, s52, 81920
    s_mov_b32 m0, s48
    s_add_u32 s48, s55, 3145728
    buffer_load_dwordx4 v30, s[12:15], s48 offen  lds
    s_add_u32 s48, s52, 82944
    s_mov_b32 m0, s48
    s_add_u32 s48, s55, 3178496
    buffer_load_dwordx4 v30, s[12:15], s48 offen  lds
    s_add_u32 s48, s52, 83968
    s_mov_b32 m0, s48
    s_add_u32 s48, s55, 3211264
    buffer_load_dwordx4 v30, s[12:15], s48 offen  lds
    s_add_u32 s48, s52, 84992
    s_mov_b32 m0, s48
    s_add_u32 s48, s55, 3244032
    buffer_load_dwordx4 v30, s[12:15], s48 offen  lds
    s_add_u32 s48, s52, 86016
    s_mov_b32 m0, s48
    s_add_u32 s48, s55, 3276800
    buffer_load_dwordx4 v30, s[12:15], s48 offen  lds
    s_add_u32 s48, s52, 87040
    s_mov_b32 m0, s48
    s_add_u32 s48, s55, 3309568
    buffer_load_dwordx4 v30, s[12:15], s48 offen  lds
    s_add_u32 s48, s52, 88064
    s_mov_b32 m0, s48
    s_add_u32 s48, s55, 3342336
    buffer_load_dwordx4 v30, s[12:15], s48 offen  lds
    s_add_u32 s48, s52, 89088
    s_mov_b32 m0, s48
    s_add_u32 s48, s55, 3375104
    buffer_load_dwordx4 v30, s[12:15], s48 offen  lds
L_role_11:
    ds_read_b128 a[96:99], v168
    ds_read_b64_tr_b16 v[96:97], v172 offset:0
    ds_read_b64_tr_b16 v[98:99], v172 offset:1024
    ds_read_b64_tr_b16 v[100:101], v173 offset:0
    ds_read_b64_tr_b16 v[102:103], v173 offset:1024
    ds_read_b64_tr_b16 v[104:105], v174 offset:0
    ds_read_b64_tr_b16 v[106:107], v174 offset:1024
    ds_read_b64_tr_b16 v[108:109], v175 offset:0
    ds_read_b64_tr_b16 v[110:111], v175 offset:1024
    ds_read_b128 a[100:103], v169
    ds_read_b64_tr_b16 v[112:113], v172 offset:4096
    ds_read_b64_tr_b16 v[114:115], v172 offset:5120
    ds_read_b64_tr_b16 v[116:117], v173 offset:4096
    ds_read_b64_tr_b16 v[118:119], v173 offset:5120
    s_waitcnt lgkmcnt(11)
    v_mfma_f32_32x32x16_bf16 v[32:47], v[96:99], a[96:99], v[32:47]
    ds_read_b64_tr_b16 v[120:121], v174 offset:4096
    ds_read_b64_tr_b16 v[122:123], v174 offset:5120
    s_waitcnt lgkmcnt(11)
    v_mfma_f32_32x32x16_bf16 v[48:63], v[100:103], a[96:99], v[48:63]
    ds_read_b64_tr_b16 v[124:125], v175 offset:4096
    ds_read_b64_tr_b16 v[126:127], v175 offset:5120
    s_waitcnt lgkmcnt(11)
    v_mfma_f32_32x32x16_bf16 v[64:79], v[104:107], a[96:99], v[64:79]
    ds_read_b128 a[104:107], v170
    ds_read_b64_tr_b16 v[128:129], v172 offset:8192
    ds_read_b64_tr_b16 v[130:131], v172 offset:9216
    s_waitcnt lgkmcnt(12)
    v_mfma_f32_32x32x16_bf16 v[80:95], v[108:111], a[96:99], v[80:95]
    ds_read_b64_tr_b16 v[132:133], v173 offset:8192
    ds_read_b64_tr_b16 v[134:135], v173 offset:9216
    s_waitcnt lgkmcnt(11)
    v_mfma_f32_32x32x16_bf16 v[32:47], v[112:115], a[100:103], v[32:47]
    ds_read_b64_tr_b16 v[136:137], v174 offset:8192
    ds_read_b64_tr_b16 v[138:139], v174 offset:9216
    s_waitcnt lgkmcnt(11)
    v_mfma_f32_32x32x16_bf16 v[48:63], v[116:119], a[100:103], v[48:63]
    ds_read_b64_tr_b16 v[140:141], v175 offset:8192
    ds_read_b64_tr_b16 v[142:143], v175 offset:9216
    s_waitcnt lgkmcnt(11)
    v_mfma_f32_32x32x16_bf16 v[64:79], v[120:123], a[100:103], v[64:79]
    ds_read_b128 a[108:111], v171
    ds_read_b64_tr_b16 v[144:145], v172 offset:12288
    ds_read_b64_tr_b16 v[146:147], v172 offset:13312
    s_waitcnt lgkmcnt(12)
    v_mfma_f32_32x32x16_bf16 v[80:95], v[124:127], a[100:103], v[80:95]
    ds_read_b64_tr_b16 v[148:149], v173 offset:12288
    ds_read_b64_tr_b16 v[150:151], v173 offset:13312
    s_waitcnt lgkmcnt(11)
    v_mfma_f32_32x32x16_bf16 v[32:47], v[128:131], a[104:107], v[32:47]
    ds_read_b64_tr_b16 v[152:153], v174 offset:12288
    ds_read_b64_tr_b16 v[154:155], v174 offset:13312
    s_waitcnt lgkmcnt(11)
    v_mfma_f32_32x32x16_bf16 v[48:63], v[132:135], a[104:107], v[48:63]
    ds_read_b64_tr_b16 v[156:157], v175 offset:12288
    ds_read_b64_tr_b16 v[158:159], v175 offset:13312
    s_waitcnt lgkmcnt(11)
    v_mfma_f32_32x32x16_bf16 v[64:79], v[136:139], a[104:107], v[64:79]
    s_waitcnt lgkmcnt(9)
    v_mfma_f32_32x32x16_bf16 v[80:95], v[140:143], a[104:107], v[80:95]
    s_waitcnt lgkmcnt(6)
    v_mfma_f32_32x32x16_bf16 v[32:47], v[144:147], a[108:111], v[32:47]
    s_waitcnt lgkmcnt(4)
    v_mfma_f32_32x32x16_bf16 v[48:63], v[148:151], a[108:111], v[48:63]
    s_waitcnt lgkmcnt(2)
    v_mfma_f32_32x32x16_bf16 v[64:79], v[152:155], a[108:111], v[64:79]
    s_waitcnt lgkmcnt(0)
    v_mfma_f32_32x32x16_bf16 v[80:95], v[156:159], a[108:111], v[80:95]
    v_add_u32 v168, 131072, v164
    v_add_u32 v172, 147456, v25
    v_add_u32 v169, 131072, v165
    v_add_u32 v173, 147456, v26
    v_add_u32 v170, 131072, v166
    v_add_u32 v174, 147456, v27
    v_add_u32 v171, 131072, v167
    v_add_u32 v175, 147456, v28
    s_cmp_lt_u32 s3, 2
    s_cbranch_scc0 L_role_12
    s_waitcnt vmcnt(16)
L_role_12:
    s_barrier
    s_cmp_lt_u32 s3, 2
    s_cbranch_scc0 L_role_13
    s_add_u32 s48, s52, 98304
    s_mov_b32 m0, s48
    s_add_u32 s48, s54, 896
    buffer_load_dwordx4 v29, s[8:11], s48 offen  lds
    s_add_u32 s48, s52, 99328
    s_mov_b32 m0, s48
    s_add_u32 s48, s54, 10112
    buffer_load_dwordx4 v29, s[8:11], s48 offen  lds
    s_add_u32 s48, s52, 100352
    s_mov_b32 m0, s48
    s_add_u32 s48, s54, 19328
    buffer_load_dwordx4 v29, s[8:11], s48 offen  lds
    s_add_u32 s48, s52, 101376
    s_mov_b32 m0, s48
    s_add_u32 s48, s54, 28544
    buffer_load_dwordx4 v29, s[8:11], s48 offen  lds
    s_add_u32 s48, s52, 102400
    s_mov_b32 m0, s48
    s_add_u32 s48, s54, 37760
    buffer_load_dwordx4 v29, s[8:11], s48 offen  lds
    s_add_u32 s48, s52, 103424
    s_mov_b32 m0, s48
    s_add_u32 s48, s54, 46976
    buffer_load_dwordx4 v29, s[8:11], s48 offen  lds
    s_add_u32 s48, s52, 104448
    s_mov_b32 m0, s48
    s_add_u32 s48, s54, 56192
    buffer_load_dwordx4 v29, s[8:11], s48 offen  lds
    s_add_u32 s48, s52, 105472
    s_mov_b32 m0, s48
    s_add_u32 s48, s54, 65408
    buffer_load_dwordx4 v29, s[8:11], s48 offen  lds
    s_add_u32 s48, s52, 114688
    s_mov_b32 m0, s48
    s_add_u32 s48, s55, 3670016
    buffer_load_dwordx4 v30, s[12:15], s48 offen  lds
    s_add_u32 s48, s52, 115712
    s_mov_b32 m0, s48
    s_add_u32 s48, s55, 3702784
    buffer_load_dwordx4 v30, s[12:15], s48 offen  lds
    s_add_u32 s48, s52, 116736
    s_mov_b32 m0, s48
    s_add_u32 s48, s55, 3735552
    buffer_load_dwordx4 v30, s[12:15], s48 offen  lds
    s_add_u32 s48, s52, 117760
    s_mov_b32 m0, s48
    s_add_u32 s48, s55, 3768320
    buffer_load_dwordx4 v30, s[12:15], s48 offen  lds
    s_add_u32 s48, s52, 118784
    s_mov_b32 m0, s48
    s_add_u32 s48, s55, 3801088
    buffer_load_dwordx4 v30, s[12:15], s48 offen  lds
    s_add_u32 s48, s52, 119808
    s_mov_b32 m0, s48
    s_add_u32 s48, s55, 3833856
    buffer_load_dwordx4 v30, s[12:15], s48 offen  lds
    s_add_u32 s48, s52, 120832
    s_mov_b32 m0, s48
    s_add_u32 s48, s55, 3866624
    buffer_load_dwordx4 v30, s[12:15], s48 offen  lds
    s_add_u32 s48, s52, 121856
    s_mov_b32 m0, s48
    s_add_u32 s48, s55, 3899392
    buffer_load_dwordx4 v30, s[12:15], s48 offen  lds
L_role_13:
    ds_read_b128 a[96:99], v168
    ds_read_b64_tr_b16 v[96:97], v172 offset:0
    ds_read_b64_tr_b16 v[98:99], v172 offset:1024
    ds_read_b64_tr_b16 v[100:101], v173 offset:0
    ds_read_b64_tr_b16 v[102:103], v173 offset:1024
    ds_read_b64_tr_b16 v[104:105], v174 offset:0
    ds_read_b64_tr_b16 v[106:107], v174 offset:1024
    ds_read_b64_tr_b16 v[108:109], v175 offset:0
    ds_read_b64_tr_b16 v[110:111], v175 offset:1024
    ds_read_b128 a[100:103], v169
    ds_read_b64_tr_b16 v[112:113], v172 offset:4096
    ds_read_b64_tr_b16 v[114:115], v172 offset:5120
    ds_read_b64_tr_b16 v[116:117], v173 offset:4096
    ds_read_b64_tr_b16 v[118:119], v173 offset:5120
    s_waitcnt lgkmcnt(11)
    v_mfma_f32_32x32x16_bf16 v[32:47], v[96:99], a[96:99], v[32:47]
    ds_read_b64_tr_b16 v[120:121], v174 offset:4096
    ds_read_b64_tr_b16 v[122:123], v174 offset:5120
    s_waitcnt lgkmcnt(11)
    v_mfma_f32_32x32x16_bf16 v[48:63], v[100:103], a[96:99], v[48:63]
    ds_read_b64_tr_b16 v[124:125], v175 offset:4096
    ds_read_b64_tr_b16 v[126:127], v175 offset:5120
    s_waitcnt lgkmcnt(11)
    v_mfma_f32_32x32x16_bf16 v[64:79], v[104:107], a[96:99], v[64:79]
    ds_read_b128 a[104:107], v170
    ds_read_b64_tr_b16 v[128:129], v172 offset:8192
    ds_read_b64_tr_b16 v[130:131], v172 offset:9216
    s_waitcnt lgkmcnt(12)
    v_mfma_f32_32x32x16_bf16 v[80:95], v[108:111], a[96:99], v[80:95]
    ds_read_b64_tr_b16 v[132:133], v173 offset:8192
    ds_read_b64_tr_b16 v[134:135], v173 offset:9216
    s_waitcnt lgkmcnt(11)
    v_mfma_f32_32x32x16_bf16 v[32:47], v[112:115], a[100:103], v[32:47]
    ds_read_b64_tr_b16 v[136:137], v174 offset:8192
    ds_read_b64_tr_b16 v[138:139], v174 offset:9216
    s_waitcnt lgkmcnt(11)
    v_mfma_f32_32x32x16_bf16 v[48:63], v[116:119], a[100:103], v[48:63]
    ds_read_b64_tr_b16 v[140:141], v175 offset:8192
    ds_read_b64_tr_b16 v[142:143], v175 offset:9216
    s_waitcnt lgkmcnt(11)
    v_mfma_f32_32x32x16_bf16 v[64:79], v[120:123], a[100:103], v[64:79]
    ds_read_b128 a[108:111], v171
    ds_read_b64_tr_b16 v[144:145], v172 offset:12288
    ds_read_b64_tr_b16 v[146:147], v172 offset:13312
    s_waitcnt lgkmcnt(12)
    v_mfma_f32_32x32x16_bf16 v[80:95], v[124:127], a[100:103], v[80:95]
    ds_read_b64_tr_b16 v[148:149], v173 offset:12288
    ds_read_b64_tr_b16 v[150:151], v173 offset:13312
    s_waitcnt lgkmcnt(11)
    v_mfma_f32_32x32x16_bf16 v[32:47], v[128:131], a[104:107], v[32:47]
    ds_read_b64_tr_b16 v[152:153], v174 offset:12288
    ds_read_b64_tr_b16 v[154:155], v174 offset:13312
    s_waitcnt lgkmcnt(11)
    v_mfma_f32_32x32x16_bf16 v[48:63], v[132:135], a[104:107], v[48:63]
    ds_read_b64_tr_b16 v[156:157], v175 offset:12288
    ds_read_b64_tr_b16 v[158:159], v175 offset:13312
    s_waitcnt lgkmcnt(11)
    v_mfma_f32_32x32x16_bf16 v[64:79], v[136:139], a[104:107], v[64:79]
    s_waitcnt lgkmcnt(9)
    v_mfma_f32_32x32x16_bf16 v[80:95], v[140:143], a[104:107], v[80:95]
    s_waitcnt lgkmcnt(6)
    v_mfma_f32_32x32x16_bf16 v[32:47], v[144:147], a[108:111], v[32:47]
    s_waitcnt lgkmcnt(4)
    v_mfma_f32_32x32x16_bf16 v[48:63], v[148:151], a[108:111], v[48:63]
    s_waitcnt lgkmcnt(2)
    v_mfma_f32_32x32x16_bf16 v[64:79], v[152:155], a[108:111], v[64:79]
    s_waitcnt lgkmcnt(0)
    v_mfma_f32_32x32x16_bf16 v[80:95], v[156:159], a[108:111], v[80:95]
    v_add_u32 v168, 49152, v164
    v_add_u32 v172, 81920, v25
    v_add_u32 v169, 49152, v165
    v_add_u32 v173, 81920, v26
    v_add_u32 v170, 49152, v166
    v_add_u32 v174, 81920, v27
    v_add_u32 v171, 49152, v167
    v_add_u32 v175, 81920, v28
    s_cmp_lt_u32 s3, 2
    s_cbranch_scc0 L_role_14
    s_waitcnt vmcnt(16)
L_role_14:
    s_barrier
    s_cmp_lt_u32 s3, 2
    s_cbranch_scc0 L_role_15
    s_add_u32 s48, s52, 131072
    s_mov_b32 m0, s48
    s_add_u32 s48, s54, 1024
    buffer_load_dwordx4 v29, s[8:11], s48 offen  lds
    s_add_u32 s48, s52, 132096
    s_mov_b32 m0, s48
    s_add_u32 s48, s54, 10240
    buffer_load_dwordx4 v29, s[8:11], s48 offen  lds
    s_add_u32 s48, s52, 133120
    s_mov_b32 m0, s48
    s_add_u32 s48, s54, 19456
    buffer_load_dwordx4 v29, s[8:11], s48 offen  lds
    s_add_u32 s48, s52, 134144
    s_mov_b32 m0, s48
    s_add_u32 s48, s54, 28672
    buffer_load_dwordx4 v29, s[8:11], s48 offen  lds
    s_add_u32 s48, s52, 135168
    s_mov_b32 m0, s48
    s_add_u32 s48, s54, 37888
    buffer_load_dwordx4 v29, s[8:11], s48 offen  lds
    s_add_u32 s48, s52, 136192
    s_mov_b32 m0, s48
    s_add_u32 s48, s54, 47104
    buffer_load_dwordx4 v29, s[8:11], s48 offen  lds
    s_add_u32 s48, s52, 137216
    s_mov_b32 m0, s48
    s_add_u32 s48, s54, 56320
    buffer_load_dwordx4 v29, s[8:11], s48 offen  lds
    s_add_u32 s48, s52, 138240
    s_mov_b32 m0, s48
    s_add_u32 s48, s54, 65536
    buffer_load_dwordx4 v29, s[8:11], s48 offen  lds
    s_add_u32 s48, s52, 147456
    s_mov_b32 m0, s48
    s_add_u32 s48, s55, 4194304
    buffer_load_dwordx4 v30, s[12:15], s48 offen  lds
    s_add_u32 s48, s52, 148480
    s_mov_b32 m0, s48
    s_add_u32 s48, s55, 4227072
    buffer_load_dwordx4 v30, s[12:15], s48 offen  lds
    s_add_u32 s48, s52, 149504
    s_mov_b32 m0, s48
    s_add_u32 s48, s55, 4259840
    buffer_load_dwordx4 v30, s[12:15], s48 offen  lds
    s_add_u32 s48, s52, 150528
    s_mov_b32 m0, s48
    s_add_u32 s48, s55, 4292608
    buffer_load_dwordx4 v30, s[12:15], s48 offen  lds
    s_add_u32 s48, s52, 151552
    s_mov_b32 m0, s48
    s_add_u32 s48, s55, 4325376
    buffer_load_dwordx4 v30, s[12:15], s48 offen  lds
    s_add_u32 s48, s52, 152576
    s_mov_b32 m0, s48
    s_add_u32 s48, s55, 4358144
    buffer_load_dwordx4 v30, s[12:15], s48 offen  lds
    s_add_u32 s48, s52, 153600
    s_mov_b32 m0, s48
    s_add_u32 s48, s55, 4390912
    buffer_load_dwordx4 v30, s[12:15], s48 offen  lds
    s_add_u32 s48, s52, 154624
    s_mov_b32 m0, s48
    s_add_u32 s48, s55, 4423680
    buffer_load_dwordx4 v30, s[12:15], s48 offen  lds
L_role_15:
    ds_read_b128 a[96:99], v168
    ds_read_b64_tr_b16 v[96:97], v172 offset:0
    ds_read_b64_tr_b16 v[98:99], v172 offset:1024
    ds_read_b64_tr_b16 v[100:101], v173 offset:0
    ds_read_b64_tr_b16 v[102:103], v173 offset:1024
    ds_read_b64_tr_b16 v[104:105], v174 offset:0
    ds_read_b64_tr_b16 v[106:107], v174 offset:1024
    ds_read_b64_tr_b16 v[108:109], v175 offset:0
    ds_read_b64_tr_b16 v[110:111], v175 offset:1024
    ds_read_b128 a[100:103], v169
    ds_read_b64_tr_b16 v[112:113], v172 offset:4096
    ds_read_b64_tr_b16 v[114:115], v172 offset:5120
    ds_read_b64_tr_b16 v[116:117], v173 offset:4096
    ds_read_b64_tr_b16 v[118:119], v173 offset:5120
    s_waitcnt lgkmcnt(11)
    v_mfma_f32_32x32x16_bf16 v[32:47], v[96:99], a[96:99], v[32:47]
    ds_read_b64_tr_b16 v[120:121], v174 offset:4096
    ds_read_b64_tr_b16 v[122:123], v174 offset:5120
    s_waitcnt lgkmcnt(11)
    v_mfma_f32_32x32x16_bf16 v[48:63], v[100:103], a[96:99], v[48:63]
    ds_read_b64_tr_b16 v[124:125], v175 offset:4096
    ds_read_b64_tr_b16 v[126:127], v175 offset:5120
    s_waitcnt lgkmcnt(11)
    v_mfma_f32_32x32x16_bf16 v[64:79], v[104:107], a[96:99], v[64:79]
    ds_read_b128 a[104:107], v170
    ds_read_b64_tr_b16 v[128:129], v172 offset:8192
    ds_read_b64_tr_b16 v[130:131], v172 offset:9216
    s_waitcnt lgkmcnt(12)
    v_mfma_f32_32x32x16_bf16 v[80:95], v[108:111], a[96:99], v[80:95]
    ds_read_b64_tr_b16 v[132:133], v173 offset:8192
    ds_read_b64_tr_b16 v[134:135], v173 offset:9216
    s_waitcnt lgkmcnt(11)
    v_mfma_f32_32x32x16_bf16 v[32:47], v[112:115], a[100:103], v[32:47]
    ds_read_b64_tr_b16 v[136:137], v174 offset:8192
    ds_read_b64_tr_b16 v[138:139], v174 offset:9216
    s_waitcnt lgkmcnt(11)
    v_mfma_f32_32x32x16_bf16 v[48:63], v[116:119], a[100:103], v[48:63]
    ds_read_b64_tr_b16 v[140:141], v175 offset:8192
    ds_read_b64_tr_b16 v[142:143], v175 offset:9216
    s_waitcnt lgkmcnt(11)
    v_mfma_f32_32x32x16_bf16 v[64:79], v[120:123], a[100:103], v[64:79]
    ds_read_b128 a[108:111], v171
    ds_read_b64_tr_b16 v[144:145], v172 offset:12288
    ds_read_b64_tr_b16 v[146:147], v172 offset:13312
    s_waitcnt lgkmcnt(12)
    v_mfma_f32_32x32x16_bf16 v[80:95], v[124:127], a[100:103], v[80:95]
    ds_read_b64_tr_b16 v[148:149], v173 offset:12288
    ds_read_b64_tr_b16 v[150:151], v173 offset:13312
    s_waitcnt lgkmcnt(11)
    v_mfma_f32_32x32x16_bf16 v[32:47], v[128:131], a[104:107], v[32:47]
    ds_read_b64_tr_b16 v[152:153], v174 offset:12288
    ds_read_b64_tr_b16 v[154:155], v174 offset:13312
    s_waitcnt lgkmcnt(11)
    v_mfma_f32_32x32x16_bf16 v[48:63], v[132:135], a[104:107], v[48:63]
    ds_read_b64_tr_b16 v[156:157], v175 offset:12288
    ds_read_b64_tr_b16 v[158:159], v175 offset:13312
    s_waitcnt lgkmcnt(11)
    v_mfma_f32_32x32x16_bf16 v[64:79], v[136:139], a[104:107], v[64:79]
    s_waitcnt lgkmcnt(9)
    v_mfma_f32_32x32x16_bf16 v[80:95], v[140:143], a[104:107], v[80:95]
    s_waitcnt lgkmcnt(6)
    v_mfma_f32_32x32x16_bf16 v[32:47], v[144:147], a[108:111], v[32:47]
    s_waitcnt lgkmcnt(4)
    v_mfma_f32_32x32x16_bf16 v[48:63], v[148:151], a[108:111], v[48:63]
    s_waitcnt lgkmcnt(2)
    v_mfma_f32_32x32x16_bf16 v[64:79], v[152:155], a[108:111], v[64:79]
    s_waitcnt lgkmcnt(0)
    v_mfma_f32_32x32x16_bf16 v[80:95], v[156:159], a[108:111], v[80:95]
    v_add_u32 v168, 98304, v164
    v_add_u32 v172, 114688, v25
    v_add_u32 v169, 98304, v165
    v_add_u32 v173, 114688, v26
    v_add_u32 v170, 98304, v166
    v_add_u32 v174, 114688, v27
    v_add_u32 v171, 98304, v167
    v_add_u32 v175, 114688, v28
    s_cmp_lt_u32 s3, 2
    s_cbranch_scc0 L_role_16
    s_waitcnt vmcnt(16)
L_role_16:
    s_barrier
    s_cmp_lt_u32 s3, 2
    s_cbranch_scc1 L_role_17
    s_add_u32 s48, s52, 49152
    s_mov_b32 m0, s48
    s_add_u32 s48, s51, 49152
    s_and_b32 s48, s48, 0x3ffff
    s_add_u32 s48, s48, s52
    buffer_load_dwordx4 v13, s[16:19], s48 offen offset:0 nt lds
    buffer_load_dwordx4 v14, s[16:19], s48 offen offset:1024 nt lds
    buffer_load_dwordx4 v15, s[16:19], s48 offen offset:2048 nt lds
    buffer_load_dwordx4 v16, s[16:19], s48 offen offset:3072 nt lds
    s_add_u32 s48, s52, 53248
    s_mov_b32 m0, s48
    s_add_u32 s48, s51, 49152
    s_and_b32 s48, s48, 0x3ffff
    s_add_u32 s48, s48, s52
    s_add_u32 s48, s48, 4096
    buffer_load_dwordx4 v13, s[16:19], s48 offen offset:0 nt lds
    buffer_load_dwordx4 v14, s[16:19], s48 offen offset:1024 nt lds
    buffer_load_dwordx4 v15, s[16:19], s48 offen offset:2048 nt lds
    buffer_load_dwordx4 v16, s[16:19], s48 offen offset:3072 nt lds
    s_add_u32 s48, s52, 81920
    s_mov_b32 m0, s48
    s_add_u32 s48, s51, 16384
    s_and_b32 s48, s48, 0x3ffff
    s_add_u32 s48, s48, s52
    buffer_load_dwordx4 v17, s[20:23], s48 offen offset:0 nt lds
    buffer_load_dwordx4 v17, s[20:23], s48 offen offset:1024 nt lds
    buffer_load_dwordx4 v17, s[20:23], s48 offen offset:2048 nt lds
    buffer_load_dwordx4 v17, s[20:23], s48 offen offset:3072 nt lds
    s_add_u32 s48, s52, 86016
    s_mov_b32 m0, s48
    s_add_u32 s48, s51, 16384
    s_and_b32 s48, s48, 0x3ffff
    s_add_u32 s48, s48, s52
    s_add_u32 s48, s48, 4096
    buffer_load_dwordx4 v17, s[20:23], s48 offen offset:0 nt lds
    buffer_load_dwordx4 v17, s[20:23], s48 offen offset:1024 nt lds
    buffer_load_dwordx4 v17, s[20:23], s48 offen offset:2048 nt lds
    buffer_load_dwordx4 v17, s[20:23], s48 offen offset:3072 nt lds
L_role_17:
    ds_read_b128 a[96:99], v168
    ds_read_b64_tr_b16 v[96:97], v172 offset:0
    ds_read_b64_tr_b16 v[98:99], v172 offset:1024
    ds_read_b64_tr_b16 v[100:101], v173 offset:0
    ds_read_b64_tr_b16 v[102:103], v173 offset:1024
    ds_read_b64_tr_b16 v[104:105], v174 offset:0
    ds_read_b64_tr_b16 v[106:107], v174 offset:1024
    ds_read_b64_tr_b16 v[108:109], v175 offset:0
    ds_read_b64_tr_b16 v[110:111], v175 offset:1024
    ds_read_b128 a[100:103], v169
    ds_read_b64_tr_b16 v[112:113], v172 offset:4096
    ds_read_b64_tr_b16 v[114:115], v172 offset:5120
    ds_read_b64_tr_b16 v[116:117], v173 offset:4096
    ds_read_b64_tr_b16 v[118:119], v173 offset:5120
    s_waitcnt lgkmcnt(11)
    v_mfma_f32_32x32x16_bf16 v[32:47], v[96:99], a[96:99], v[32:47]
    ds_read_b64_tr_b16 v[120:121], v174 offset:4096
    ds_read_b64_tr_b16 v[122:123], v174 offset:5120
    s_waitcnt lgkmcnt(11)
    v_mfma_f32_32x32x16_bf16 v[48:63], v[100:103], a[96:99], v[48:63]
    ds_read_b64_tr_b16 v[124:125], v175 offset:4096
    ds_read_b64_tr_b16 v[126:127], v175 offset:5120
    s_waitcnt lgkmcnt(11)
    v_mfma_f32_32x32x16_bf16 v[64:79], v[104:107], a[96:99], v[64:79]
    ds_read_b128 a[104:107], v170
    ds_read_b64_tr_b16 v[128:129], v172 offset:8192
    ds_read_b64_tr_b16 v[130:131], v172 offset:9216
    s_waitcnt lgkmcnt(12)
    v_mfma_f32_32x32x16_bf16 v[80:95], v[108:111], a[96:99], v[80:95]
    ds_read_b64_tr_b16 v[132:133], v173 offset:8192
    ds_read_b64_tr_b16 v[134:135], v173 offset:9216
    s_waitcnt lgkmcnt(11)
    v_mfma_f32_32x32x16_bf16 v[32:47], v[112:115], a[100:103], v[32:47]
    ds_read_b64_tr_b16 v[136:137], v174 offset:8192
    ds_read_b64_tr_b16 v[138:139], v174 offset:9216
    s_waitcnt lgkmcnt(11)
    v_mfma_f32_32x32x16_bf16 v[48:63], v[116:119], a[100:103], v[48:63]
    ds_read_b64_tr_b16 v[140:141], v175 offset:8192
    ds_read_b64_tr_b16 v[142:143], v175 offset:9216
    s_waitcnt lgkmcnt(11)
    v_mfma_f32_32x32x16_bf16 v[64:79], v[120:123], a[100:103], v[64:79]
    ds_read_b128 a[108:111], v171
    ds_read_b64_tr_b16 v[144:145], v172 offset:12288
    ds_read_b64_tr_b16 v[146:147], v172 offset:13312
    s_waitcnt lgkmcnt(12)
    v_mfma_f32_32x32x16_bf16 v[80:95], v[124:127], a[100:103], v[80:95]
    ds_read_b64_tr_b16 v[148:149], v173 offset:12288
    ds_read_b64_tr_b16 v[150:151], v173 offset:13312
    s_waitcnt lgkmcnt(11)
    v_mfma_f32_32x32x16_bf16 v[32:47], v[128:131], a[104:107], v[32:47]
    ds_read_b64_tr_b16 v[152:153], v174 offset:12288
    ds_read_b64_tr_b16 v[154:155], v174 offset:13312
    s_waitcnt lgkmcnt(11)
    v_mfma_f32_32x32x16_bf16 v[48:63], v[132:135], a[104:107], v[48:63]
    ds_read_b64_tr_b16 v[156:157], v175 offset:12288
    ds_read_b64_tr_b16 v[158:159], v175 offset:13312
    s_waitcnt lgkmcnt(11)
    v_mfma_f32_32x32x16_bf16 v[64:79], v[136:139], a[104:107], v[64:79]
    s_waitcnt lgkmcnt(9)
    v_mfma_f32_32x32x16_bf16 v[80:95], v[140:143], a[104:107], v[80:95]
    s_waitcnt lgkmcnt(6)
    v_mfma_f32_32x32x16_bf16 v[32:47], v[144:147], a[108:111], v[32:47]
    s_waitcnt lgkmcnt(4)
    v_mfma_f32_32x32x16_bf16 v[48:63], v[148:151], a[108:111], v[48:63]
    s_waitcnt lgkmcnt(2)
    v_mfma_f32_32x32x16_bf16 v[64:79], v[152:155], a[108:111], v[64:79]
    s_waitcnt lgkmcnt(0)
    v_mfma_f32_32x32x16_bf16 v[80:95], v[156:159], a[108:111], v[80:95]
    v_add_u32 v168, 131072, v164
    v_add_u32 v172, 147456, v25
    v_add_u32 v169, 131072, v165
    v_add_u32 v173, 147456, v26
    v_add_u32 v170, 131072, v166
    v_add_u32 v174, 147456, v27
    v_add_u32 v171, 131072, v167
    v_add_u32 v175, 147456, v28
    s_cmp_lt_u32 s3, 2
    s_cbranch_scc0 L_role_18
    s_waitcnt vmcnt(0)
L_role_18:
    s_barrier
    ds_read_b128 a[96:99], v168
    ds_read_b64_tr_b16 v[96:97], v172 offset:0
    ds_read_b64_tr_b16 v[98:99], v172 offset:1024
    ds_read_b64_tr_b16 v[100:101], v173 offset:0
    ds_read_b64_tr_b16 v[102:103], v173 offset:1024
    ds_read_b64_tr_b16 v[104:105], v174 offset:0
    ds_read_b64_tr_b16 v[106:107], v174 offset:1024
    ds_read_b64_tr_b16 v[108:109], v175 offset:0
    ds_read_b64_tr_b16 v[110:111], v175 offset:1024
    ds_read_b128 a[100:103], v169
    ds_read_b64_tr_b16 v[112:113], v172 offset:4096
    ds_read_b64_tr_b16 v[114:115], v172 offset:5120
    ds_read_b64_tr_b16 v[116:117], v173 offset:4096
    ds_read_b64_tr_b16 v[118:119], v173 offset:5120
    s_waitcnt lgkmcnt(11)
    v_mfma_f32_32x32x16_bf16 v[32:47], v[96:99], a[96:99], v[32:47]
    ds_read_b64_tr_b16 v[120:121], v174 offset:4096
    ds_read_b64_tr_b16 v[122:123], v174 offset:5120
    s_waitcnt lgkmcnt(11)
    v_mfma_f32_32x32x16_bf16 v[48:63], v[100:103], a[96:99], v[48:63]
    ds_read_b64_tr_b16 v[124:125], v175 offset:4096
    ds_read_b64_tr_b16 v[126:127], v175 offset:5120
    s_waitcnt lgkmcnt(11)
    v_mfma_f32_32x32x16_bf16 v[64:79], v[104:107], a[96:99], v[64:79]
    ds_read_b128 a[104:107], v170
    ds_read_b64_tr_b16 v[128:129], v172 offset:8192
    ds_read_b64_tr_b16 v[130:131], v172 offset:9216
    s_waitcnt lgkmcnt(12)
    v_mfma_f32_32x32x16_bf16 v[80:95], v[108:111], a[96:99], v[80:95]
    ds_read_b64_tr_b16 v[132:133], v173 offset:8192
    ds_read_b64_tr_b16 v[134:135], v173 offset:9216
    s_waitcnt lgkmcnt(11)
    v_mfma_f32_32x32x16_bf16 v[32:47], v[112:115], a[100:103], v[32:47]
    ds_read_b64_tr_b16 v[136:137], v174 offset:8192
    ds_read_b64_tr_b16 v[138:139], v174 offset:9216
    s_waitcnt lgkmcnt(11)
    v_mfma_f32_32x32x16_bf16 v[48:63], v[116:119], a[100:103], v[48:63]
    ds_read_b64_tr_b16 v[140:141], v175 offset:8192
    ds_read_b64_tr_b16 v[142:143], v175 offset:9216
    s_waitcnt lgkmcnt(11)
    v_mfma_f32_32x32x16_bf16 v[64:79], v[120:123], a[100:103], v[64:79]
    ds_read_b128 a[108:111], v171
    ds_read_b64_tr_b16 v[144:145], v172 offset:12288
    ds_read_b64_tr_b16 v[146:147], v172 offset:13312
    s_waitcnt lgkmcnt(12)
    v_mfma_f32_32x32x16_bf16 v[80:95], v[124:127], a[100:103], v[80:95]
    ds_read_b64_tr_b16 v[148:149], v173 offset:12288
    ds_read_b64_tr_b16 v[150:151], v173 offset:13312
    s_waitcnt lgkmcnt(11)
    v_mfma_f32_32x32x16_bf16 v[32:47], v[128:131], a[104:107], v[32:47]
    ds_read_b64_tr_b16 v[152:153], v174 offset:12288
    ds_read_b64_tr_b16 v[154:155], v174 offset:13312
    s_waitcnt lgkmcnt(11)
    v_mfma_f32_32x32x16_bf16 v[48:63], v[132:135], a[104:107], v[48:63]
    ds_read_b64_tr_b16 v[156:157], v175 offset:12288
    ds_read_b64_tr_b16 v[158:159], v175 offset:13312
    s_waitcnt lgkmcnt(11)
    v_mfma_f32_32x32x16_bf16 v[64:79], v[136:139], a[104:107], v[64:79]
    s_waitcnt lgkmcnt(9)
    v_mfma_f32_32x32x16_bf16 v[80:95], v[140:143], a[104:107], v[80:95]
    s_waitcnt lgkmcnt(6)
    v_mfma_f32_32x32x16_bf16 v[32:47], v[144:147], a[108:111], v[32:47]
    s_waitcnt lgkmcnt(4)
    v_mfma_f32_32x32x16_bf16 v[48:63], v[148:151], a[108:111], v[48:63]
    s_waitcnt lgkmcnt(2)
    v_mfma_f32_32x32x16_bf16 v[64:79], v[152:155], a[108:111], v[64:79]
    s_waitcnt lgkmcnt(0)
    v_mfma_f32_32x32x16_bf16 v[80:95], v[156:159], a[108:111], v[80:95]
    s_barrier
    s_lshl_b32 s30, s3, 13
    v_and_b32 v96, 31, v0
    v_lshrrev_b32 v97, 5, v0
    v_and_b32 v22, 15, v96
    v_lshlrev_b32 v23, 8, v96
    v_lshl_add_u32 v23, v97, 3, v23
    v_add_u32 v23, s30, v23
    v_add_u32 v23, 131072, v23
    s_nop 7
    v_cvt_pk_bf16_f32 v160, v32, v33
    v_cvt_pk_bf16_f32 v161, v34, v35
    v_xor_b32 v31, 0, v22
    v_lshl_add_u32 v31, v31, 4, v23
    ds_write_b64 v31, v[160:161]
    v_cvt_pk_bf16_f32 v162, v36, v37
    v_cvt_pk_bf16_f32 v163, v38, v39
    v_xor_b32 v31, 1, v22
    v_lshl_add_u32 v31, v31, 4, v23
    ds_write_b64 v31, v[162:163]
    v_cvt_pk_bf16_f32 v164, v40, v41
    v_cvt_pk_bf16_f32 v165, v42, v43
    v_xor_b32 v31, 2, v22
    v_lshl_add_u32 v31, v31, 4, v23
    ds_write_b64 v31, v[164:165]
    v_cvt_pk_bf16_f32 v166, v44, v45
    v_cvt_pk_bf16_f32 v167, v46, v47
    v_xor_b32 v31, 3, v22
    v_lshl_add_u32 v31, v31, 4, v23
    ds_write_b64 v31, v[166:167]
    v_cvt_pk_bf16_f32 v168, v48, v49
    v_cvt_pk_bf16_f32 v169, v50, v51
    v_xor_b32 v31, 4, v22
    v_lshl_add_u32 v31, v31, 4, v23
    ds_write_b64 v31, v[168:169]
    v_cvt_pk_bf16_f32 v170, v52, v53
    v_cvt_pk_bf16_f32 v171, v54, v55
    v_xor_b32 v31, 5, v22
    v_lshl_add_u32 v31, v31, 4, v23
    ds_write_b64 v31, v[170:171]
    v_cvt_pk_bf16_f32 v172, v56, v57
    v_cvt_pk_bf16_f32 v173, v58, v59
    v_xor_b32 v31, 6, v22
    v_lshl_add_u32 v31, v31, 4, v23
    ds_write_b64 v31, v[172:173]
    v_cvt_pk_bf16_f32 v174, v60, v61
    v_cvt_pk_bf16_f32 v175, v62, v63
    v_xor_b32 v31, 7, v22
    v_lshl_add_u32 v31, v31, 4, v23
    ds_write_b64 v31, v[174:175]
    v_cvt_pk_bf16_f32 v160, v64, v65
    v_cvt_pk_bf16_f32 v161, v66, v67
    v_xor_b32 v31, 8, v22
    v_lshl_add_u32 v31, v31, 4, v23
    ds_write_b64 v31, v[160:161]
    v_cvt_pk_bf16_f32 v162, v68, v69
    v_cvt_pk_bf16_f32 v163, v70, v71
    v_xor_b32 v31, 9, v22
    v_lshl_add_u32 v31, v31, 4, v23
    ds_write_b64 v31, v[162:163]
    v_cvt_pk_bf16_f32 v164, v72, v73
    v_cvt_pk_bf16_f32 v165, v74, v75
    v_xor_b32 v31, 10, v22
    v_lshl_add_u32 v31, v31, 4, v23
    ds_write_b64 v31, v[164:165]
    v_cvt_pk_bf16_f32 v166, v76, v77
    v_cvt_pk_bf16_f32 v167, v78, v79
    v_xor_b32 v31, 11, v22
    v_lshl_add_u32 v31, v31, 4, v23
    ds_write_b64 v31, v[166:167]
    v_cvt_pk_bf16_f32 v168, v80, v81
    v_cvt_pk_bf16_f32 v169, v82, v83
    v_xor_b32 v31, 12, v22
    v_lshl_add_u32 v31, v31, 4, v23
    ds_write_b64 v31, v[168:169]
    v_cvt_pk_bf16_f32 v170, v84, v85
    v_cvt_pk_bf16_f32 v171, v86, v87
    v_xor_b32 v31, 13, v22
    v_lshl_add_u32 v31, v31, 4, v23
    ds_write_b64 v31, v[170:171]
    v_cvt_pk_bf16_f32 v172, v88, v89
    v_cvt_pk_bf16_f32 v173, v90, v91
    v_xor_b32 v31, 14, v22
    v_lshl_add_u32 v31, v31, 4, v23
    ds_write_b64 v31, v[172:173]
    v_cvt_pk_bf16_f32 v174, v92, v93
    v_cvt_pk_bf16_f32 v175, v94, v95
    v_xor_b32 v31, 15, v22
    v_lshl_add_u32 v31, v31, 4, v23
    ds_write_b64 v31, v[174:175]
    s_waitcnt lgkmcnt(0)
    v_lshlrev_b32 v23, 8, v96
    v_add_u32 v23, s30, v23
    v_add_u32 v23, 131072, v23
    v_or_b32 v31, 0, v97
    v_xor_b32 v31, v31, v22
    v_lshl_add_u32 v31, v31, 4, v23
    ds_read_b128 a[0:3], v31
    v_or_b32 v31, 2, v97
    v_xor_b32 v31, v31, v22
    v_lshl_add_u32 v31, v31, 4, v23
    ds_read_b128 a[4:7], v31
    v_or_b32 v31, 4, v97
    v_xor_b32 v31, v31, v22
    v_lshl_add_u32 v31, v31, 4, v23
    ds_read_b128 a[8:11], v31
    v_or_b32 v31, 6, v97
    v_xor_b32 v31, v31, v22
    v_lshl_add_u32 v31, v31, 4, v23
    ds_read_b128 a[12:15], v31
    v_or_b32 v31, 8, v97
    v_xor_b32 v31, v31, v22
    v_lshl_add_u32 v31, v31, 4, v23
    ds_read_b128 a[16:19], v31
    v_or_b32 v31, 10, v97
    v_xor_b32 v31, v31, v22
    v_lshl_add_u32 v31, v31, 4, v23
    ds_read_b128 a[20:23], v31
    v_or_b32 v31, 12, v97
    v_xor_b32 v31, v31, v22
    v_lshl_add_u32 v31, v31, 4, v23
    ds_read_b128 a[24:27], v31
    v_or_b32 v31, 14, v97
    v_xor_b32 v31, v31, v22
    v_lshl_add_u32 v31, v31, 4, v23
    ds_read_b128 a[28:31], v31
    v_mov_b32 v18, 0xff800000
    v_mov_b32 v20, 0
    v_mov_b32 v32, 0
    v_mov_b32 v33, 0
    v_mov_b32 v34, 0
    v_mov_b32 v35, 0
    v_mov_b32 v36, 0
    v_mov_b32 v37, 0
    v_mov_b32 v38, 0
    v_mov_b32 v39, 0
    v_mov_b32 v40, 0
    v_mov_b32 v41, 0
    v_mov_b32 v42, 0
    v_mov_b32 v43, 0
    v_mov_b32 v44, 0
    v_mov_b32 v45, 0
    v_mov_b32 v46, 0
    v_mov_b32 v47, 0
    v_mov_b32 v48, 0
    v_mov_b32 v49, 0
    v_mov_b32 v50, 0
    v_mov_b32 v51, 0
    v_mov_b32 v52, 0
    v_mov_b32 v53, 0
    v_mov_b32 v54, 0
    v_mov_b32 v55, 0
    v_mov_b32 v56, 0
    v_mov_b32 v57, 0
    v_mov_b32 v58, 0
    v_mov_b32 v59, 0
    v_mov_b32 v60, 0
    v_mov_b32 v61, 0
    v_mov_b32 v62, 0
    v_mov_b32 v63, 0
    v_mov_b32 v64, 0
    v_mov_b32 v65, 0
    v_mov_b32 v66, 0
    v_mov_b32 v67, 0
    v_mov_b32 v68, 0
    v_mov_b32 v69, 0
    v_mov_b32 v70, 0
    v_mov_b32 v71, 0
    v_mov_b32 v72, 0
    v_mov_b32 v73, 0
    v_mov_b32 v74, 0
    v_mov_b32 v75, 0
    v_mov_b32 v76, 0
    v_mov_b32 v77, 0
    v_mov_b32 v78, 0
    v_mov_b32 v79, 0
    v_mov_b32 v80, 0
    v_mov_b32 v81, 0
    v_mov_b32 v82, 0
    v_mov_b32 v83, 0
    v_mov_b32 v84, 0
    v_mov_b32 v85, 0
    v_mov_b32 v86, 0
    v_mov_b32 v87, 0
    v_mov_b32 v88, 0
    v_mov_b32 v89, 0
    v_mov_b32 v90, 0
    v_mov_b32 v91, 0
    v_mov_b32 v92, 0
    v_mov_b32 v93, 0
    v_mov_b32 v94, 0
    v_mov_b32 v95, 0
    s_waitcnt lgkmcnt(0)
    s_waitcnt vmcnt(40)
    s_barrier
    ds_read_b128 a[96:99], v1 offset:0
    ds_read_b128 a[100:103], v2 offset:0
    ds_read_b128 a[104:107], v3 offset:0
    ds_read_b128 a[108:111], v4 offset:0
    ds_read_b128 a[112:115], v5 offset:0
    ds_read_b128 a[116:119], v6 offset:0
    s_waitcnt lgkmcnt(5)
    v_mfma_f32_32x32x16_bf16 v[96:111], a[96:99], a[0:3], 0
    ds_read_b128 a[120:123], v7 offset:0
    s_waitcnt lgkmcnt(5)
    v_mfma_f32_32x32x16_bf16 v[96:111], a[100:103], a[4:7], v[96:111]
    ds_read_b128 a[124:127], v8 offset:0
    s_waitcnt lgkmcnt(5)
    v_mfma_f32_32x32x16_bf16 v[96:111], a[104:107], a[8:11], v[96:111]
    ds_read_b128 a[128:131], v1 offset:8192
    s_waitcnt lgkmcnt(5)
    v_mfma_f32_32x32x16_bf16 v[96:111], a[108:111], a[12:15], v[96:111]
    ds_read_b128 a[132:135], v2 offset:8192
    s_waitcnt lgkmcnt(5)
    v_mfma_f32_32x32x16_bf16 v[96:111], a[112:115], a[16:19], v[96:111]
    ds_read_b128 a[136:139], v3 offset:8192
    s_waitcnt lgkmcnt(5)
    v_mfma_f32_32x32x16_bf16 v[96:111], a[116:119], a[20:23], v[96:111]
    ds_read_b128 a[140:143], v4 offset:8192
    s_waitcnt lgkmcnt(5)
    v_mfma_f32_32x32x16_bf16 v[96:111], a[120:123], a[24:27], v[96:111]
    ds_read_b128 a[144:147], v5 offset:8192
    s_waitcnt lgkmcnt(5)
    v_mfma_f32_32x32x16_bf16 v[96:111], a[124:127], a[28:31], v[96:111]
    ds_read_b128 a[148:151], v6 offset:8192
    s_waitcnt lgkmcnt(5)
    v_mfma_f32_32x32x16_bf16 v[112:127], a[128:131], a[0:3], 0
    ds_read_b128 a[152:155], v7 offset:8192
    s_waitcnt lgkmcnt(5)
    v_mfma_f32_32x32x16_bf16 v[112:127], a[132:135], a[4:7], v[112:127]
    ds_read_b128 a[156:159], v8 offset:8192
    s_waitcnt lgkmcnt(5)
    v_mfma_f32_32x32x16_bf16 v[112:127], a[136:139], a[8:11], v[112:127]
    s_waitcnt lgkmcnt(4)
    v_mfma_f32_32x32x16_bf16 v[112:127], a[140:143], a[12:15], v[112:127]
    s_waitcnt lgkmcnt(3)
    v_mfma_f32_32x32x16_bf16 v[112:127], a[144:147], a[16:19], v[112:127]
    s_waitcnt lgkmcnt(2)
    v_mfma_f32_32x32x16_bf16 v[112:127], a[148:151], a[20:23], v[112:127]
    s_waitcnt lgkmcnt(1)
    v_mfma_f32_32x32x16_bf16 v[112:127], a[152:155], a[24:27], v[112:127]
    s_waitcnt lgkmcnt(0)
    v_mfma_f32_32x32x16_bf16 v[112:127], a[156:159], a[28:31], v[112:127]
    s_nop 7
    s_waitcnt vmcnt(32)
    s_barrier
    s_cmp_lt_u32 s3, 2
    s_cbranch_scc1 L_role_19
    s_add_u32 s48, s52, 0
    s_mov_b32 m0, s48
    s_add_u32 s48, s51, 65536
    s_and_b32 s48, s48, 0x3ffff
    s_add_u32 s48, s48, s52
    buffer_load_dwordx4 v13, s[16:19], s48 offen offset:0 nt lds
    buffer_load_dwordx4 v14, s[16:19], s48 offen offset:1024 nt lds
    buffer_load_dwordx4 v15, s[16:19], s48 offen offset:2048 nt lds
    buffer_load_dwordx4 v16, s[16:19], s48 offen offset:3072 nt lds
    s_add_u32 s48, s52, 4096
    s_mov_b32 m0, s48
    s_add_u32 s48, s51, 65536
    s_and_b32 s48, s48, 0x3ffff
    s_add_u32 s48, s48, s52
    s_add_u32 s48, s48, 4096
    buffer_load_dwordx4 v13, s[16:19], s48 offen offset:0 nt lds
    buffer_load_dwordx4 v14, s[16:19], s48 offen offset:1024 nt lds
    buffer_load_dwordx4 v15, s[16:19], s48 offen offset:2048 nt lds
    buffer_load_dwordx4 v16, s[16:19], s48 offen offset:3072 nt lds
    s_add_u32 s48, s52, 98304
    s_mov_b32 m0, s48
    s_add_u32 s48, s51, 32768
    s_and_b32 s48, s48, 0x3ffff
    s_add_u32 s48, s48, s52
    buffer_load_dwordx4 v17, s[20:23], s48 offen offset:0 nt lds
    buffer_load_dwordx4 v17, s[20:23], s48 offen offset:1024 nt lds
    buffer_load_dwordx4 v17, s[20:23], s48 offen offset:2048 nt lds
    buffer_load_dwordx4 v17, s[20:23], s48 offen offset:3072 nt lds
    s_add_u32 s48, s52, 102400
    s_mov_b32 m0, s48
    s_add_u32 s48, s51, 32768
    s_and_b32 s48, s48, 0x3ffff
    s_add_u32 s48, s48, s52
    s_add_u32 s48, s48, 4096
    buffer_load_dwordx4 v17, s[20:23], s48 offen offset:0 nt lds
    buffer_load_dwordx4 v17, s[20:23], s48 offen offset:1024 nt lds
    buffer_load_dwordx4 v17, s[20:23], s48 offen offset:2048 nt lds
    buffer_load_dwordx4 v17, s[20:23], s48 offen offset:3072 nt lds
L_role_19:
    ds_read_b128 a[96:99], v1 offset:16384
    ds_read_b128 a[100:103], v2 offset:16384
    ds_read_b128 a[104:107], v3 offset:16384
    ds_read_b128 a[108:111], v4 offset:16384
    ds_read_b128 a[112:115], v5 offset:16384
    ds_read_b128 a[116:119], v6 offset:16384
    s_waitcnt lgkmcnt(5)
    v_mfma_f32_32x32x16_bf16 v[128:143], a[96:99], a[0:3], 0
    v_max3_f32 v22, v96, v97, v98
    v_max3_f32 v23, v99, v100, v101
    v_max3_f32 v22, v22, v102, v103
    v_max3_f32 v23, v23, v104, v105
    v_max3_f32 v22, v22, v106, v107
    v_max3_f32 v23, v23, v108, v109
    v_max3_f32 v22, v22, v110, v111
    v_max3_f32 v23, v23, v112, v113
    v_max3_f32 v22, v22, v114, v115
    v_max3_f32 v23, v23, v116, v117
    v_max3_f32 v22, v22, v118, v119
    v_max3_f32 v23, v23, v120, v121
    v_max3_f32 v22, v22, v122, v123
    ds_read_b128 a[120:123], v7 offset:16384
    s_waitcnt lgkmcnt(5)
    v_mfma_f32_32x32x16_bf16 v[128:143], a[100:103], a[4:7], v[128:143]
    v_max3_f32 v23, v23, v124, v125
    v_max3_f32 v22, v22, v126, v127
    v_max_f32 v22, v22, v23
    v_mov_b32 v23, v22
    s_nop 1
    v_permlane32_swap_b32 v22, v23
    s_nop 1
    v_max3_f32 v19, v18, v22, v23
    v_sub_f32 v22, v18, v19
    v_mul_f32 v24, s50, v19
    v_mul_f32 v22, s49, v22
    v_mov_b32 v18, v19
    v_exp_f32 v21, v22
    ds_read_b128 a[124:127], v8 offset:16384
    s_waitcnt lgkmcnt(5)
    v_mfma_f32_32x32x16_bf16 v[128:143], a[104:107], a[8:11], v[128:143]
    v_fma_f32 v96, v96, s49, v24
    v_fma_f32 v97, v97, s49, v24
    v_exp_f32 v96, v96
    v_fma_f32 v98, v98, s49, v24
    v_exp_f32 v97, v97
    v_fma_f32 v99, v99, s49, v24
    v_exp_f32 v98, v98
    v_fma_f32 v100, v100, s49, v24
    v_exp_f32 v99, v99
    v_fma_f32 v101, v101, s49, v24
    v_exp_f32 v100, v100
    v_fma_f32 v102, v102, s49, v24
    v_exp_f32 v101, v101
    ds_read_b128 a[128:131], v1 offset:24576
    s_waitcnt lgkmcnt(5)
    v_mfma_f32_32x32x16_bf16 v[128:143], a[108:111], a[12:15], v[128:143]
    v_fma_f32 v103, v103, s49, v24
    v_exp_f32 v102, v102
    v_fma_f32 v104, v104, s49, v24
    v_exp_f32 v103, v103
    v_fma_f32 v105, v105, s49, v24
    v_exp_f32 v104, v104
    v_fma_f32 v106, v106, s49, v24
    v_exp_f32 v105, v105
    v_fma_f32 v107, v107, s49, v24
    v_exp_f32 v106, v106
    v_fma_f32 v108, v108, s49, v24
    v_exp_f32 v107, v107
    v_fma_f32 v109, v109, s49, v24
    ds_read_b128 a[132:135], v2 offset:24576
    s_waitcnt lgkmcnt(5)
    v_mfma_f32_32x32x16_bf16 v[128:143], a[112:115], a[16:19], v[128:143]
    v_exp_f32 v108, v108
    v_fma_f32 v110, v110, s49, v24
    v_exp_f32 v109, v109
    v_fma_f32 v111, v111, s49, v24
    v_exp_f32 v110, v110
    v_fma_f32 v112, v112, s49, v24
    v_exp_f32 v111, v111
    v_fma_f32 v113, v113, s49, v24
    v_exp_f32 v112, v112
    v_fma_f32 v114, v114, s49, v24
    v_exp_f32 v113, v113
    v_fma_f32 v115, v115, s49, v24
    v_exp_f32 v114, v114
    ds_read_b128 a[136:139], v3 offset:24576
    s_waitcnt lgkmcnt(5)
    v_mfma_f32_32x32x16_bf16 v[128:143], a[116:119], a[20:23], v[128:143]
    v_fma_f32 v116, v116, s49, v24
    v_exp_f32 v115, v115
    v_fma_f32 v117, v117, s49, v24
    v_exp_f32 v116, v116
    v_fma_f32 v118, v118, s49, v24
    v_exp_f32 v117, v117
    v_fma_f32 v119, v119, s49, v24
    v_exp_f32 v118, v118
    v_fma_f32 v120, v120, s49, v24
    v_exp_f32 v119, v119
    v_fma_f32 v121, v121, s49, v24
    v_exp_f32 v120, v120
    v_fma_f32 v122, v122, s49, v24
    ds_read_b128 a[140:143], v4 offset:24576
    s_waitcnt lgkmcnt(5)
    v_mfma_f32_32x32x16_bf16 v[128:143], a[120:123], a[24:27], v[128:143]
    v_exp_f32 v121, v121
    v_fma_f32 v123, v123, s49, v24
    v_exp_f32 v122, v122
    v_fma_f32 v124, v124, s49, v24
    v_exp_f32 v123, v123
    v_fma_f32 v125, v125, s49, v24
    v_exp_f32 v124, v124
    v_fma_f32 v126, v126, s49, v24
    v_exp_f32 v125, v125
    v_fma_f32 v127, v127, s49, v24
    v_exp_f32 v126, v126
    v_exp_f32 v127, v127
    v_mul_f32 v20, v20, v21
    ds_read_b128 a[144:147], v5 offset:24576
    s_waitcnt lgkmcnt(5)
    v_mfma_f32_32x32x16_bf16 v[128:143], a[124:127], a[28:31], v[128:143]
    v_add_f32 v22, v96, v97
    v_add_f32 v23, v98, v99
    v_add_f32 v22, v22, v100
    v_add_f32 v23, v23, v101
    v_add_f32 v22, v22, v102
    v_add_f32 v23, v23, v103
    v_add_f32 v22, v22, v104
    v_add_f32 v23, v23, v105
    v_add_f32 v22, v22, v106
    v_add_f32 v23, v23, v107
    v_add_f32 v22, v22, v108
    v_add_f32 v23, v23, v109
    v_add_f32 v22, v22, v110
    ds_read_b128 a[148:151], v6 offset:24576
    s_waitcnt lgkmcnt(5)
    v_mfma_f32_32x32x16_bf16 v[144:159], a[128:131], a[0:3], 0
    v_add_f32 v23, v23, v111
    v_add_f32 v22, v22, v112
    v_add_f32 v23, v23, v113
    v_add_f32 v22, v22, v114
    v_add_f32 v23, v23, v115
    v_add_f32 v22, v22, v116
    v_add_f32 v23, v23, v117
    v_add_f32 v22, v22, v118
    v_add_f32 v23, v23, v119
    v_add_f32 v22, v22, v120
    v_add_f32 v23, v23, v121
    v_add_f32 v22, v22, v122
    v_add_f32 v23, v23, v123
    ds_read_b128 a[152:155], v7 offset:24576
    s_waitcnt lgkmcnt(5)
    v_mfma_f32_32x32x16_bf16 v[144:159], a[132:135], a[4:7], v[144:159]
    v_add_f32 v22, v22, v124
    v_add_f32 v23, v23, v125
    v_add_f32 v22, v22, v126
    v_add_f32 v23, v23, v127
    v_add_f32 v22, v22, v23
    v_add_f32 v20, v20, v22
    v_cvt_pk_bf16_f32 v160, v96, v97
    v_cvt_pk_bf16_f32 v161, v98, v99
    v_cvt_pk_bf16_f32 v162, v100, v101
    v_cvt_pk_bf16_f32 v163, v102, v103
    v_cvt_pk_bf16_f32 v164, v104, v105
    v_cvt_pk_bf16_f32 v165, v106, v107
    v_cvt_pk_bf16_f32 v166, v108, v109
    ds_read_b128 a[156:159], v8 offset:24576
    s_waitcnt lgkmcnt(5)
    v_mfma_f32_32x32x16_bf16 v[144:159], a[136:139], a[8:11], v[144:159]
    v_cvt_pk_bf16_f32 v167, v110, v111
    v_cvt_pk_bf16_f32 v168, v112, v113
    v_cvt_pk_bf16_f32 v169, v114, v115
    v_cvt_pk_bf16_f32 v170, v116, v117
    v_cvt_pk_bf16_f32 v171, v118, v119
    v_cvt_pk_bf16_f32 v172, v120, v121
    v_cvt_pk_bf16_f32 v173, v122, v123
    v_cvt_pk_bf16_f32 v174, v124, v125
    v_cvt_pk_bf16_f32 v175, v126, v127
    v_mul_f32 v32, v32, v21
    v_mul_f32 v33, v33, v21
    v_mul_f32 v34, v34, v21
    v_mul_f32 v35, v35, v21
    s_waitcnt lgkmcnt(4)
    v_mfma_f32_32x32x16_bf16 v[144:159], a[140:143], a[12:15], v[144:159]
    v_mul_f32 v36, v36, v21
    v_mul_f32 v37, v37, v21
    v_mul_f32 v38, v38, v21
    v_mul_f32 v39, v39, v21
    v_mul_f32 v40, v40, v21
    v_mul_f32 v41, v41, v21
    v_mul_f32 v42, v42, v21
    v_mul_f32 v43, v43, v21
    v_mul_f32 v44, v44, v21
    v_mul_f32 v45, v45, v21
    v_mul_f32 v46, v46, v21
    v_mul_f32 v47, v47, v21
    v_mul_f32 v48, v48, v21
    s_waitcnt lgkmcnt(3)
    v_mfma_f32_32x32x16_bf16 v[144:159], a[144:147], a[16:19], v[144:159]
    v_mul_f32 v49, v49, v21
    v_mul_f32 v50, v50, v21
    v_mul_f32 v51, v51, v21
    v_mul_f32 v52, v52, v21
    v_mul_f32 v53, v53, v21
    v_mul_f32 v54, v54, v21
    v_mul_f32 v55, v55, v21
    v_mul_f32 v56, v56, v21
    v_mul_f32 v57, v57, v21
    v_mul_f32 v58, v58, v21
    v_mul_f32 v59, v59, v21
    v_mul_f32 v60, v60, v21
    v_mul_f32 v61, v61, v21
    s_waitcnt lgkmcnt(2)
    v_mfma_f32_32x32x16_bf16 v[144:159], a[148:151], a[20:23], v[144:159]
    v_mul_f32 v62, v62, v21
    v_mul_f32 v63, v63, v21
    v_mul_f32 v64, v64, v21
    v_mul_f32 v65, v65, v21
    v_mul_f32 v66, v66, v21
    v_mul_f32 v67, v67, v21
    v_mul_f32 v68, v68, v21
    v_mul_f32 v69, v69, v21
    v_mul_f32 v70, v70, v21
    v_mul_f32 v71, v71, v21
    v_mul_f32 v72, v72, v21
    v_mul_f32 v73, v73, v21
    v_mul_f32 v74, v74, v21
    s_waitcnt lgkmcnt(1)
    v_mfma_f32_32x32x16_bf16 v[144:159], a[152:155], a[24:27], v[144:159]
    v_mul_f32 v75, v75, v21
    v_mul_f32 v76, v76, v21
    v_mul_f32 v77, v77, v21
    v_mul_f32 v78, v78, v21
    v_mul_f32 v79, v79, v21
    v_mul_f32 v80, v80, v21
    v_mul_f32 v81, v81, v21
    v_mul_f32 v82, v82, v21
    v_mul_f32 v83, v83, v21
    v_mul_f32 v84, v84, v21
    v_mul_f32 v85, v85, v21
    v_mul_f32 v86, v86, v21
    v_mul_f32 v87, v87, v21
    s_waitcnt lgkmcnt(0)
    v_mfma_f32_32x32x16_bf16 v[144:159], a[156:159], a[28:31], v[144:159]
    v_mul_f32 v88, v88, v21
    v_mul_f32 v89, v89, v21
    v_mul_f32 v90, v90, v21
    v_mul_f32 v91, v91, v21
    v_mul_f32 v92, v92, v21
    v_mul_f32 v93, v93, v21
    v_mul_f32 v94, v94, v21
    v_mul_f32 v95, v95, v21
    s_waitcnt vmcnt(32)
    s_barrier
    s_cmp_lt_u32 s3, 2
    s_cbranch_scc1 L_role_20
    s_add_u32 s48, s52, 16384
    s_mov_b32 m0, s48
    s_add_u32 s48, s51, 81920
    s_and_b32 s48, s48, 0x3ffff
    s_add_u32 s48, s48, s52
    buffer_load_dwordx4 v13, s[16:19], s48 offen offset:0 nt lds
    buffer_load_dwordx4 v14, s[16:19], s48 offen offset:1024 nt lds
    buffer_load_dwordx4 v15, s[16:19], s48 offen offset:2048 nt lds
    buffer_load_dwordx4 v16, s[16:19], s48 offen offset:3072 nt lds
    s_add_u32 s48, s52, 20480
    s_mov_b32 m0, s48
    s_add_u32 s48, s51, 81920
    s_and_b32 s48, s48, 0x3ffff
    s_add_u32 s48, s48, s52
    s_add_u32 s48, s48, 4096
    buffer_load_dwordx4 v13, s[16:19], s48 offen offset:0 nt lds
    buffer_load_dwordx4 v14, s[16:19], s48 offen offset:1024 nt lds
    buffer_load_dwordx4 v15, s[16:19], s48 offen offset:2048 nt lds
    buffer_load_dwordx4 v16, s[16:19], s48 offen offset:3072 nt lds
    s_add_u32 s48, s52, 114688
    s_mov_b32 m0, s48
    s_add_u32 s48, s51, 49152
    s_and_b32 s48, s48, 0x3ffff
    s_add_u32 s48, s48, s52
    buffer_load_dwordx4 v17, s[20:23], s48 offen offset:0 nt lds
    buffer_load_dwordx4 v17, s[20:23], s48 offen offset:1024 nt lds
    buffer_load_dwordx4 v17, s[20:23], s48 offen offset:2048 nt lds
    buffer_load_dwordx4 v17, s[20:23], s48 offen offset:3072 nt lds
    s_add_u32 s48, s52, 118784
    s_mov_b32 m0, s48
    s_add_u32 s48, s51, 49152
    s_and_b32 s48, s48, 0x3ffff
    s_add_u32 s48, s48, s52
    s_add_u32 s48, s48, 4096
    buffer_load_dwordx4 v17, s[20:23], s48 offen offset:0 nt lds
    buffer_load_dwordx4 v17, s[20:23], s48 offen offset:1024 nt lds
    buffer_load_dwordx4 v17, s[20:23], s48 offen offset:2048 nt lds
    buffer_load_dwordx4 v17, s[20:23], s48 offen offset:3072 nt lds
L_role_20:
    ds_read_b64_tr_b16 a[32:33], v9 offset:0
    ds_read_b64_tr_b16 a[34:35], v9 offset:2048
    ds_read_b64_tr_b16 a[36:37], v10 offset:0
    ds_read_b64_tr_b16 a[38:39], v10 offset:2048
    ds_read_b64_tr_b16 a[40:41], v11 offset:0
    ds_read_b64_tr_b16 a[42:43], v11 offset:2048
    ds_read_b64_tr_b16 a[44:45], v12 offset:0
    ds_read_b64_tr_b16 a[46:47], v12 offset:2048
    ds_read_b64_tr_b16 a[48:49], v9 offset:4096
    ds_read_b64_tr_b16 a[50:51], v9 offset:6144
    ds_read_b64_tr_b16 a[52:53], v10 offset:4096
    ds_read_b64_tr_b16 a[54:55], v10 offset:6144
    s_waitcnt lgkmcnt(10)
    v_mfma_f32_32x32x16_bf16 v[32:47], a[32:35], v[160:163], v[32:47]
    v_max3_f32 v22, v128, v129, v130
    v_max3_f32 v23, v131, v132, v133
    v_max3_f32 v22, v22, v134, v135
    v_max3_f32 v23, v23, v136, v137
    v_max3_f32 v22, v22, v138, v139
    v_max3_f32 v23, v23, v140, v141
    v_max3_f32 v22, v22, v142, v143
    ds_read_b64_tr_b16 a[56:57], v11 offset:4096
    ds_read_b64_tr_b16 a[58:59], v11 offset:6144
    s_waitcnt lgkmcnt(10)
    v_mfma_f32_32x32x16_bf16 v[48:63], a[36:39], v[160:163], v[48:63]
    v_max3_f32 v23, v23, v144, v145
    v_max3_f32 v22, v22, v146, v147
    v_max3_f32 v23, v23, v148, v149
    v_max3_f32 v22, v22, v150, v151
    v_max3_f32 v23, v23, v152, v153
    v_max3_f32 v22, v22, v154, v155
    v_max3_f32 v23, v23, v156, v157
    ds_read_b64_tr_b16 a[60:61], v12 offset:4096
    ds_read_b64_tr_b16 a[62:63], v12 offset:6144
    s_waitcnt lgkmcnt(10)
    v_mfma_f32_32x32x16_bf16 v[64:79], a[40:43], v[160:163], v[64:79]
    v_max3_f32 v22, v22, v158, v159
    v_max_f32 v22, v22, v23
    v_mov_b32 v23, v22
    s_nop 1
    v_permlane32_swap_b32 v22, v23
    s_nop 1
    v_max3_f32 v19, v18, v22, v23
    ds_read_b64_tr_b16 a[64:65], v9 offset:8192
    ds_read_b64_tr_b16 a[66:67], v9 offset:10240
    s_waitcnt lgkmcnt(10)
    v_mfma_f32_32x32x16_bf16 v[80:95], a[44:47], v[160:163], v[80:95]
    v_sub_f32 v22, v18, v19
    v_mul_f32 v24, s50, v19
    v_mul_f32 v22, s49, v22
    v_mov_b32 v18, v19
    v_exp_f32 v21, v22
    v_fma_f32 v128, v128, s49, v24
    v_fma_f32 v129, v129, s49, v24
    ds_read_b64_tr_b16 a[68:69], v10 offset:8192
    ds_read_b64_tr_b16 a[70:71], v10 offset:10240
    s_waitcnt lgkmcnt(10)
    v_mfma_f32_32x32x16_bf16 v[32:47], a[48:51], v[164:167], v[32:47]
    v_exp_f32 v128, v128
    v_fma_f32 v130, v130, s49, v24
    v_exp_f32 v129, v129
    v_fma_f32 v131, v131, s49, v24
    v_exp_f32 v130, v130
    v_fma_f32 v132, v132, s49, v24
    v_exp_f32 v131, v131
    ds_read_b64_tr_b16 a[72:73], v11 offset:8192
    ds_read_b64_tr_b16 a[74:75], v11 offset:10240
    s_waitcnt lgkmcnt(10)
    v_mfma_f32_32x32x16_bf16 v[48:63], a[52:55], v[164:167], v[48:63]
    v_fma_f32 v133, v133, s49, v24
    v_exp_f32 v132, v132
    v_fma_f32 v134, v134, s49, v24
    v_exp_f32 v133, v133
    v_fma_f32 v135, v135, s49, v24
    v_exp_f32 v134, v134
    v_fma_f32 v136, v136, s49, v24
    ds_read_b64_tr_b16 a[76:77], v12 offset:8192
    ds_read_b64_tr_b16 a[78:79], v12 offset:10240
    s_waitcnt lgkmcnt(10)
    v_mfma_f32_32x32x16_bf16 v[64:79], a[56:59], v[164:167], v[64:79]
    v_exp_f32 v135, v135
    v_fma_f32 v137, v137, s49, v24
    v_exp_f32 v136, v136
    v_fma_f32 v138, v138, s49, v24
    v_exp_f32 v137, v137
    v_fma_f32 v139, v139, s49, v24
    v_exp_f32 v138, v138
    ds_read_b64_tr_b16 a[80:81], v9 offset:12288
    ds_read_b64_tr_b16 a[82:83], v9 offset:14336
    s_waitcnt lgkmcnt(10)
    v_mfma_f32_32x32x16_bf16 v[80:95], a[60:63], v[164:167], v[80:95]
    v_fma_f32 v140, v140, s49, v24
    v_exp_f32 v139, v139
    v_fma_f32 v141, v141, s49, v24
    v_exp_f32 v140, v140
    v_fma_f32 v142, v142, s49, v24
    v_exp_f32 v141, v141
    v_fma_f32 v143, v143, s49, v24
    ds_read_b64_tr_b16 a[84:85], v10 offset:12288
    ds_read_b64_tr_b16 a[86:87], v10 offset:14336
    s_waitcnt lgkmcnt(10)
    v_mfma_f32_32x32x16_bf16 v[32:47], a[64:67], v[168:171], v[32:47]
    v_exp_f32 v142, v142
    v_fma_f32 v144, v144, s49, v24
    v_exp_f32 v143, v143
    v_fma_f32 v145, v145, s49, v24
    v_exp_f32 v144, v144
    v_fma_f32 v146, v146, s49, v24
    v_exp_f32 v145, v145
    ds_read_b64_tr_b16 a[88:89], v11 offset:12288
    ds_read_b64_tr_b16 a[90:91], v11 offset:14336
    s_waitcnt lgkmcnt(10)
    v_mfma_f32_32x32x16_bf16 v[48:63], a[68:71], v[168:171], v[48:63]
    v_fma_f32 v147, v147, s49, v24
    v_exp_f32 v146, v146
    v_fma_f32 v148, v148, s49, v24
    v_exp_f32 v147, v147
    v_fma_f32 v149, v149, s49, v24
    v_exp_f32 v148, v148
    v_fma_f32 v150, v150, s49, v24
    ds_read_b64_tr_b16 a[92:93], v12 offset:12288
    ds_read_b64_tr_b16 a[94:95], v12 offset:14336
    s_waitcnt lgkmcnt(10)
    v_mfma_f32_32x32x16_bf16 v[64:79], a[72:75], v[168:171], v[64:79]
    v_exp_f32 v149, v149
    v_fma_f32 v151, v151, s49, v24
    v_exp_f32 v150, v150
    v_fma_f32 v152, v152, s49, v24
    v_exp_f32 v151, v151
    v_fma_f32 v153, v153, s49, v24
    v_exp_f32 v152, v152
    ds_read_b128 a[96:99], v1 offset:32768
    s_waitcnt lgkmcnt(9)
    v_mfma_f32_32x32x16_bf16 v[80:95], a[76:79], v[168:171], v[80:95]
    v_fma_f32 v154, v154, s49, v24
    v_exp_f32 v153, v153
    v_fma_f32 v155, v155, s49, v24
    v_exp_f32 v154, v154
    v_fma_f32 v156, v156, s49, v24
    v_exp_f32 v155, v155
    v_fma_f32 v157, v157, s49, v24
    ds_read_b128 a[100:103], v2 offset:32768
    s_waitcnt lgkmcnt(8)
    v_mfma_f32_32x32x16_bf16 v[32:47], a[80:83], v[172:175], v[32:47]
    v_exp_f32 v156, v156
    v_fma_f32 v158, v158, s49, v24
    v_exp_f32 v157, v157
    v_fma_f32 v159, v159, s49, v24
    v_exp_f32 v158, v158
    v_exp_f32 v159, v159
    v_mul_f32 v20, v20, v21
    ds_read_b128 a[104:107], v3 offset:32768
    s_waitcnt lgkmcnt(7)
    v_mfma_f32_32x32x16_bf16 v[48:63], a[84:87], v[172:175], v[48:63]
    v_add_f32 v22, v128, v129
    v_add_f32 v23, v130, v131
    v_add_f32 v22, v22, v132
    v_add_f32 v23, v23, v133
    v_add_f32 v22, v22, v134
    v_add_f32 v23, v23, v135
    v_add_f32 v22, v22, v136
    ds_read_b128 a[108:111], v4 offset:32768
    s_waitcnt lgkmcnt(6)
    v_mfma_f32_32x32x16_bf16 v[64:79], a[88:91], v[172:175], v[64:79]
    v_add_f32 v23, v23, v137
    v_add_f32 v22, v22, v138
    v_add_f32 v23, v23, v139
    v_add_f32 v22, v22, v140
    v_add_f32 v23, v23, v141
    v_add_f32 v22, v22, v142
    v_add_f32 v23, v23, v143
    ds_read_b128 a[112:115], v5 offset:32768
    s_waitcnt lgkmcnt(5)
    v_mfma_f32_32x32x16_bf16 v[80:95], a[92:95], v[172:175], v[80:95]
    v_add_f32 v22, v22, v144
    v_add_f32 v23, v23, v145
    v_add_f32 v22, v22, v146
    v_add_f32 v23, v23, v147
    v_add_f32 v22, v22, v148
    v_add_f32 v23, v23, v149
    v_add_f32 v22, v22, v150
    ds_read_b128 a[116:119], v6 offset:32768
    s_waitcnt lgkmcnt(5)
    v_mfma_f32_32x32x16_bf16 v[96:111], a[96:99], a[0:3], 0
    v_add_f32 v23, v23, v151
    v_add_f32 v22, v22, v152
    v_add_f32 v23, v23, v153
    v_add_f32 v22, v22, v154
    v_add_f32 v23, v23, v155
    v_add_f32 v22, v22, v156
    v_add_f32 v23, v23, v157
    ds_read_b128 a[120:123], v7 offset:32768
    s_waitcnt lgkmcnt(5)
    v_mfma_f32_32x32x16_bf16 v[96:111], a[100:103], a[4:7], v[96:111]
    v_add_f32 v22, v22, v158
    v_add_f32 v23, v23, v159
    v_add_f32 v22, v22, v23
    v_add_f32 v20, v20, v22
    v_cvt_pk_bf16_f32 v160, v128, v129
    v_cvt_pk_bf16_f32 v161, v130, v131
    v_cvt_pk_bf16_f32 v162, v132, v133
    ds_read_b128 a[124:127], v8 offset:32768
    s_waitcnt lgkmcnt(5)
    v_mfma_f32_32x32x16_bf16 v[96:111], a[104:107], a[8:11], v[96:111]
    v_cvt_pk_bf16_f32 v163, v134, v135
    v_cvt_pk_bf16_f32 v164, v136, v137
    v_cvt_pk_bf16_f32 v165, v138, v139
    v_cvt_pk_bf16_f32 v166, v140, v141
    v_cvt_pk_bf16_f32 v167, v142, v143
    v_cvt_pk_bf16_f32 v168, v144, v145
    v_cvt_pk_bf16_f32 v169, v146, v147
    ds_read_b128 a[128:131], v1 offset:40960
    s_waitcnt lgkmcnt(5)
    v_mfma_f32_32x32x16_bf16 v[96:111], a[108:111], a[12:15], v[96:111]
    v_cvt_pk_bf16_f32 v170, v148, v149
    v_cvt_pk_bf16_f32 v171, v150, v151
    v_cvt_pk_bf16_f32 v172, v152, v153
    v_cvt_pk_bf16_f32 v173, v154, v155
    v_cvt_pk_bf16_f32 v174, v156, v157
    v_cvt_pk_bf16_f32 v175, v158, v159
    v_mul_f32 v32, v32, v21
    ds_read_b128 a[132:135], v2 offset:40960
    s_waitcnt lgkmcnt(5)
    v_mfma_f32_32x32x16_bf16 v[96:111], a[112:115], a[16:19], v[96:111]
    v_mul_f32 v33, v33, v21
    v_mul_f32 v34, v34, v21
    v_mul_f32 v35, v35, v21
    v_mul_f32 v36, v36, v21
    v_mul_f32 v37, v37, v21
    v_mul_f32 v38, v38, v21
    v_mul_f32 v39, v39, v21
    ds_read_b128 a[136:139], v3 offset:40960
    s_waitcnt lgkmcnt(5)
    v_mfma_f32_32x32x16_bf16 v[96:111], a[116:119], a[20:23], v[96:111]
    v_mul_f32 v40, v40, v21
    v_mul_f32 v41, v41, v21
    v_mul_f32 v42, v42, v21
    v_mul_f32 v43, v43, v21
    v_mul_f32 v44, v44, v21
    v_mul_f32 v45, v45, v21
    v_mul_f32 v46, v46, v21
    ds_read_b128 a[140:143], v4 offset:40960
    s_waitcnt lgkmcnt(5)
    v_mfma_f32_32x32x16_bf16 v[96:111], a[120:123], a[24:27], v[96:111]
    v_mul_f32 v47, v47, v21
    v_mul_f32 v48, v48, v21
    v_mul_f32 v49, v49, v21
    v_mul_f32 v50, v50, v21
    v_mul_f32 v51, v51, v21
    v_mul_f32 v52, v52, v21
    v_mul_f32 v53, v53, v21
    ds_read_b128 a[144:147], v5 offset:40960
    s_waitcnt lgkmcnt(5)
    v_mfma_f32_32x32x16_bf16 v[96:111], a[124:127], a[28:31], v[96:111]
    v_mul_f32 v54, v54, v21
    v_mul_f32 v55, v55, v21
    v_mul_f32 v56, v56, v21
    v_mul_f32 v57, v57, v21
    v_mul_f32 v58, v58, v21
    v_mul_f32 v59, v59, v21
    v_mul_f32 v60, v60, v21
    ds_read_b128 a[148:151], v6 offset:40960
    s_waitcnt lgkmcnt(5)
    v_mfma_f32_32x32x16_bf16 v[112:127], a[128:131], a[0:3], 0
    v_mul_f32 v61, v61, v21
    v_mul_f32 v62, v62, v21
    v_mul_f32 v63, v63, v21
    v_mul_f32 v64, v64, v21
    v_mul_f32 v65, v65, v21
    v_mul_f32 v66, v66, v21
    v_mul_f32 v67, v67, v21
    ds_read_b128 a[152:155], v7 offset:40960
    s_waitcnt lgkmcnt(5)
    v_mfma_f32_32x32x16_bf16 v[112:127], a[132:135], a[4:7], v[112:127]
    v_mul_f32 v68, v68, v21
    v_mul_f32 v69, v69, v21
    v_mul_f32 v70, v70, v21
    v_mul_f32 v71, v71, v21
    v_mul_f32 v72, v72, v21
    v_mul_f32 v73, v73, v21
    v_mul_f32 v74, v74, v21
    ds_read_b128 a[156:159], v8 offset:40960
    s_waitcnt lgkmcnt(5)
    v_mfma_f32_32x32x16_bf16 v[112:127], a[136:139], a[8:11], v[112:127]
    v_mul_f32 v75, v75, v21
    v_mul_f32 v76, v76, v21
    v_mul_f32 v77, v77, v21
    v_mul_f32 v78, v78, v21
    v_mul_f32 v79, v79, v21
    v_mul_f32 v80, v80, v21
    v_mul_f32 v81, v81, v21
    s_waitcnt lgkmcnt(4)
    v_mfma_f32_32x32x16_bf16 v[112:127], a[140:143], a[12:15], v[112:127]
    v_mul_f32 v82, v82, v21
    v_mul_f32 v83, v83, v21
    v_mul_f32 v84, v84, v21
    v_mul_f32 v85, v85, v21
    v_mul_f32 v86, v86, v21
    v_mul_f32 v87, v87, v21
    v_mul_f32 v88, v88, v21
    s_waitcnt lgkmcnt(3)
    v_mfma_f32_32x32x16_bf16 v[112:127], a[144:147], a[16:19], v[112:127]
    v_mul_f32 v89, v89, v21
    v_mul_f32 v90, v90, v21
    v_mul_f32 v91, v91, v21
    v_mul_f32 v92, v92, v21
    v_mul_f32 v93, v93, v21
    v_mul_f32 v94, v94, v21
    v_mul_f32 v95, v95, v21
    s_waitcnt lgkmcnt(2)
    v_mfma_f32_32x32x16_bf16 v[112:127], a[148:151], a[20:23], v[112:127]
    s_waitcnt lgkmcnt(1)
    v_mfma_f32_32x32x16_bf16 v[112:127], a[152:155], a[24:27], v[112:127]
    s_waitcnt lgkmcnt(0)
    v_mfma_f32_32x32x16_bf16 v[112:127], a[156:159], a[28:31], v[112:127]
    s_waitcnt vmcnt(32)
    s_barrier
    s_cmp_lt_u32 s3, 2
    s_cbranch_scc1 L_role_21
    s_add_u32 s48, s52, 32768
    s_mov_b32 m0, s48
    s_add_u32 s48, s51, 98304
    s_and_b32 s48, s48, 0x3ffff
    s_add_u32 s48, s48, s52
    buffer_load_dwordx4 v13, s[16:19], s48 offen offset:0 nt lds
    buffer_load_dwordx4 v14, s[16:19], s48 offen offset:1024 nt lds
    buffer_load_dwordx4 v15, s[16:19], s48 offen offset:2048 nt lds
    buffer_load_dwordx4 v16, s[16:19], s48 offen offset:3072 nt lds
    s_add_u32 s48, s52, 36864
    s_mov_b32 m0, s48
    s_add_u32 s48, s51, 98304
    s_and_b32 s48, s48, 0x3ffff
    s_add_u32 s48, s48, s52
    s_add_u32 s48, s48, 4096
    buffer_load_dwordx4 v13, s[16:19], s48 offen offset:0 nt lds
    buffer_load_dwordx4 v14, s[16:19], s48 offen offset:1024 nt lds
    buffer_load_dwordx4 v15, s[16:19], s48 offen offset:2048 nt lds
    buffer_load_dwordx4 v16, s[16:19], s48 offen offset:3072 nt lds
    s_add_u32 s48, s52, 65536
    s_mov_b32 m0, s48
    s_add_u32 s48, s51, 65536
    s_and_b32 s48, s48, 0x3ffff
    s_add_u32 s48, s48, s52
    buffer_load_dwordx4 v17, s[20:23], s48 offen offset:0 nt lds
    buffer_load_dwordx4 v17, s[20:23], s48 offen offset:1024 nt lds
    buffer_load_dwordx4 v17, s[20:23], s48 offen offset:2048 nt lds
    buffer_load_dwordx4 v17, s[20:23], s48 offen offset:3072 nt lds
    s_add_u32 s48, s52, 69632
    s_mov_b32 m0, s48
    s_add_u32 s48, s51, 65536
    s_and_b32 s48, s48, 0x3ffff
    s_add_u32 s48, s48, s52
    s_add_u32 s48, s48, 4096
    buffer_load_dwordx4 v17, s[20:23], s48 offen offset:0 nt lds
    buffer_load_dwordx4 v17, s[20:23], s48 offen offset:1024 nt lds
    buffer_load_dwordx4 v17, s[20:23], s48 offen offset:2048 nt lds
    buffer_load_dwordx4 v17, s[20:23], s48 offen offset:3072 nt lds
L_role_21:
    ds_read_b64_tr_b16 a[32:33], v9 offset:16384
    ds_read_b64_tr_b16 a[34:35], v9 offset:18432
    ds_read_b64_tr_b16 a[36:37], v10 offset:16384
    ds_read_b64_tr_b16 a[38:39], v10 offset:18432
    ds_read_b64_tr_b16 a[40:41], v11 offset:16384
    ds_read_b64_tr_b16 a[42:43], v11 offset:18432
    ds_read_b64_tr_b16 a[44:45], v12 offset:16384
    ds_read_b64_tr_b16 a[46:47], v12 offset:18432
    ds_read_b64_tr_b16 a[48:49], v9 offset:20480
    ds_read_b64_tr_b16 a[50:51], v9 offset:22528
    ds_read_b64_tr_b16 a[52:53], v10 offset:20480
    ds_read_b64_tr_b16 a[54:55], v10 offset:22528
    s_waitcnt lgkmcnt(10)
    v_mfma_f32_32x32x16_bf16 v[32:47], a[32:35], v[160:163], v[32:47]
    v_max3_f32 v22, v96, v97, v98
    v_max3_f32 v23, v99, v100, v101
    v_max3_f32 v22, v22, v102, v103
    v_max3_f32 v23, v23, v104, v105
    v_max3_f32 v22, v22, v106, v107
    v_max3_f32 v23, v23, v108, v109
    v_max3_f32 v22, v22, v110, v111
    ds_read_b64_tr_b16 a[56:57], v11 offset:20480
    ds_read_b64_tr_b16 a[58:59], v11 offset:22528
    s_waitcnt lgkmcnt(10)
    v_mfma_f32_32x32x16_bf16 v[48:63], a[36:39], v[160:163], v[48:63]
    v_max3_f32 v23, v23, v112, v113
    v_max3_f32 v22, v22, v114, v115
    v_max3_f32 v23, v23, v116, v117
    v_max3_f32 v22, v22, v118, v119
    v_max3_f32 v23, v23, v120, v121
    v_max3_f32 v22, v22, v122, v123
    v_max3_f32 v23, v23, v124, v125
    ds_read_b64_tr_b16 a[60:61], v12 offset:20480
    ds_read_b64_tr_b16 a[62:63], v12 offset:22528
    s_waitcnt lgkmcnt(10)
    v_mfma_f32_32x32x16_bf16 v[64:79], a[40:43], v[160:163], v[64:79]
    v_max3_f32 v22, v22, v126, v127
    v_max_f32 v22, v22, v23
    v_mov_b32 v23, v22
    s_nop 1
    v_permlane32_swap_b32 v22, v23
    s_nop 1
    v_max3_f32 v19, v18, v22, v23
    ds_read_b64_tr_b16 a[64:65], v9 offset:24576
    ds_read_b64_tr_b16 a[66:67], v9 offset:26624
    s_waitcnt lgkmcnt(10)
    v_mfma_f32_32x32x16_bf16 v[80:95], a[44:47], v[160:163], v[80:95]
    v_sub_f32 v22, v18, v19
    v_mul_f32 v24, s50, v19
    v_mul_f32 v22, s49, v22
    v_mov_b32 v18, v19
    v_exp_f32 v21, v22
    v_fma_f32 v96, v96, s49, v24
    v_fma_f32 v97, v97, s49, v24
    ds_read_b64_tr_b16 a[68:69], v10 offset:24576
    ds_read_b64_tr_b16 a[70:71], v10 offset:26624
    s_waitcnt lgkmcnt(10)
    v_mfma_f32_32x32x16_bf16 v[32:47], a[48:51], v[164:167], v[32:47]
    v_exp_f32 v96, v96
    v_fma_f32 v98, v98, s49, v24
    v_exp_f32 v97, v97
    v_fma_f32 v99, v99, s49, v24
    v_exp_f32 v98, v98
    v_fma_f32 v100, v100, s49, v24
    v_exp_f32 v99, v99
    ds_read_b64_tr_b16 a[72:73], v11 offset:24576
    ds_read_b64_tr_b16 a[74:75], v11 offset:26624
    s_waitcnt lgkmcnt(10)
    v_mfma_f32_32x32x16_bf16 v[48:63], a[52:55], v[164:167], v[48:63]
    v_fma_f32 v101, v101, s49, v24
    v_exp_f32 v100, v100
    v_fma_f32 v102, v102, s49, v24
    v_exp_f32 v101, v101
    v_fma_f32 v103, v103, s49, v24
    v_exp_f32 v102, v102
    v_fma_f32 v104, v104, s49, v24
    ds_read_b64_tr_b16 a[76:77], v12 offset:24576
    ds_read_b64_tr_b16 a[78:79], v12 offset:26624
    s_waitcnt lgkmcnt(10)
    v_mfma_f32_32x32x16_bf16 v[64:79], a[56:59], v[164:167], v[64:79]
    v_exp_f32 v103, v103
    v_fma_f32 v105, v105, s49, v24
    v_exp_f32 v104, v104
    v_fma_f32 v106, v106, s49, v24
    v_exp_f32 v105, v105
    v_fma_f32 v107, v107, s49, v24
    v_exp_f32 v106, v106
    ds_read_b64_tr_b16 a[80:81], v9 offset:28672
    ds_read_b64_tr_b16 a[82:83], v9 offset:30720
    s_waitcnt lgkmcnt(10)
    v_mfma_f32_32x32x16_bf16 v[80:95], a[60:63], v[164:167], v[80:95]
    v_fma_f32 v108, v108, s49, v24
    v_exp_f32 v107, v107
    v_fma_f32 v109, v109, s49, v24
    v_exp_f32 v108, v108
    v_fma_f32 v110, v110, s49, v24
    v_exp_f32 v109, v109
    v_fma_f32 v111, v111, s49, v24
    ds_read_b64_tr_b16 a[84:85], v10 offset:28672
    ds_read_b64_tr_b16 a[86:87], v10 offset:30720
    s_waitcnt lgkmcnt(10)
    v_mfma_f32_32x32x16_bf16 v[32:47], a[64:67], v[168:171], v[32:47]
    v_exp_f32 v110, v110
    v_fma_f32 v112, v112, s49, v24
    v_exp_f32 v111, v111
    v_fma_f32 v113, v113, s49, v24
    v_exp_f32 v112, v112
    v_fma_f32 v114, v114, s49, v24
    v_exp_f32 v113, v113
    ds_read_b64_tr_b16 a[88:89], v11 offset:28672
    ds_read_b64_tr_b16 a[90:91], v11 offset:30720
    s_waitcnt lgkmcnt(10)
    v_mfma_f32_32x32x16_bf16 v[48:63], a[68:71], v[168:171], v[48:63]
    v_fma_f32 v115, v115, s49, v24
    v_exp_f32 v114, v114
    v_fma_f32 v116, v116, s49, v24
    v_exp_f32 v115, v115
    v_fma_f32 v117, v117, s49, v24
    v_exp_f32 v116, v116
    v_fma_f32 v118, v118, s49, v24
    ds_read_b64_tr_b16 a[92:93], v12 offset:28672
    ds_read_b64_tr_b16 a[94:95], v12 offset:30720
    s_waitcnt lgkmcnt(10)
    v_mfma_f32_32x32x16_bf16 v[64:79], a[72:75], v[168:171], v[64:79]
    v_exp_f32 v117, v117
    v_fma_f32 v119, v119, s49, v24
    v_exp_f32 v118, v118
    v_fma_f32 v120, v120, s49, v24
    v_exp_f32 v119, v119
    v_fma_f32 v121, v121, s49, v24
    v_exp_f32 v120, v120
    ds_read_b128 a[96:99], v1 offset:49152
    s_waitcnt lgkmcnt(9)
    v_mfma_f32_32x32x16_bf16 v[80:95], a[76:79], v[168:171], v[80:95]
    v_fma_f32 v122, v122, s49, v24
    v_exp_f32 v121, v121
    v_fma_f32 v123, v123, s49, v24
    v_exp_f32 v122, v122
    v_fma_f32 v124, v124, s49, v24
    v_exp_f32 v123, v123
    v_fma_f32 v125, v125, s49, v24
    ds_read_b128 a[100:103], v2 offset:49152
    s_waitcnt lgkmcnt(8)
    v_mfma_f32_32x32x16_bf16 v[32:47], a[80:83], v[172:175], v[32:47]
    v_exp_f32 v124, v124
    v_fma_f32 v126, v126, s49, v24
    v_exp_f32 v125, v125
    v_fma_f32 v127, v127, s49, v24
    v_exp_f32 v126, v126
    v_exp_f32 v127, v127
    v_mul_f32 v20, v20, v21
    ds_read_b128 a[104:107], v3 offset:49152
    s_waitcnt lgkmcnt(7)
    v_mfma_f32_32x32x16_bf16 v[48:63], a[84:87], v[172:175], v[48:63]
    v_add_f32 v22, v96, v97
    v_add_f32 v23, v98, v99
    v_add_f32 v22, v22, v100
    v_add_f32 v23, v23, v101
    v_add_f32 v22, v22, v102
    v_add_f32 v23, v23, v103
    v_add_f32 v22, v22, v104
    ds_read_b128 a[108:111], v4 offset:49152
    s_waitcnt lgkmcnt(6)
    v_mfma_f32_32x32x16_bf16 v[64:79], a[88:91], v[172:175], v[64:79]
    v_add_f32 v23, v23, v105
    v_add_f32 v22, v22, v106
    v_add_f32 v23, v23, v107
    v_add_f32 v22, v22, v108
    v_add_f32 v23, v23, v109
    v_add_f32 v22, v22, v110
    v_add_f32 v23, v23, v111
    ds_read_b128 a[112:115], v5 offset:49152
    s_waitcnt lgkmcnt(5)
    v_mfma_f32_32x32x16_bf16 v[80:95], a[92:95], v[172:175], v[80:95]
    v_add_f32 v22, v22, v112
    v_add_f32 v23, v23, v113
    v_add_f32 v22, v22, v114
    v_add_f32 v23, v23, v115
    v_add_f32 v22, v22, v116
    v_add_f32 v23, v23, v117
    v_add_f32 v22, v22, v118
    ds_read_b128 a[116:119], v6 offset:49152
    s_waitcnt lgkmcnt(5)
    v_mfma_f32_32x32x16_bf16 v[128:143], a[96:99], a[0:3], 0
    v_add_f32 v23, v23, v119
    v_add_f32 v22, v22, v120
    v_add_f32 v23, v23, v121
    v_add_f32 v22, v22, v122
    v_add_f32 v23, v23, v123
    v_add_f32 v22, v22, v124
    v_add_f32 v23, v23, v125
    ds_read_b128 a[120:123], v7 offset:49152
    s_waitcnt lgkmcnt(5)
    v_mfma_f32_32x32x16_bf16 v[128:143], a[100:103], a[4:7], v[128:143]
    v_add_f32 v22, v22, v126
    v_add_f32 v23, v23, v127
    v_add_f32 v22, v22, v23
    v_add_f32 v20, v20, v22
    v_cvt_pk_bf16_f32 v160, v96, v97
    v_cvt_pk_bf16_f32 v161, v98, v99
    v_cvt_pk_bf16_f32 v162, v100, v101
    ds_read_b128 a[124:127], v8 offset:49152
    s_waitcnt lgkmcnt(5)
    v_mfma_f32_32x32x16_bf16 v[128:143], a[104:107], a[8:11], v[128:143]
    v_cvt_pk_bf16_f32 v163, v102, v103
    v_cvt_pk_bf16_f32 v164, v104, v105
    v_cvt_pk_bf16_f32 v165, v106, v107
    v_cvt_pk_bf16_f32 v166, v108, v109
    v_cvt_pk_bf16_f32 v167, v110, v111
    v_cvt_pk_bf16_f32 v168, v112, v113
    v_cvt_pk_bf16_f32 v169, v114, v115
    ds_read_b128 a[128:131], v1 offset:57344
    s_waitcnt lgkmcnt(5)
    v_mfma_f32_32x32x16_bf16 v[128:143], a[108:111], a[12:15], v[128:143]
    v_cvt_pk_bf16_f32 v170, v116, v117
    v_cvt_pk_bf16_f32 v171, v118, v119
    v_cvt_pk_bf16_f32 v172, v120, v121
    v_cvt_pk_bf16_f32 v173, v122, v123
    v_cvt_pk_bf16_f32 v174, v124, v125
    v_cvt_pk_bf16_f32 v175, v126, v127
    v_mul_f32 v32, v32, v21
    ds_read_b128 a[132:135], v2 offset:57344
    s_waitcnt lgkmcnt(5)
    v_mfma_f32_32x32x16_bf16 v[128:143], a[112:115], a[16:19], v[128:143]
    v_mul_f32 v33, v33, v21
    v_mul_f32 v34, v34, v21
    v_mul_f32 v35, v35, v21
    v_mul_f32 v36, v36, v21
    v_mul_f32 v37, v37, v21
    v_mul_f32 v38, v38, v21
    v_mul_f32 v39, v39, v21
    ds_read_b128 a[136:139], v3 offset:57344
    s_waitcnt lgkmcnt(5)
    v_mfma_f32_32x32x16_bf16 v[128:143], a[116:119], a[20:23], v[128:143]
    v_mul_f32 v40, v40, v21
    v_mul_f32 v41, v41, v21
    v_mul_f32 v42, v42, v21
    v_mul_f32 v43, v43, v21
    v_mul_f32 v44, v44, v21
    v_mul_f32 v45, v45, v21
    v_mul_f32 v46, v46, v21
    ds_read_b128 a[140:143], v4 offset:57344
    s_waitcnt lgkmcnt(5)
    v_mfma_f32_32x32x16_bf16 v[128:143], a[120:123], a[24:27], v[128:143]
    v_mul_f32 v47, v47, v21
    v_mul_f32 v48, v48, v21
    v_mul_f32 v49, v49, v21
    v_mul_f32 v50, v50, v21
    v_mul_f32 v51, v51, v21
    v_mul_f32 v52, v52, v21
    v_mul_f32 v53, v53, v21
    ds_read_b128 a[144:147], v5 offset:57344
    s_waitcnt lgkmcnt(5)
    v_mfma_f32_32x32x16_bf16 v[128:143], a[124:127], a[28:31], v[128:143]
    v_mul_f32 v54, v54, v21
    v_mul_f32 v55, v55, v21
    v_mul_f32 v56, v56, v21
    v_mul_f32 v57, v57, v21
    v_mul_f32 v58, v58, v21
    v_mul_f32 v59, v59, v21
    v_mul_f32 v60, v60, v21
    ds_read_b128 a[148:151], v6 offset:57344
    s_waitcnt lgkmcnt(5)
    v_mfma_f32_32x32x16_bf16 v[144:159], a[128:131], a[0:3], 0
    v_mul_f32 v61, v61, v21
    v_mul_f32 v62, v62, v21
    v_mul_f32 v63, v63, v21
    v_mul_f32 v64, v64, v21
    v_mul_f32 v65, v65, v21
    v_mul_f32 v66, v66, v21
    v_mul_f32 v67, v67, v21
    ds_read_b128 a[152:155], v7 offset:57344
    s_waitcnt lgkmcnt(5)
    v_mfma_f32_32x32x16_bf16 v[144:159], a[132:135], a[4:7], v[144:159]
    v_mul_f32 v68, v68, v21
    v_mul_f32 v69, v69, v21
    v_mul_f32 v70, v70, v21
    v_mul_f32 v71, v71, v21
    v_mul_f32 v72, v72, v21
    v_mul_f32 v73, v73, v21
    v_mul_f32 v74, v74, v21
    ds_read_b128 a[156:159], v8 offset:57344
    s_waitcnt lgkmcnt(5)
    v_mfma_f32_32x32x16_bf16 v[144:159], a[136:139], a[8:11], v[144:159]
    v_mul_f32 v75, v75, v21
    v_mul_f32 v76, v76, v21
    v_mul_f32 v77, v77, v21
    v_mul_f32 v78, v78, v21
    v_mul_f32 v79, v79, v21
    v_mul_f32 v80, v80, v21
    v_mul_f32 v81, v81, v21
    s_waitcnt lgkmcnt(4)
    v_mfma_f32_32x32x16_bf16 v[144:159], a[140:143], a[12:15], v[144:159]
    v_mul_f32 v82, v82, v21
    v_mul_f32 v83, v83, v21
    v_mul_f32 v84, v84, v21
    v_mul_f32 v85, v85, v21
    v_mul_f32 v86, v86, v21
    v_mul_f32 v87, v87, v21
    v_mul_f32 v88, v88, v21
    s_waitcnt lgkmcnt(3)
    v_mfma_f32_32x32x16_bf16 v[144:159], a[144:147], a[16:19], v[144:159]
    v_mul_f32 v89, v89, v21
    v_mul_f32 v90, v90, v21
    v_mul_f32 v91, v91, v21
    v_mul_f32 v92, v92, v21
    v_mul_f32 v93, v93, v21
    v_mul_f32 v94, v94, v21
    v_mul_f32 v95, v95, v21
    s_waitcnt lgkmcnt(2)
    v_mfma_f32_32x32x16_bf16 v[144:159], a[148:151], a[20:23], v[144:159]
    s_waitcnt lgkmcnt(1)
    v_mfma_f32_32x32x16_bf16 v[144:159], a[152:155], a[24:27], v[144:159]
    s_waitcnt lgkmcnt(0)
    v_mfma_f32_32x32x16_bf16 v[144:159], a[156:159], a[28:31], v[144:159]
    s_waitcnt vmcnt(32)
    s_barrier
    s_cmp_lt_u32 s3, 2
    s_cbranch_scc1 L_role_22
    s_add_u32 s48, s52, 49152
    s_mov_b32 m0, s48
    s_add_u32 s48, s51, 114688
    s_and_b32 s48, s48, 0x3ffff
    s_add_u32 s48, s48, s52
    buffer_load_dwordx4 v13, s[16:19], s48 offen offset:0 nt lds
    buffer_load_dwordx4 v14, s[16:19], s48 offen offset:1024 nt lds
    buffer_load_dwordx4 v15, s[16:19], s48 offen offset:2048 nt lds
    buffer_load_dwordx4 v16, s[16:19], s48 offen offset:3072 nt lds
    s_add_u32 s48, s52, 53248
    s_mov_b32 m0, s48
    s_add_u32 s48, s51, 114688
    s_and_b32 s48, s48, 0x3ffff
    s_add_u32 s48, s48, s52
    s_add_u32 s48, s48, 4096
    buffer_load_dwordx4 v13, s[16:19], s48 offen offset:0 nt lds
    buffer_load_dwordx4 v14, s[16:19], s48 offen offset:1024 nt lds
    buffer_load_dwordx4 v15, s[16:19], s48 offen offset:2048 nt lds
    buffer_load_dwordx4 v16, s[16:19], s48 offen offset:3072 nt lds
    s_add_u32 s48, s52, 81920
    s_mov_b32 m0, s48
    s_add_u32 s48, s51, 81920
    s_and_b32 s48, s48, 0x3ffff
    s_add_u32 s48, s48, s52
    buffer_load_dwordx4 v17, s[20:23], s48 offen offset:0 nt lds
    buffer_load_dwordx4 v17, s[20:23], s48 offen offset:1024 nt lds
    buffer_load_dwordx4 v17, s[20:23], s48 offen offset:2048 nt lds
    buffer_load_dwordx4 v17, s[20:23], s48 offen offset:3072 nt lds
    s_add_u32 s48, s52, 86016
    s_mov_b32 m0, s48
    s_add_u32 s48, s51, 81920
    s_and_b32 s48, s48, 0x3ffff
    s_add_u32 s48, s48, s52
    s_add_u32 s48, s48, 4096
    buffer_load_dwordx4 v17, s[20:23], s48 offen offset:0 nt lds
    buffer_load_dwordx4 v17, s[20:23], s48 offen offset:1024 nt lds
    buffer_load_dwordx4 v17, s[20:23], s48 offen offset:2048 nt lds
    buffer_load_dwordx4 v17, s[20:23], s48 offen offset:3072 nt lds
L_role_22:
    ds_read_b64_tr_b16 a[32:33], v9 offset:32768
    ds_read_b64_tr_b16 a[34:35], v9 offset:34816
    ds_read_b64_tr_b16 a[36:37], v10 offset:32768
    ds_read_b64_tr_b16 a[38:39], v10 offset:34816
    ds_read_b64_tr_b16 a[40:41], v11 offset:32768
    ds_read_b64_tr_b16 a[42:43], v11 offset:34816
    ds_read_b64_tr_b16 a[44:45], v12 offset:32768
    ds_read_b64_tr_b16 a[46:47], v12 offset:34816
    ds_read_b64_tr_b16 a[48:49], v9 offset:36864
    ds_read_b64_tr_b16 a[50:51], v9 offset:38912
    ds_read_b64_tr_b16 a[52:53], v10 offset:36864
    ds_read_b64_tr_b16 a[54:55], v10 offset:38912
    s_waitcnt lgkmcnt(10)
    v_mfma_f32_32x32x16_bf16 v[32:47], a[32:35], v[160:163], v[32:47]
    v_max3_f32 v22, v128, v129, v130
    v_max3_f32 v23, v131, v132, v133
    v_max3_f32 v22, v22, v134, v135
    v_max3_f32 v23, v23, v136, v137
    v_max3_f32 v22, v22, v138, v139
    v_max3_f32 v23, v23, v140, v141
    v_max3_f32 v22, v22, v142, v143
    ds_read_b64_tr_b16 a[56:57], v11 offset:36864
    ds_read_b64_tr_b16 a[58:59], v11 offset:38912
    s_waitcnt lgkmcnt(10)
    v_mfma_f32_32x32x16_bf16 v[48:63], a[36:39], v[160:163], v[48:63]
    v_max3_f32 v23, v23, v144, v145
    v_max3_f32 v22, v22, v146, v147
    v_max3_f32 v23, v23, v148, v149
    v_max3_f32 v22, v22, v150, v151
    v_max3_f32 v23, v23, v152, v153
    v_max3_f32 v22, v22, v154, v155
    v_max3_f32 v23, v23, v156, v157
    ds_read_b64_tr_b16 a[60:61], v12 offset:36864
    ds_read_b64_tr_b16 a[62:63], v12 offset:38912
    s_waitcnt lgkmcnt(10)
    v_mfma_f32_32x32x16_bf16 v[64:79], a[40:43], v[160:163], v[64:79]
    v_max3_f32 v22, v22, v158, v159
    v_max_f32 v22, v22, v23
    v_mov_b32 v23, v22
    s_nop 1
    v_permlane32_swap_b32 v22, v23
    s_nop 1
    v_max3_f32 v19, v18, v22, v23
    ds_read_b64_tr_b16 a[64:65], v9 offset:40960
    ds_read_b64_tr_b16 a[66:67], v9 offset:43008
    s_waitcnt lgkmcnt(10)
    v_mfma_f32_32x32x16_bf16 v[80:95], a[44:47], v[160:163], v[80:95]
    v_sub_f32 v22, v18, v19
    v_mul_f32 v24, s50, v19
    v_mul_f32 v22, s49, v22
    v_mov_b32 v18, v19
    v_exp_f32 v21, v22
    v_fma_f32 v128, v128, s49, v24
    v_fma_f32 v129, v129, s49, v24
    ds_read_b64_tr_b16 a[68:69], v10 offset:40960
    ds_read_b64_tr_b16 a[70:71], v10 offset:43008
    s_waitcnt lgkmcnt(10)
    v_mfma_f32_32x32x16_bf16 v[32:47], a[48:51], v[164:167], v[32:47]
    v_exp_f32 v128, v128
    v_fma_f32 v130, v130, s49, v24
    v_exp_f32 v129, v129
    v_fma_f32 v131, v131, s49, v24
    v_exp_f32 v130, v130
    v_fma_f32 v132, v132, s49, v24
    v_exp_f32 v131, v131
    ds_read_b64_tr_b16 a[72:73], v11 offset:40960
    ds_read_b64_tr_b16 a[74:75], v11 offset:43008
    s_waitcnt lgkmcnt(10)
    v_mfma_f32_32x32x16_bf16 v[48:63], a[52:55], v[164:167], v[48:63]
    v_fma_f32 v133, v133, s49, v24
    v_exp_f32 v132, v132
    v_fma_f32 v134, v134, s49, v24
    v_exp_f32 v133, v133
    v_fma_f32 v135, v135, s49, v24
    v_exp_f32 v134, v134
    v_fma_f32 v136, v136, s49, v24
    ds_read_b64_tr_b16 a[76:77], v12 offset:40960
    ds_read_b64_tr_b16 a[78:79], v12 offset:43008
    s_waitcnt lgkmcnt(10)
    v_mfma_f32_32x32x16_bf16 v[64:79], a[56:59], v[164:167], v[64:79]
    v_exp_f32 v135, v135
    v_fma_f32 v137, v137, s49, v24
    v_exp_f32 v136, v136
    v_fma_f32 v138, v138, s49, v24
    v_exp_f32 v137, v137
    v_fma_f32 v139, v139, s49, v24
    v_exp_f32 v138, v138
    ds_read_b64_tr_b16 a[80:81], v9 offset:45056
    ds_read_b64_tr_b16 a[82:83], v9 offset:47104
    s_waitcnt lgkmcnt(10)
    v_mfma_f32_32x32x16_bf16 v[80:95], a[60:63], v[164:167], v[80:95]
    v_fma_f32 v140, v140, s49, v24
    v_exp_f32 v139, v139
    v_fma_f32 v141, v141, s49, v24
    v_exp_f32 v140, v140
    v_fma_f32 v142, v142, s49, v24
    v_exp_f32 v141, v141
    v_fma_f32 v143, v143, s49, v24
    ds_read_b64_tr_b16 a[84:85], v10 offset:45056
    ds_read_b64_tr_b16 a[86:87], v10 offset:47104
    s_waitcnt lgkmcnt(10)
    v_mfma_f32_32x32x16_bf16 v[32:47], a[64:67], v[168:171], v[32:47]
    v_exp_f32 v142, v142
    v_fma_f32 v144, v144, s49, v24
    v_exp_f32 v143, v143
    v_fma_f32 v145, v145, s49, v24
    v_exp_f32 v144, v144
    v_fma_f32 v146, v146, s49, v24
    v_exp_f32 v145, v145
    ds_read_b64_tr_b16 a[88:89], v11 offset:45056
    ds_read_b64_tr_b16 a[90:91], v11 offset:47104
    s_waitcnt lgkmcnt(10)
    v_mfma_f32_32x32x16_bf16 v[48:63], a[68:71], v[168:171], v[48:63]
    v_fma_f32 v147, v147, s49, v24
    v_exp_f32 v146, v146
    v_fma_f32 v148, v148, s49, v24
    v_exp_f32 v147, v147
    v_fma_f32 v149, v149, s49, v24
    v_exp_f32 v148, v148
    v_fma_f32 v150, v150, s49, v24
    ds_read_b64_tr_b16 a[92:93], v12 offset:45056
    ds_read_b64_tr_b16 a[94:95], v12 offset:47104
    s_waitcnt lgkmcnt(10)
    v_mfma_f32_32x32x16_bf16 v[64:79], a[72:75], v[168:171], v[64:79]
    v_exp_f32 v149, v149
    v_fma_f32 v151, v151, s49, v24
    v_exp_f32 v150, v150
    v_fma_f32 v152, v152, s49, v24
    v_exp_f32 v151, v151
    v_fma_f32 v153, v153, s49, v24
    v_exp_f32 v152, v152
    ds_read_b128 a[96:99], v1 offset:0
    s_waitcnt lgkmcnt(9)
    v_mfma_f32_32x32x16_bf16 v[80:95], a[76:79], v[168:171], v[80:95]
    v_fma_f32 v154, v154, s49, v24
    v_exp_f32 v153, v153
    v_fma_f32 v155, v155, s49, v24
    v_exp_f32 v154, v154
    v_fma_f32 v156, v156, s49, v24
    v_exp_f32 v155, v155
    v_fma_f32 v157, v157, s49, v24
    ds_read_b128 a[100:103], v2 offset:0
    s_waitcnt lgkmcnt(8)
    v_mfma_f32_32x32x16_bf16 v[32:47], a[80:83], v[172:175], v[32:47]
    v_exp_f32 v156, v156
    v_fma_f32 v158, v158, s49, v24
    v_exp_f32 v157, v157
    v_fma_f32 v159, v159, s49, v24
    v_exp_f32 v158, v158
    v_exp_f32 v159, v159
    v_mul_f32 v20, v20, v21
    ds_read_b128 a[104:107], v3 offset:0
    s_waitcnt lgkmcnt(7)
    v_mfma_f32_32x32x16_bf16 v[48:63], a[84:87], v[172:175], v[48:63]
    v_add_f32 v22, v128, v129
    v_add_f32 v23, v130, v131
    v_add_f32 v22, v22, v132
    v_add_f32 v23, v23, v133
    v_add_f32 v22, v22, v134
    v_add_f32 v23, v23, v135
    v_add_f32 v22, v22, v136
    ds_read_b128 a[108:111], v4 offset:0
    s_waitcnt lgkmcnt(6)
    v_mfma_f32_32x32x16_bf16 v[64:79], a[88:91], v[172:175], v[64:79]
    v_add_f32 v23, v23, v137
    v_add_f32 v22, v22, v138
    v_add_f32 v23, v23, v139
    v_add_f32 v22, v22, v140
    v_add_f32 v23, v23, v141
    v_add_f32 v22, v22, v142
    v_add_f32 v23, v23, v143
    ds_read_b128 a[112:115], v5 offset:0
    s_waitcnt lgkmcnt(5)
    v_mfma_f32_32x32x16_bf16 v[80:95], a[92:95], v[172:175], v[80:95]
    v_add_f32 v22, v22, v144
    v_add_f32 v23, v23, v145
    v_add_f32 v22, v22, v146
    v_add_f32 v23, v23, v147
    v_add_f32 v22, v22, v148
    v_add_f32 v23, v23, v149
    v_add_f32 v22, v22, v150
    ds_read_b128 a[116:119], v6 offset:0
    s_waitcnt lgkmcnt(5)
    v_mfma_f32_32x32x16_bf16 v[96:111], a[96:99], a[0:3], 0
    v_add_f32 v23, v23, v151
    v_add_f32 v22, v22, v152
    v_add_f32 v23, v23, v153
    v_add_f32 v22, v22, v154
    v_add_f32 v23, v23, v155
    v_add_f32 v22, v22, v156
    v_add_f32 v23, v23, v157
    ds_read_b128 a[120:123], v7 offset:0
    s_waitcnt lgkmcnt(5)
    v_mfma_f32_32x32x16_bf16 v[96:111], a[100:103], a[4:7], v[96:111]
    v_add_f32 v22, v22, v158
    v_add_f32 v23, v23, v159
    v_add_f32 v22, v22, v23
    v_add_f32 v20, v20, v22
    v_cvt_pk_bf16_f32 v160, v128, v129
    v_cvt_pk_bf16_f32 v161, v130, v131
    v_cvt_pk_bf16_f32 v162, v132, v133
    ds_read_b128 a[124:127], v8 offset:0
    s_waitcnt lgkmcnt(5)
    v_mfma_f32_32x32x16_bf16 v[96:111], a[104:107], a[8:11], v[96:111]
    v_cvt_pk_bf16_f32 v163, v134, v135
    v_cvt_pk_bf16_f32 v164, v136, v137
    v_cvt_pk_bf16_f32 v165, v138, v139
    v_cvt_pk_bf16_f32 v166, v140, v141
    v_cvt_pk_bf16_f32 v167, v142, v143
    v_cvt_pk_bf16_f32 v168, v144, v145
    v_cvt_pk_bf16_f32 v169, v146, v147
    ds_read_b128 a[128:131], v1 offset:8192
    s_waitcnt lgkmcnt(5)
    v_mfma_f32_32x32x16_bf16 v[96:111], a[108:111], a[12:15], v[96:111]
    v_cvt_pk_bf16_f32 v170, v148, v149
    v_cvt_pk_bf16_f32 v171, v150, v151
    v_cvt_pk_bf16_f32 v172, v152, v153
    v_cvt_pk_bf16_f32 v173, v154, v155
    v_cvt_pk_bf16_f32 v174, v156, v157
    v_cvt_pk_bf16_f32 v175, v158, v159
    v_mul_f32 v32, v32, v21
    ds_read_b128 a[132:135], v2 offset:8192
    s_waitcnt lgkmcnt(5)
    v_mfma_f32_32x32x16_bf16 v[96:111], a[112:115], a[16:19], v[96:111]
    v_mul_f32 v33, v33, v21
    v_mul_f32 v34, v34, v21
    v_mul_f32 v35, v35, v21
    v_mul_f32 v36, v36, v21
    v_mul_f32 v37, v37, v21
    v_mul_f32 v38, v38, v21
    v_mul_f32 v39, v39, v21
    ds_read_b128 a[136:139], v3 offset:8192
    s_waitcnt lgkmcnt(5)
    v_mfma_f32_32x32x16_bf16 v[96:111], a[116:119], a[20:23], v[96:111]
    v_mul_f32 v40, v40, v21
    v_mul_f32 v41, v41, v21
    v_mul_f32 v42, v42, v21
    v_mul_f32 v43, v43, v21
    v_mul_f32 v44, v44, v21
    v_mul_f32 v45, v45, v21
    v_mul_f32 v46, v46, v21
    ds_read_b128 a[140:143], v4 offset:8192
    s_waitcnt lgkmcnt(5)
    v_mfma_f32_32x32x16_bf16 v[96:111], a[120:123], a[24:27], v[96:111]
    v_mul_f32 v47, v47, v21
    v_mul_f32 v48, v48, v21
    v_mul_f32 v49, v49, v21
    v_mul_f32 v50, v50, v21
    v_mul_f32 v51, v51, v21
    v_mul_f32 v52, v52, v21
    v_mul_f32 v53, v53, v21
    ds_read_b128 a[144:147], v5 offset:8192
    s_waitcnt lgkmcnt(5)
    v_mfma_f32_32x32x16_bf16 v[96:111], a[124:127], a[28:31], v[96:111]
    v_mul_f32 v54, v54, v21
    v_mul_f32 v55, v55, v21
    v_mul_f32 v56, v56, v21
    v_mul_f32 v57, v57, v21
    v_mul_f32 v58, v58, v21
    v_mul_f32 v59, v59, v21
    v_mul_f32 v60, v60, v21
    ds_read_b128 a[148:151], v6 offset:8192
    s_waitcnt lgkmcnt(5)
    v_mfma_f32_32x32x16_bf16 v[112:127], a[128:131], a[0:3], 0
    v_mul_f32 v61, v61, v21
    v_mul_f32 v62, v62, v21
    v_mul_f32 v63, v63, v21
    v_mul_f32 v64, v64, v21
    v_mul_f32 v65, v65, v21
    v_mul_f32 v66, v66, v21
    v_mul_f32 v67, v67, v21
    ds_read_b128 a[152:155], v7 offset:8192
    s_waitcnt lgkmcnt(5)
    v_mfma_f32_32x32x16_bf16 v[112:127], a[132:135], a[4:7], v[112:127]
    v_mul_f32 v68, v68, v21
    v_mul_f32 v69, v69, v21
    v_mul_f32 v70, v70, v21
    v_mul_f32 v71, v71, v21
    v_mul_f32 v72, v72, v21
    v_mul_f32 v73, v73, v21
    v_mul_f32 v74, v74, v21
    ds_read_b128 a[156:159], v8 offset:8192
    s_waitcnt lgkmcnt(5)
    v_mfma_f32_32x32x16_bf16 v[112:127], a[136:139], a[8:11], v[112:127]
    v_mul_f32 v75, v75, v21
    v_mul_f32 v76, v76, v21
    v_mul_f32 v77, v77, v21
    v_mul_f32 v78, v78, v21
    v_mul_f32 v79, v79, v21
    v_mul_f32 v80, v80, v21
    v_mul_f32 v81, v81, v21
    s_waitcnt lgkmcnt(4)
    v_mfma_f32_32x32x16_bf16 v[112:127], a[140:143], a[12:15], v[112:127]
    v_mul_f32 v82, v82, v21
    v_mul_f32 v83, v83, v21
    v_mul_f32 v84, v84, v21
    v_mul_f32 v85, v85, v21
    v_mul_f32 v86, v86, v21
    v_mul_f32 v87, v87, v21
    v_mul_f32 v88, v88, v21
    s_waitcnt lgkmcnt(3)
    v_mfma_f32_32x32x16_bf16 v[112:127], a[144:147], a[16:19], v[112:127]
    v_mul_f32 v89, v89, v21
    v_mul_f32 v90, v90, v21
    v_mul_f32 v91, v91, v21
    v_mul_f32 v92, v92, v21
    v_mul_f32 v93, v93, v21
    v_mul_f32 v94, v94, v21
    v_mul_f32 v95, v95, v21
    s_waitcnt lgkmcnt(2)
    v_mfma_f32_32x32x16_bf16 v[112:127], a[148:151], a[20:23], v[112:127]
    s_waitcnt lgkmcnt(1)
    v_mfma_f32_32x32x16_bf16 v[112:127], a[152:155], a[24:27], v[112:127]
    s_waitcnt lgkmcnt(0)
    v_mfma_f32_32x32x16_bf16 v[112:127], a[156:159], a[28:31], v[112:127]
    s_waitcnt vmcnt(32)
    s_barrier
    s_cmp_lt_u32 s3, 2
    s_cbranch_scc1 L_role_23
    s_add_u32 s48, s52, 0
    s_mov_b32 m0, s48
    s_add_u32 s48, s51, 131072
    s_and_b32 s48, s48, 0x3ffff
    s_add_u32 s48, s48, s52
    buffer_load_dwordx4 v13, s[16:19], s48 offen offset:0 nt lds
    buffer_load_dwordx4 v14, s[16:19], s48 offen offset:1024 nt lds
    buffer_load_dwordx4 v15, s[16:19], s48 offen offset:2048 nt lds
    buffer_load_dwordx4 v16, s[16:19], s48 offen offset:3072 nt lds
    s_add_u32 s48, s52, 4096
    s_mov_b32 m0, s48
    s_add_u32 s48, s51, 131072
    s_and_b32 s48, s48, 0x3ffff
    s_add_u32 s48, s48, s52
    s_add_u32 s48, s48, 4096
    buffer_load_dwordx4 v13, s[16:19], s48 offen offset:0 nt lds
    buffer_load_dwordx4 v14, s[16:19], s48 offen offset:1024 nt lds
    buffer_load_dwordx4 v15, s[16:19], s48 offen offset:2048 nt lds
    buffer_load_dwordx4 v16, s[16:19], s48 offen offset:3072 nt lds
    s_add_u32 s48, s52, 98304
    s_mov_b32 m0, s48
    s_add_u32 s48, s51, 98304
    s_and_b32 s48, s48, 0x3ffff
    s_add_u32 s48, s48, s52
    buffer_load_dwordx4 v17, s[20:23], s48 offen offset:0 nt lds
    buffer_load_dwordx4 v17, s[20:23], s48 offen offset:1024 nt lds
    buffer_load_dwordx4 v17, s[20:23], s48 offen offset:2048 nt lds
    buffer_load_dwordx4 v17, s[20:23], s48 offen offset:3072 nt lds
    s_add_u32 s48, s52, 102400
    s_mov_b32 m0, s48
    s_add_u32 s48, s51, 98304
    s_and_b32 s48, s48, 0x3ffff
    s_add_u32 s48, s48, s52
    s_add_u32 s48, s48, 4096
    buffer_load_dwordx4 v17, s[20:23], s48 offen offset:0 nt lds
    buffer_load_dwordx4 v17, s[20:23], s48 offen offset:1024 nt lds
    buffer_load_dwordx4 v17, s[20:23], s48 offen offset:2048 nt lds
    buffer_load_dwordx4 v17, s[20:23], s48 offen offset:3072 nt lds
L_role_23:
    ds_read_b64_tr_b16 a[32:33], v9 offset:49152
    ds_read_b64_tr_b16 a[34:35], v9 offset:51200
    ds_read_b64_tr_b16 a[36:37], v10 offset:49152
    ds_read_b64_tr_b16 a[38:39], v10 offset:51200
    ds_read_b64_tr_b16 a[40:41], v11 offset:49152
    ds_read_b64_tr_b16 a[42:43], v11 offset:51200
    ds_read_b64_tr_b16 a[44:45], v12 offset:49152
    ds_read_b64_tr_b16 a[46:47], v12 offset:51200
    ds_read_b64_tr_b16 a[48:49], v9 offset:53248
    ds_read_b64_tr_b16 a[50:51], v9 offset:55296
    ds_read_b64_tr_b16 a[52:53], v10 offset:53248
    ds_read_b64_tr_b16 a[54:55], v10 offset:55296
    s_waitcnt lgkmcnt(10)
    v_mfma_f32_32x32x16_bf16 v[32:47], a[32:35], v[160:163], v[32:47]
    v_max3_f32 v22, v96, v97, v98
    v_max3_f32 v23, v99, v100, v101
    v_max3_f32 v22, v22, v102, v103
    v_max3_f32 v23, v23, v104, v105
    v_max3_f32 v22, v22, v106, v107
    v_max3_f32 v23, v23, v108, v109
    v_max3_f32 v22, v22, v110, v111
    ds_read_b64_tr_b16 a[56:57], v11 offset:53248
    ds_read_b64_tr_b16 a[58:59], v11 offset:55296
    s_waitcnt lgkmcnt(10)
    v_mfma_f32_32x32x16_bf16 v[48:63], a[36:39], v[160:163], v[48:63]
    v_max3_f32 v23, v23, v112, v113
    v_max3_f32 v22, v22, v114, v115
    v_max3_f32 v23, v23, v116, v117
    v_max3_f32 v22, v22, v118, v119
    v_max3_f32 v23, v23, v120, v121
    v_max3_f32 v22, v22, v122, v123
    v_max3_f32 v23, v23, v124, v125
    ds_read_b64_tr_b16 a[60:61], v12 offset:53248
    ds_read_b64_tr_b16 a[62:63], v12 offset:55296
    s_waitcnt lgkmcnt(10)
    v_mfma_f32_32x32x16_bf16 v[64:79], a[40:43], v[160:163], v[64:79]
    v_max3_f32 v22, v22, v126, v127
    v_max_f32 v22, v22, v23
    v_mov_b32 v23, v22
    s_nop 1
    v_permlane32_swap_b32 v22, v23
    s_nop 1
    v_max3_f32 v19, v18, v22, v23
    ds_read_b64_tr_b16 a[64:65], v9 offset:57344
    ds_read_b64_tr_b16 a[66:67], v9 offset:59392
    s_waitcnt lgkmcnt(10)
    v_mfma_f32_32x32x16_bf16 v[80:95], a[44:47], v[160:163], v[80:95]
    v_sub_f32 v22, v18, v19
    v_mul_f32 v24, s50, v19
    v_mul_f32 v22, s49, v22
    v_mov_b32 v18, v19
    v_exp_f32 v21, v22
    v_fma_f32 v96, v96, s49, v24
    v_fma_f32 v97, v97, s49, v24
    ds_read_b64_tr_b16 a[68:69], v10 offset:57344
    ds_read_b64_tr_b16 a[70:71], v10 offset:59392
    s_waitcnt lgkmcnt(10)
    v_mfma_f32_32x32x16_bf16 v[32:47], a[48:51], v[164:167], v[32:47]
    v_exp_f32 v96, v96
    v_fma_f32 v98, v98, s49, v24
    v_exp_f32 v97, v97
    v_fma_f32 v99, v99, s49, v24
    v_exp_f32 v98, v98
    v_fma_f32 v100, v100, s49, v24
    v_exp_f32 v99, v99
    ds_read_b64_tr_b16 a[72:73], v11 offset:57344
    ds_read_b64_tr_b16 a[74:75], v11 offset:59392
    s_waitcnt lgkmcnt(10)
    v_mfma_f32_32x32x16_bf16 v[48:63], a[52:55], v[164:167], v[48:63]
    v_fma_f32 v101, v101, s49, v24
    v_exp_f32 v100, v100
    v_fma_f32 v102, v102, s49, v24
    v_exp_f32 v101, v101
    v_fma_f32 v103, v103, s49, v24
    v_exp_f32 v102, v102
    v_fma_f32 v104, v104, s49, v24
    ds_read_b64_tr_b16 a[76:77], v12 offset:57344
    ds_read_b64_tr_b16 a[78:79], v12 offset:59392
    s_waitcnt lgkmcnt(10)
    v_mfma_f32_32x32x16_bf16 v[64:79], a[56:59], v[164:167], v[64:79]
    v_exp_f32 v103, v103
    v_fma_f32 v105, v105, s49, v24
    v_exp_f32 v104, v104
    v_fma_f32 v106, v106, s49, v24
    v_exp_f32 v105, v105
    v_fma_f32 v107, v107, s49, v24
    v_exp_f32 v106, v106
    ds_read_b64_tr_b16 a[80:81], v9 offset:61440
    ds_read_b64_tr_b16 a[82:83], v9 offset:63488
    s_waitcnt lgkmcnt(10)
    v_mfma_f32_32x32x16_bf16 v[80:95], a[60:63], v[164:167], v[80:95]
    v_fma_f32 v108, v108, s49, v24
    v_exp_f32 v107, v107
    v_fma_f32 v109, v109, s49, v24
    v_exp_f32 v108, v108
    v_fma_f32 v110, v110, s49, v24
    v_exp_f32 v109, v109
    v_fma_f32 v111, v111, s49, v24
    ds_read_b64_tr_b16 a[84:85], v10 offset:61440
    ds_read_b64_tr_b16 a[86:87], v10 offset:63488
    s_waitcnt lgkmcnt(10)
    v_mfma_f32_32x32x16_bf16 v[32:47], a[64:67], v[168:171], v[32:47]
    v_exp_f32 v110, v110
    v_fma_f32 v112, v112, s49, v24
    v_exp_f32 v111, v111
    v_fma_f32 v113, v113, s49, v24
    v_exp_f32 v112, v112
    v_fma_f32 v114, v114, s49, v24
    v_exp_f32 v113, v113
    ds_read_b64_tr_b16 a[88:89], v11 offset:61440
    ds_read_b64_tr_b16 a[90:91], v11 offset:63488
    s_waitcnt lgkmcnt(10)
    v_mfma_f32_32x32x16_bf16 v[48:63], a[68:71], v[168:171], v[48:63]
    v_fma_f32 v115, v115, s49, v24
    v_exp_f32 v114, v114
    v_fma_f32 v116, v116, s49, v24
    v_exp_f32 v115, v115
    v_fma_f32 v117, v117, s49, v24
    v_exp_f32 v116, v116
    v_fma_f32 v118, v118, s49, v24
    ds_read_b64_tr_b16 a[92:93], v12 offset:61440
    ds_read_b64_tr_b16 a[94:95], v12 offset:63488
    s_waitcnt lgkmcnt(10)
    v_mfma_f32_32x32x16_bf16 v[64:79], a[72:75], v[168:171], v[64:79]
    v_exp_f32 v117, v117
    v_fma_f32 v119, v119, s49, v24
    v_exp_f32 v118, v118
    v_fma_f32 v120, v120, s49, v24
    v_exp_f32 v119, v119
    v_fma_f32 v121, v121, s49, v24
    v_exp_f32 v120, v120
    ds_read_b128 a[96:99], v1 offset:16384
    s_waitcnt lgkmcnt(9)
    v_mfma_f32_32x32x16_bf16 v[80:95], a[76:79], v[168:171], v[80:95]
    v_fma_f32 v122, v122, s49, v24
    v_exp_f32 v121, v121
    v_fma_f32 v123, v123, s49, v24
    v_exp_f32 v122, v122
    v_fma_f32 v124, v124, s49, v24
    v_exp_f32 v123, v123
    v_fma_f32 v125, v125, s49, v24
    ds_read_b128 a[100:103], v2 offset:16384
    s_waitcnt lgkmcnt(8)
    v_mfma_f32_32x32x16_bf16 v[32:47], a[80:83], v[172:175], v[32:47]
    v_exp_f32 v124, v124
    v_fma_f32 v126, v126, s49, v24
    v_exp_f32 v125, v125
    v_fma_f32 v127, v127, s49, v24
    v_exp_f32 v126, v126
    v_exp_f32 v127, v127
    v_mul_f32 v20, v20, v21
    ds_read_b128 a[104:107], v3 offset:16384
    s_waitcnt lgkmcnt(7)
    v_mfma_f32_32x32x16_bf16 v[48:63], a[84:87], v[172:175], v[48:63]
    v_add_f32 v22, v96, v97
    v_add_f32 v23, v98, v99
    v_add_f32 v22, v22, v100
    v_add_f32 v23, v23, v101
    v_add_f32 v22, v22, v102
    v_add_f32 v23, v23, v103
    v_add_f32 v22, v22, v104
    ds_read_b128 a[108:111], v4 offset:16384
    s_waitcnt lgkmcnt(6)
    v_mfma_f32_32x32x16_bf16 v[64:79], a[88:91], v[172:175], v[64:79]
    v_add_f32 v23, v23, v105
    v_add_f32 v22, v22, v106
    v_add_f32 v23, v23, v107
    v_add_f32 v22, v22, v108
    v_add_f32 v23, v23, v109
    v_add_f32 v22, v22, v110
    v_add_f32 v23, v23, v111
    ds_read_b128 a[112:115], v5 offset:16384
    s_waitcnt lgkmcnt(5)
    v_mfma_f32_32x32x16_bf16 v[80:95], a[92:95], v[172:175], v[80:95]
    v_add_f32 v22, v22, v112
    v_add_f32 v23, v23, v113
    v_add_f32 v22, v22, v114
    v_add_f32 v23, v23, v115
    v_add_f32 v22, v22, v116
    v_add_f32 v23, v23, v117
    v_add_f32 v22, v22, v118
    ds_read_b128 a[116:119], v6 offset:16384
    s_waitcnt lgkmcnt(5)
    v_mfma_f32_32x32x16_bf16 v[128:143], a[96:99], a[0:3], 0
    v_add_f32 v23, v23, v119
    v_add_f32 v22, v22, v120
    v_add_f32 v23, v23, v121
    v_add_f32 v22, v22, v122
    v_add_f32 v23, v23, v123
    v_add_f32 v22, v22, v124
    v_add_f32 v23, v23, v125
    ds_read_b128 a[120:123], v7 offset:16384
    s_waitcnt lgkmcnt(5)
    v_mfma_f32_32x32x16_bf16 v[128:143], a[100:103], a[4:7], v[128:143]
    v_add_f32 v22, v22, v126
    v_add_f32 v23, v23, v127
    v_add_f32 v22, v22, v23
    v_add_f32 v20, v20, v22
    v_cvt_pk_bf16_f32 v160, v96, v97
    v_cvt_pk_bf16_f32 v161, v98, v99
    v_cvt_pk_bf16_f32 v162, v100, v101
    ds_read_b128 a[124:127], v8 offset:16384
    s_waitcnt lgkmcnt(5)
    v_mfma_f32_32x32x16_bf16 v[128:143], a[104:107], a[8:11], v[128:143]
    v_cvt_pk_bf16_f32 v163, v102, v103
    v_cvt_pk_bf16_f32 v164, v104, v105
    v_cvt_pk_bf16_f32 v165, v106, v107
    v_cvt_pk_bf16_f32 v166, v108, v109
    v_cvt_pk_bf16_f32 v167, v110, v111
    v_cvt_pk_bf16_f32 v168, v112, v113
    v_cvt_pk_bf16_f32 v169, v114, v115
    ds_read_b128 a[128:131], v1 offset:24576
    s_waitcnt lgkmcnt(5)
    v_mfma_f32_32x32x16_bf16 v[128:143], a[108:111], a[12:15], v[128:143]
    v_cvt_pk_bf16_f32 v170, v116, v117
    v_cvt_pk_bf16_f32 v171, v118, v119
    v_cvt_pk_bf16_f32 v172, v120, v121
    v_cvt_pk_bf16_f32 v173, v122, v123
    v_cvt_pk_bf16_f32 v174, v124, v125
    v_cvt_pk_bf16_f32 v175, v126, v127
    v_mul_f32 v32, v32, v21
    ds_read_b128 a[132:135], v2 offset:24576
    s_waitcnt lgkmcnt(5)
    v_mfma_f32_32x32x16_bf16 v[128:143], a[112:115], a[16:19], v[128:143]
    v_mul_f32 v33, v33, v21
    v_mul_f32 v34, v34, v21
    v_mul_f32 v35, v35, v21
    v_mul_f32 v36, v36, v21
    v_mul_f32 v37, v37, v21
    v_mul_f32 v38, v38, v21
    v_mul_f32 v39, v39, v21
    ds_read_b128 a[136:139], v3 offset:24576
    s_waitcnt lgkmcnt(5)
    v_mfma_f32_32x32x16_bf16 v[128:143], a[116:119], a[20:23], v[128:143]
    v_mul_f32 v40, v40, v21
    v_mul_f32 v41, v41, v21
    v_mul_f32 v42, v42, v21
    v_mul_f32 v43, v43, v21
    v_mul_f32 v44, v44, v21
    v_mul_f32 v45, v45, v21
    v_mul_f32 v46, v46, v21
    ds_read_b128 a[140:143], v4 offset:24576
    s_waitcnt lgkmcnt(5)
    v_mfma_f32_32x32x16_bf16 v[128:143], a[120:123], a[24:27], v[128:143]
    v_mul_f32 v47, v47, v21
    v_mul_f32 v48, v48, v21
    v_mul_f32 v49, v49, v21
    v_mul_f32 v50, v50, v21
    v_mul_f32 v51, v51, v21
    v_mul_f32 v52, v52, v21
    v_mul_f32 v53, v53, v21
    ds_read_b128 a[144:147], v5 offset:24576
    s_waitcnt lgkmcnt(5)
    v_mfma_f32_32x32x16_bf16 v[128:143], a[124:127], a[28:31], v[128:143]
    v_mul_f32 v54, v54, v21
    v_mul_f32 v55, v55, v21
    v_mul_f32 v56, v56, v21
    v_mul_f32 v57, v57, v21
    v_mul_f32 v58, v58, v21
    v_mul_f32 v59, v59, v21
    v_mul_f32 v60, v60, v21
    ds_read_b128 a[148:151], v6 offset:24576
    s_waitcnt lgkmcnt(5)
    v_mfma_f32_32x32x16_bf16 v[144:159], a[128:131], a[0:3], 0
    v_mul_f32 v61, v61, v21
    v_mul_f32 v62, v62, v21
    v_mul_f32 v63, v63, v21
    v_mul_f32 v64, v64, v21
    v_mul_f32 v65, v65, v21
    v_mul_f32 v66, v66, v21
    v_mul_f32 v67, v67, v21
    ds_read_b128 a[152:155], v7 offset:24576
    s_waitcnt lgkmcnt(5)
    v_mfma_f32_32x32x16_bf16 v[144:159], a[132:135], a[4:7], v[144:159]
    v_mul_f32 v68, v68, v21
    v_mul_f32 v69, v69, v21
    v_mul_f32 v70, v70, v21
    v_mul_f32 v71, v71, v21
    v_mul_f32 v72, v72, v21
    v_mul_f32 v73, v73, v21
    v_mul_f32 v74, v74, v21
    ds_read_b128 a[156:159], v8 offset:24576
    s_waitcnt lgkmcnt(5)
    v_mfma_f32_32x32x16_bf16 v[144:159], a[136:139], a[8:11], v[144:159]
    v_mul_f32 v75, v75, v21
    v_mul_f32 v76, v76, v21
    v_mul_f32 v77, v77, v21
    v_mul_f32 v78, v78, v21
    v_mul_f32 v79, v79, v21
    v_mul_f32 v80, v80, v21
    v_mul_f32 v81, v81, v21
    s_waitcnt lgkmcnt(4)
    v_mfma_f32_32x32x16_bf16 v[144:159], a[140:143], a[12:15], v[144:159]
    v_mul_f32 v82, v82, v21
    v_mul_f32 v83, v83, v21
    v_mul_f32 v84, v84, v21
    v_mul_f32 v85, v85, v21
    v_mul_f32 v86, v86, v21
    v_mul_f32 v87, v87, v21
    v_mul_f32 v88, v88, v21
    s_waitcnt lgkmcnt(3)
    v_mfma_f32_32x32x16_bf16 v[144:159], a[144:147], a[16:19], v[144:159]
    v_mul_f32 v89, v89, v21
    v_mul_f32 v90, v90, v21
    v_mul_f32 v91, v91, v21
    v_mul_f32 v92, v92, v21
    v_mul_f32 v93, v93, v21
    v_mul_f32 v94, v94, v21
    v_mul_f32 v95, v95, v21
    s_waitcnt lgkmcnt(2)
    v_mfma_f32_32x32x16_bf16 v[144:159], a[148:151], a[20:23], v[144:159]
    s_waitcnt lgkmcnt(1)
    v_mfma_f32_32x32x16_bf16 v[144:159], a[152:155], a[24:27], v[144:159]
    s_waitcnt lgkmcnt(0)
    v_mfma_f32_32x32x16_bf16 v[144:159], a[156:159], a[28:31], v[144:159]
    s_waitcnt vmcnt(32)
    s_barrier
    s_cmp_lt_u32 s3, 2
    s_cbranch_scc1 L_role_24
    s_add_u32 s48, s52, 16384
    s_mov_b32 m0, s48
    s_add_u32 s48, s51, 147456
    s_and_b32 s48, s48, 0x3ffff
    s_add_u32 s48, s48, s52
    buffer_load_dwordx4 v13, s[16:19], s48 offen offset:0 nt lds
    buffer_load_dwordx4 v14, s[16:19], s48 offen offset:1024 nt lds
    buffer_load_dwordx4 v15, s[16:19], s48 offen offset:2048 nt lds
    buffer_load_dwordx4 v16, s[16:19], s48 offen offset:3072 nt lds
    s_add_u32 s48, s52, 20480
    s_mov_b32 m0, s48
    s_add_u32 s48, s51, 147456
    s_and_b32 s48, s48, 0x3ffff
    s_add_u32 s48, s48, s52
    s_add_u32 s48, s48, 4096
    buffer_load_dwordx4 v13, s[16:19], s48 offen offset:0 nt lds
    buffer_load_dwordx4 v14, s[16:19], s48 offen offset:1024 nt lds
    buffer_load_dwordx4 v15, s[16:19], s48 offen offset:2048 nt lds
    buffer_load_dwordx4 v16, s[16:19], s48 offen offset:3072 nt lds
    s_add_u32 s48, s52, 114688
    s_mov_b32 m0, s48
    s_add_u32 s48, s51, 114688
    s_and_b32 s48, s48, 0x3ffff
    s_add_u32 s48, s48, s52
    buffer_load_dwordx4 v17, s[20:23], s48 offen offset:0 nt lds
    buffer_load_dwordx4 v17, s[20:23], s48 offen offset:1024 nt lds
    buffer_load_dwordx4 v17, s[20:23], s48 offen offset:2048 nt lds
    buffer_load_dwordx4 v17, s[20:23], s48 offen offset:3072 nt lds
    s_add_u32 s48, s52, 118784
    s_mov_b32 m0, s48
    s_add_u32 s48, s51, 114688
    s_and_b32 s48, s48, 0x3ffff
    s_add_u32 s48, s48, s52
    s_add_u32 s48, s48, 4096
    buffer_load_dwordx4 v17, s[20:23], s48 offen offset:0 nt lds
    buffer_load_dwordx4 v17, s[20:23], s48 offen offset:1024 nt lds
    buffer_load_dwordx4 v17, s[20:23], s48 offen offset:2048 nt lds
    buffer_load_dwordx4 v17, s[20:23], s48 offen offset:3072 nt lds
L_role_24:
    ds_read_b64_tr_b16 a[32:33], v9 offset:0
    ds_read_b64_tr_b16 a[34:35], v9 offset:2048
    ds_read_b64_tr_b16 a[36:37], v10 offset:0
    ds_read_b64_tr_b16 a[38:39], v10 offset:2048
    ds_read_b64_tr_b16 a[40:41], v11 offset:0
    ds_read_b64_tr_b16 a[42:43], v11 offset:2048
    ds_read_b64_tr_b16 a[44:45], v12 offset:0
    ds_read_b64_tr_b16 a[46:47], v12 offset:2048
    ds_read_b64_tr_b16 a[48:49], v9 offset:4096
    ds_read_b64_tr_b16 a[50:51], v9 offset:6144
    ds_read_b64_tr_b16 a[52:53], v10 offset:4096
    ds_read_b64_tr_b16 a[54:55], v10 offset:6144
    s_waitcnt lgkmcnt(10)
    v_mfma_f32_32x32x16_bf16 v[32:47], a[32:35], v[160:163], v[32:47]
    v_max3_f32 v22, v128, v129, v130
    v_max3_f32 v23, v131, v132, v133
    v_max3_f32 v22, v22, v134, v135
    v_max3_f32 v23, v23, v136, v137
    v_max3_f32 v22, v22, v138, v139
    v_max3_f32 v23, v23, v140, v141
    v_max3_f32 v22, v22, v142, v143
    ds_read_b64_tr_b16 a[56:57], v11 offset:4096
    ds_read_b64_tr_b16 a[58:59], v11 offset:6144
    s_waitcnt lgkmcnt(10)
    v_mfma_f32_32x32x16_bf16 v[48:63], a[36:39], v[160:163], v[48:63]
    v_max3_f32 v23, v23, v144, v145
    v_max3_f32 v22, v22, v146, v147
    v_max3_f32 v23, v23, v148, v149
    v_max3_f32 v22, v22, v150, v151
    v_max3_f32 v23, v23, v152, v153
    v_max3_f32 v22, v22, v154, v155
    v_max3_f32 v23, v23, v156, v157
    ds_read_b64_tr_b16 a[60:61], v12 offset:4096
    ds_read_b64_tr_b16 a[62:63], v12 offset:6144
    s_waitcnt lgkmcnt(10)
    v_mfma_f32_32x32x16_bf16 v[64:79], a[40:43], v[160:163], v[64:79]
    v_max3_f32 v22, v22, v158, v159
    v_max_f32 v22, v22, v23
    v_mov_b32 v23, v22
    s_nop 1
    v_permlane32_swap_b32 v22, v23
    s_nop 1
    v_max3_f32 v19, v18, v22, v23
    ds_read_b64_tr_b16 a[64:65], v9 offset:8192
    ds_read_b64_tr_b16 a[66:67], v9 offset:10240
    s_waitcnt lgkmcnt(10)
    v_mfma_f32_32x32x16_bf16 v[80:95], a[44:47], v[160:163], v[80:95]
    v_sub_f32 v22, v18, v19
    v_mul_f32 v24, s50, v19
    v_mul_f32 v22, s49, v22
    v_mov_b32 v18, v19
    v_exp_f32 v21, v22
    v_fma_f32 v128, v128, s49, v24
    v_fma_f32 v129, v129, s49, v24
    ds_read_b64_tr_b16 a[68:69], v10 offset:8192
    ds_read_b64_tr_b16 a[70:71], v10 offset:10240
    s_waitcnt lgkmcnt(10)
    v_mfma_f32_32x32x16_bf16 v[32:47], a[48:51], v[164:167], v[32:47]
    v_exp_f32 v128, v128
    v_fma_f32 v130, v130, s49, v24
    v_exp_f32 v129, v129
    v_fma_f32 v131, v131, s49, v24
    v_exp_f32 v130, v130
    v_fma_f32 v132, v132, s49, v24
    v_exp_f32 v131, v131
    ds_read_b64_tr_b16 a[72:73], v11 offset:8192
    ds_read_b64_tr_b16 a[74:75], v11 offset:10240
    s_waitcnt lgkmcnt(10)
    v_mfma_f32_32x32x16_bf16 v[48:63], a[52:55], v[164:167], v[48:63]
    v_fma_f32 v133, v133, s49, v24
    v_exp_f32 v132, v132
    v_fma_f32 v134, v134, s49, v24
    v_exp_f32 v133, v133
    v_fma_f32 v135, v135, s49, v24
    v_exp_f32 v134, v134
    v_fma_f32 v136, v136, s49, v24
    ds_read_b64_tr_b16 a[76:77], v12 offset:8192
    ds_read_b64_tr_b16 a[78:79], v12 offset:10240
    s_waitcnt lgkmcnt(10)
    v_mfma_f32_32x32x16_bf16 v[64:79], a[56:59], v[164:167], v[64:79]
    v_exp_f32 v135, v135
    v_fma_f32 v137, v137, s49, v24
    v_exp_f32 v136, v136
    v_fma_f32 v138, v138, s49, v24
    v_exp_f32 v137, v137
    v_fma_f32 v139, v139, s49, v24
    v_exp_f32 v138, v138
    ds_read_b64_tr_b16 a[80:81], v9 offset:12288
    ds_read_b64_tr_b16 a[82:83], v9 offset:14336
    s_waitcnt lgkmcnt(10)
    v_mfma_f32_32x32x16_bf16 v[80:95], a[60:63], v[164:167], v[80:95]
    v_fma_f32 v140, v140, s49, v24
    v_exp_f32 v139, v139
    v_fma_f32 v141, v141, s49, v24
    v_exp_f32 v140, v140
    v_fma_f32 v142, v142, s49, v24
    v_exp_f32 v141, v141
    v_fma_f32 v143, v143, s49, v24
    ds_read_b64_tr_b16 a[84:85], v10 offset:12288
    ds_read_b64_tr_b16 a[86:87], v10 offset:14336
    s_waitcnt lgkmcnt(10)
    v_mfma_f32_32x32x16_bf16 v[32:47], a[64:67], v[168:171], v[32:47]
    v_exp_f32 v142, v142
    v_fma_f32 v144, v144, s49, v24
    v_exp_f32 v143, v143
    v_fma_f32 v145, v145, s49, v24
    v_exp_f32 v144, v144
    v_fma_f32 v146, v146, s49, v24
    v_exp_f32 v145, v145
    ds_read_b64_tr_b16 a[88:89], v11 offset:12288
    ds_read_b64_tr_b16 a[90:91], v11 offset:14336
    s_waitcnt lgkmcnt(10)
    v_mfma_f32_32x32x16_bf16 v[48:63], a[68:71], v[168:171], v[48:63]
    v_fma_f32 v147, v147, s49, v24
    v_exp_f32 v146, v146
    v_fma_f32 v148, v148, s49, v24
    v_exp_f32 v147, v147
    v_fma_f32 v149, v149, s49, v24
    v_exp_f32 v148, v148
    v_fma_f32 v150, v150, s49, v24
    ds_read_b64_tr_b16 a[92:93], v12 offset:12288
    ds_read_b64_tr_b16 a[94:95], v12 offset:14336
    s_waitcnt lgkmcnt(10)
    v_mfma_f32_32x32x16_bf16 v[64:79], a[72:75], v[168:171], v[64:79]
    v_exp_f32 v149, v149
    v_fma_f32 v151, v151, s49, v24
    v_exp_f32 v150, v150
    v_fma_f32 v152, v152, s49, v24
    v_exp_f32 v151, v151
    v_fma_f32 v153, v153, s49, v24
    v_exp_f32 v152, v152
    ds_read_b128 a[96:99], v1 offset:32768
    s_waitcnt lgkmcnt(9)
    v_mfma_f32_32x32x16_bf16 v[80:95], a[76:79], v[168:171], v[80:95]
    v_fma_f32 v154, v154, s49, v24
    v_exp_f32 v153, v153
    v_fma_f32 v155, v155, s49, v24
    v_exp_f32 v154, v154
    v_fma_f32 v156, v156, s49, v24
    v_exp_f32 v155, v155
    v_fma_f32 v157, v157, s49, v24
    ds_read_b128 a[100:103], v2 offset:32768
    s_waitcnt lgkmcnt(8)
    v_mfma_f32_32x32x16_bf16 v[32:47], a[80:83], v[172:175], v[32:47]
    v_exp_f32 v156, v156
    v_fma_f32 v158, v158, s49, v24
    v_exp_f32 v157, v157
    v_fma_f32 v159, v159, s49, v24
    v_exp_f32 v158, v158
    v_exp_f32 v159, v159
    v_mul_f32 v20, v20, v21
    ds_read_b128 a[104:107], v3 offset:32768
    s_waitcnt lgkmcnt(7)
    v_mfma_f32_32x32x16_bf16 v[48:63], a[84:87], v[172:175], v[48:63]
    v_add_f32 v22, v128, v129
    v_add_f32 v23, v130, v131
    v_add_f32 v22, v22, v132
    v_add_f32 v23, v23, v133
    v_add_f32 v22, v22, v134
    v_add_f32 v23, v23, v135
    v_add_f32 v22, v22, v136
    ds_read_b128 a[108:111], v4 offset:32768
    s_waitcnt lgkmcnt(6)
    v_mfma_f32_32x32x16_bf16 v[64:79], a[88:91], v[172:175], v[64:79]
    v_add_f32 v23, v23, v137
    v_add_f32 v22, v22, v138
    v_add_f32 v23, v23, v139
    v_add_f32 v22, v22, v140
    v_add_f32 v23, v23, v141
    v_add_f32 v22, v22, v142
    v_add_f32 v23, v23, v143
    ds_read_b128 a[112:115], v5 offset:32768
    s_waitcnt lgkmcnt(5)
    v_mfma_f32_32x32x16_bf16 v[80:95], a[92:95], v[172:175], v[80:95]
    v_add_f32 v22, v22, v144
    v_add_f32 v23, v23, v145
    v_add_f32 v22, v22, v146
    v_add_f32 v23, v23, v147
    v_add_f32 v22, v22, v148
    v_add_f32 v23, v23, v149
    v_add_f32 v22, v22, v150
    ds_read_b128 a[116:119], v6 offset:32768
    s_waitcnt lgkmcnt(5)
    v_mfma_f32_32x32x16_bf16 v[96:111], a[96:99], a[0:3], 0
    v_add_f32 v23, v23, v151
    v_add_f32 v22, v22, v152
    v_add_f32 v23, v23, v153
    v_add_f32 v22, v22, v154
    v_add_f32 v23, v23, v155
    v_add_f32 v22, v22, v156
    v_add_f32 v23, v23, v157
    ds_read_b128 a[120:123], v7 offset:32768
    s_waitcnt lgkmcnt(5)
    v_mfma_f32_32x32x16_bf16 v[96:111], a[100:103], a[4:7], v[96:111]
    v_add_f32 v22, v22, v158
    v_add_f32 v23, v23, v159
    v_add_f32 v22, v22, v23
    v_add_f32 v20, v20, v22
    v_cvt_pk_bf16_f32 v160, v128, v129
    v_cvt_pk_bf16_f32 v161, v130, v131
    v_cvt_pk_bf16_f32 v162, v132, v133
    ds_read_b128 a[124:127], v8 offset:32768
    s_waitcnt lgkmcnt(5)
    v_mfma_f32_32x32x16_bf16 v[96:111], a[104:107], a[8:11], v[96:111]
    v_cvt_pk_bf16_f32 v163, v134, v135
    v_cvt_pk_bf16_f32 v164, v136, v137
    v_cvt_pk_bf16_f32 v165, v138, v139
    v_cvt_pk_bf16_f32 v166, v140, v141
    v_cvt_pk_bf16_f32 v167, v142, v143
    v_cvt_pk_bf16_f32 v168, v144, v145
    v_cvt_pk_bf16_f32 v169, v146, v147
    ds_read_b128 a[128:131], v1 offset:40960
    s_waitcnt lgkmcnt(5)
    v_mfma_f32_32x32x16_bf16 v[96:111], a[108:111], a[12:15], v[96:111]
    v_cvt_pk_bf16_f32 v170, v148, v149
    v_cvt_pk_bf16_f32 v171, v150, v151
    v_cvt_pk_bf16_f32 v172, v152, v153
    v_cvt_pk_bf16_f32 v173, v154, v155
    v_cvt_pk_bf16_f32 v174, v156, v157
    v_cvt_pk_bf16_f32 v175, v158, v159
    v_mul_f32 v32, v32, v21
    ds_read_b128 a[132:135], v2 offset:40960
    s_waitcnt lgkmcnt(5)
    v_mfma_f32_32x32x16_bf16 v[96:111], a[112:115], a[16:19], v[96:111]
    v_mul_f32 v33, v33, v21
    v_mul_f32 v34, v34, v21
    v_mul_f32 v35, v35, v21
    v_mul_f32 v36, v36, v21
    v_mul_f32 v37, v37, v21
    v_mul_f32 v38, v38, v21
    v_mul_f32 v39, v39, v21
    ds_read_b128 a[136:139], v3 offset:40960
    s_waitcnt lgkmcnt(5)
    v_mfma_f32_32x32x16_bf16 v[96:111], a[116:119], a[20:23], v[96:111]
    v_mul_f32 v40, v40, v21
    v_mul_f32 v41, v41, v21
    v_mul_f32 v42, v42, v21
    v_mul_f32 v43, v43, v21
    v_mul_f32 v44, v44, v21
    v_mul_f32 v45, v45, v21
    v_mul_f32 v46, v46, v21
    ds_read_b128 a[140:143], v4 offset:40960
    s_waitcnt lgkmcnt(5)
    v_mfma_f32_32x32x16_bf16 v[96:111], a[120:123], a[24:27], v[96:111]
    v_mul_f32 v47, v47, v21
    v_mul_f32 v48, v48, v21
    v_mul_f32 v49, v49, v21
    v_mul_f32 v50, v50, v21
    v_mul_f32 v51, v51, v21
    v_mul_f32 v52, v52, v21
    v_mul_f32 v53, v53, v21
    ds_read_b128 a[144:147], v5 offset:40960
    s_waitcnt lgkmcnt(5)
    v_mfma_f32_32x32x16_bf16 v[96:111], a[124:127], a[28:31], v[96:111]
    v_mul_f32 v54, v54, v21
    v_mul_f32 v55, v55, v21
    v_mul_f32 v56, v56, v21
    v_mul_f32 v57, v57, v21
    v_mul_f32 v58, v58, v21
    v_mul_f32 v59, v59, v21
    v_mul_f32 v60, v60, v21
    ds_read_b128 a[148:151], v6 offset:40960
    s_waitcnt lgkmcnt(5)
    v_mfma_f32_32x32x16_bf16 v[112:127], a[128:131], a[0:3], 0
    v_mul_f32 v61, v61, v21
    v_mul_f32 v62, v62, v21
    v_mul_f32 v63, v63, v21
    v_mul_f32 v64, v64, v21
    v_mul_f32 v65, v65, v21
    v_mul_f32 v66, v66, v21
    v_mul_f32 v67, v67, v21
    ds_read_b128 a[152:155], v7 offset:40960
    s_waitcnt lgkmcnt(5)
    v_mfma_f32_32x32x16_bf16 v[112:127], a[132:135], a[4:7], v[112:127]
    v_mul_f32 v68, v68, v21
    v_mul_f32 v69, v69, v21
    v_mul_f32 v70, v70, v21
    v_mul_f32 v71, v71, v21
    v_mul_f32 v72, v72, v21
    v_mul_f32 v73, v73, v21
    v_mul_f32 v74, v74, v21
    ds_read_b128 a[156:159], v8 offset:40960
    s_waitcnt lgkmcnt(5)
    v_mfma_f32_32x32x16_bf16 v[112:127], a[136:139], a[8:11], v[112:127]
    v_mul_f32 v75, v75, v21
    v_mul_f32 v76, v76, v21
    v_mul_f32 v77, v77, v21
    v_mul_f32 v78, v78, v21
    v_mul_f32 v79, v79, v21
    v_mul_f32 v80, v80, v21
    v_mul_f32 v81, v81, v21
    s_waitcnt lgkmcnt(4)
    v_mfma_f32_32x32x16_bf16 v[112:127], a[140:143], a[12:15], v[112:127]
    v_mul_f32 v82, v82, v21
    v_mul_f32 v83, v83, v21
    v_mul_f32 v84, v84, v21
    v_mul_f32 v85, v85, v21
    v_mul_f32 v86, v86, v21
    v_mul_f32 v87, v87, v21
    v_mul_f32 v88, v88, v21
    s_waitcnt lgkmcnt(3)
    v_mfma_f32_32x32x16_bf16 v[112:127], a[144:147], a[16:19], v[112:127]
    v_mul_f32 v89, v89, v21
    v_mul_f32 v90, v90, v21
    v_mul_f32 v91, v91, v21
    v_mul_f32 v92, v92, v21
    v_mul_f32 v93, v93, v21
    v_mul_f32 v94, v94, v21
    v_mul_f32 v95, v95, v21
    s_waitcnt lgkmcnt(2)
    v_mfma_f32_32x32x16_bf16 v[112:127], a[148:151], a[20:23], v[112:127]
    s_waitcnt lgkmcnt(1)
    v_mfma_f32_32x32x16_bf16 v[112:127], a[152:155], a[24:27], v[112:127]
    s_waitcnt lgkmcnt(0)
    v_mfma_f32_32x32x16_bf16 v[112:127], a[156:159], a[28:31], v[112:127]
    s_waitcnt vmcnt(32)
    s_barrier
    s_cmp_lt_u32 s3, 2
    s_cbranch_scc1 L_role_25
    s_add_u32 s48, s52, 32768
    s_mov_b32 m0, s48
    s_add_u32 s48, s51, 163840
    s_and_b32 s48, s48, 0x3ffff
    s_add_u32 s48, s48, s52
    buffer_load_dwordx4 v13, s[16:19], s48 offen offset:0 nt lds
    buffer_load_dwordx4 v14, s[16:19], s48 offen offset:1024 nt lds
    buffer_load_dwordx4 v15, s[16:19], s48 offen offset:2048 nt lds
    buffer_load_dwordx4 v16, s[16:19], s48 offen offset:3072 nt lds
    s_add_u32 s48, s52, 36864
    s_mov_b32 m0, s48
    s_add_u32 s48, s51, 163840
    s_and_b32 s48, s48, 0x3ffff
    s_add_u32 s48, s48, s52
    s_add_u32 s48, s48, 4096
    buffer_load_dwordx4 v13, s[16:19], s48 offen offset:0 nt lds
    buffer_load_dwordx4 v14, s[16:19], s48 offen offset:1024 nt lds
    buffer_load_dwordx4 v15, s[16:19], s48 offen offset:2048 nt lds
    buffer_load_dwordx4 v16, s[16:19], s48 offen offset:3072 nt lds
    s_add_u32 s48, s52, 65536
    s_mov_b32 m0, s48
    s_add_u32 s48, s51, 131072
    s_and_b32 s48, s48, 0x3ffff
    s_add_u32 s48, s48, s52
    buffer_load_dwordx4 v17, s[20:23], s48 offen offset:0 nt lds
    buffer_load_dwordx4 v17, s[20:23], s48 offen offset:1024 nt lds
    buffer_load_dwordx4 v17, s[20:23], s48 offen offset:2048 nt lds
    buffer_load_dwordx4 v17, s[20:23], s48 offen offset:3072 nt lds
    s_add_u32 s48, s52, 69632
    s_mov_b32 m0, s48
    s_add_u32 s48, s51, 131072
    s_and_b32 s48, s48, 0x3ffff
    s_add_u32 s48, s48, s52
    s_add_u32 s48, s48, 4096
    buffer_load_dwordx4 v17, s[20:23], s48 offen offset:0 nt lds
    buffer_load_dwordx4 v17, s[20:23], s48 offen offset:1024 nt lds
    buffer_load_dwordx4 v17, s[20:23], s48 offen offset:2048 nt lds
    buffer_load_dwordx4 v17, s[20:23], s48 offen offset:3072 nt lds
L_role_25:
    ds_read_b64_tr_b16 a[32:33], v9 offset:16384
    ds_read_b64_tr_b16 a[34:35], v9 offset:18432
    ds_read_b64_tr_b16 a[36:37], v10 offset:16384
    ds_read_b64_tr_b16 a[38:39], v10 offset:18432
    ds_read_b64_tr_b16 a[40:41], v11 offset:16384
    ds_read_b64_tr_b16 a[42:43], v11 offset:18432
    ds_read_b64_tr_b16 a[44:45], v12 offset:16384
    ds_read_b64_tr_b16 a[46:47], v12 offset:18432
    ds_read_b64_tr_b16 a[48:49], v9 offset:20480
    ds_read_b64_tr_b16 a[50:51], v9 offset:22528
    ds_read_b64_tr_b16 a[52:53], v10 offset:20480
    ds_read_b64_tr_b16 a[54:55], v10 offset:22528
    s_waitcnt lgkmcnt(10)
    v_mfma_f32_32x32x16_bf16 v[32:47], a[32:35], v[160:163], v[32:47]
    v_max3_f32 v22, v96, v97, v98
    v_max3_f32 v23, v99, v100, v101
    v_max3_f32 v22, v22, v102, v103
    v_max3_f32 v23, v23, v104, v105
    v_max3_f32 v22, v22, v106, v107
    v_max3_f32 v23, v23, v108, v109
    v_max3_f32 v22, v22, v110, v111
    ds_read_b64_tr_b16 a[56:57], v11 offset:20480
    ds_read_b64_tr_b16 a[58:59], v11 offset:22528
    s_waitcnt lgkmcnt(10)
    v_mfma_f32_32x32x16_bf16 v[48:63], a[36:39], v[160:163], v[48:63]
    v_max3_f32 v23, v23, v112, v113
    v_max3_f32 v22, v22, v114, v115
    v_max3_f32 v23, v23, v116, v117
    v_max3_f32 v22, v22, v118, v119
    v_max3_f32 v23, v23, v120, v121
    v_max3_f32 v22, v22, v122, v123
    v_max3_f32 v23, v23, v124, v125
    ds_read_b64_tr_b16 a[60:61], v12 offset:20480
    ds_read_b64_tr_b16 a[62:63], v12 offset:22528
    s_waitcnt lgkmcnt(10)
    v_mfma_f32_32x32x16_bf16 v[64:79], a[40:43], v[160:163], v[64:79]
    v_max3_f32 v22, v22, v126, v127
    v_max_f32 v22, v22, v23
    v_mov_b32 v23, v22
    s_nop 1
    v_permlane32_swap_b32 v22, v23
    s_nop 1
    v_max3_f32 v19, v18, v22, v23
    ds_read_b64_tr_b16 a[64:65], v9 offset:24576
    ds_read_b64_tr_b16 a[66:67], v9 offset:26624
    s_waitcnt lgkmcnt(10)
    v_mfma_f32_32x32x16_bf16 v[80:95], a[44:47], v[160:163], v[80:95]
    v_sub_f32 v22, v18, v19
    v_mul_f32 v24, s50, v19
    v_mul_f32 v22, s49, v22
    v_mov_b32 v18, v19
    v_exp_f32 v21, v22
    v_fma_f32 v96, v96, s49, v24
    v_fma_f32 v97, v97, s49, v24
    ds_read_b64_tr_b16 a[68:69], v10 offset:24576
    ds_read_b64_tr_b16 a[70:71], v10 offset:26624
    s_waitcnt lgkmcnt(10)
    v_mfma_f32_32x32x16_bf16 v[32:47], a[48:51], v[164:167], v[32:47]
    v_exp_f32 v96, v96
    v_fma_f32 v98, v98, s49, v24
    v_exp_f32 v97, v97
    v_fma_f32 v99, v99, s49, v24
    v_exp_f32 v98, v98
    v_fma_f32 v100, v100, s49, v24
    v_exp_f32 v99, v99
    ds_read_b64_tr_b16 a[72:73], v11 offset:24576
    ds_read_b64_tr_b16 a[74:75], v11 offset:26624
    s_waitcnt lgkmcnt(10)
    v_mfma_f32_32x32x16_bf16 v[48:63], a[52:55], v[164:167], v[48:63]
    v_fma_f32 v101, v101, s49, v24
    v_exp_f32 v100, v100
    v_fma_f32 v102, v102, s49, v24
    v_exp_f32 v101, v101
    v_fma_f32 v103, v103, s49, v24
    v_exp_f32 v102, v102
    v_fma_f32 v104, v104, s49, v24
    ds_read_b64_tr_b16 a[76:77], v12 offset:24576
    ds_read_b64_tr_b16 a[78:79], v12 offset:26624
    s_waitcnt lgkmcnt(10)
    v_mfma_f32_32x32x16_bf16 v[64:79], a[56:59], v[164:167], v[64:79]
    v_exp_f32 v103, v103
    v_fma_f32 v105, v105, s49, v24
    v_exp_f32 v104, v104
    v_fma_f32 v106, v106, s49, v24
    v_exp_f32 v105, v105
    v_fma_f32 v107, v107, s49, v24
    v_exp_f32 v106, v106
    ds_read_b64_tr_b16 a[80:81], v9 offset:28672
    ds_read_b64_tr_b16 a[82:83], v9 offset:30720
    s_waitcnt lgkmcnt(10)
    v_mfma_f32_32x32x16_bf16 v[80:95], a[60:63], v[164:167], v[80:95]
    v_fma_f32 v108, v108, s49, v24
    v_exp_f32 v107, v107
    v_fma_f32 v109, v109, s49, v24
    v_exp_f32 v108, v108
    v_fma_f32 v110, v110, s49, v24
    v_exp_f32 v109, v109
    v_fma_f32 v111, v111, s49, v24
    ds_read_b64_tr_b16 a[84:85], v10 offset:28672
    ds_read_b64_tr_b16 a[86:87], v10 offset:30720
    s_waitcnt lgkmcnt(10)
    v_mfma_f32_32x32x16_bf16 v[32:47], a[64:67], v[168:171], v[32:47]
    v_exp_f32 v110, v110
    v_fma_f32 v112, v112, s49, v24
    v_exp_f32 v111, v111
    v_fma_f32 v113, v113, s49, v24
    v_exp_f32 v112, v112
    v_fma_f32 v114, v114, s49, v24
    v_exp_f32 v113, v113
    ds_read_b64_tr_b16 a[88:89], v11 offset:28672
    ds_read_b64_tr_b16 a[90:91], v11 offset:30720
    s_waitcnt lgkmcnt(10)
    v_mfma_f32_32x32x16_bf16 v[48:63], a[68:71], v[168:171], v[48:63]
    v_fma_f32 v115, v115, s49, v24
    v_exp_f32 v114, v114
    v_fma_f32 v116, v116, s49, v24
    v_exp_f32 v115, v115
    v_fma_f32 v117, v117, s49, v24
    v_exp_f32 v116, v116
    v_fma_f32 v118, v118, s49, v24
    ds_read_b64_tr_b16 a[92:93], v12 offset:28672
    ds_read_b64_tr_b16 a[94:95], v12 offset:30720
    s_waitcnt lgkmcnt(10)
    v_mfma_f32_32x32x16_bf16 v[64:79], a[72:75], v[168:171], v[64:79]
    v_exp_f32 v117, v117
    v_fma_f32 v119, v119, s49, v24
    v_exp_f32 v118, v118
    v_fma_f32 v120, v120, s49, v24
    v_exp_f32 v119, v119
    v_fma_f32 v121, v121, s49, v24
    v_exp_f32 v120, v120
    ds_read_b128 a[96:99], v1 offset:49152
    s_waitcnt lgkmcnt(9)
    v_mfma_f32_32x32x16_bf16 v[80:95], a[76:79], v[168:171], v[80:95]
    v_fma_f32 v122, v122, s49, v24
    v_exp_f32 v121, v121
    v_fma_f32 v123, v123, s49, v24
    v_exp_f32 v122, v122
    v_fma_f32 v124, v124, s49, v24
    v_exp_f32 v123, v123
    v_fma_f32 v125, v125, s49, v24
    ds_read_b128 a[100:103], v2 offset:49152
    s_waitcnt lgkmcnt(8)
    v_mfma_f32_32x32x16_bf16 v[32:47], a[80:83], v[172:175], v[32:47]
    v_exp_f32 v124, v124
    v_fma_f32 v126, v126, s49, v24
    v_exp_f32 v125, v125
    v_fma_f32 v127, v127, s49, v24
    v_exp_f32 v126, v126
    v_exp_f32 v127, v127
    v_mul_f32 v20, v20, v21
    ds_read_b128 a[104:107], v3 offset:49152
    s_waitcnt lgkmcnt(7)
    v_mfma_f32_32x32x16_bf16 v[48:63], a[84:87], v[172:175], v[48:63]
    v_add_f32 v22, v96, v97
    v_add_f32 v23, v98, v99
    v_add_f32 v22, v22, v100
    v_add_f32 v23, v23, v101
    v_add_f32 v22, v22, v102
    v_add_f32 v23, v23, v103
    v_add_f32 v22, v22, v104
    ds_read_b128 a[108:111], v4 offset:49152
    s_waitcnt lgkmcnt(6)
    v_mfma_f32_32x32x16_bf16 v[64:79], a[88:91], v[172:175], v[64:79]
    v_add_f32 v23, v23, v105
    v_add_f32 v22, v22, v106
    v_add_f32 v23, v23, v107
    v_add_f32 v22, v22, v108
    v_add_f32 v23, v23, v109
    v_add_f32 v22, v22, v110
    v_add_f32 v23, v23, v111
    ds_read_b128 a[112:115], v5 offset:49152
    s_waitcnt lgkmcnt(5)
    v_mfma_f32_32x32x16_bf16 v[80:95], a[92:95], v[172:175], v[80:95]
    v_add_f32 v22, v22, v112
    v_add_f32 v23, v23, v113
    v_add_f32 v22, v22, v114
    v_add_f32 v23, v23, v115
    v_add_f32 v22, v22, v116
    v_add_f32 v23, v23, v117
    v_add_f32 v22, v22, v118
    ds_read_b128 a[116:119], v6 offset:49152
    s_waitcnt lgkmcnt(5)
    v_mfma_f32_32x32x16_bf16 v[128:143], a[96:99], a[0:3], 0
    v_add_f32 v23, v23, v119
    v_add_f32 v22, v22, v120
    v_add_f32 v23, v23, v121
    v_add_f32 v22, v22, v122
    v_add_f32 v23, v23, v123
    v_add_f32 v22, v22, v124
    v_add_f32 v23, v23, v125
    ds_read_b128 a[120:123], v7 offset:49152
    s_waitcnt lgkmcnt(5)
    v_mfma_f32_32x32x16_bf16 v[128:143], a[100:103], a[4:7], v[128:143]
    v_add_f32 v22, v22, v126
    v_add_f32 v23, v23, v127
    v_add_f32 v22, v22, v23
    v_add_f32 v20, v20, v22
    v_cvt_pk_bf16_f32 v160, v96, v97
    v_cvt_pk_bf16_f32 v161, v98, v99
    v_cvt_pk_bf16_f32 v162, v100, v101
    ds_read_b128 a[124:127], v8 offset:49152
    s_waitcnt lgkmcnt(5)
    v_mfma_f32_32x32x16_bf16 v[128:143], a[104:107], a[8:11], v[128:143]
    v_cvt_pk_bf16_f32 v163, v102, v103
    v_cvt_pk_bf16_f32 v164, v104, v105
    v_cvt_pk_bf16_f32 v165, v106, v107
    v_cvt_pk_bf16_f32 v166, v108, v109
    v_cvt_pk_bf16_f32 v167, v110, v111
    v_cvt_pk_bf16_f32 v168, v112, v113
    v_cvt_pk_bf16_f32 v169, v114, v115
    ds_read_b128 a[128:131], v1 offset:57344
    s_waitcnt lgkmcnt(5)
    v_mfma_f32_32x32x16_bf16 v[128:143], a[108:111], a[12:15], v[128:143]
    v_cvt_pk_bf16_f32 v170, v116, v117
    v_cvt_pk_bf16_f32 v171, v118, v119
    v_cvt_pk_bf16_f32 v172, v120, v121
    v_cvt_pk_bf16_f32 v173, v122, v123
    v_cvt_pk_bf16_f32 v174, v124, v125
    v_cvt_pk_bf16_f32 v175, v126, v127
    v_mul_f32 v32, v32, v21
    ds_read_b128 a[132:135], v2 offset:57344
    s_waitcnt lgkmcnt(5)
    v_mfma_f32_32x32x16_bf16 v[128:143], a[112:115], a[16:19], v[128:143]
    v_mul_f32 v33, v33, v21
    v_mul_f32 v34, v34, v21
    v_mul_f32 v35, v35, v21
    v_mul_f32 v36, v36, v21
    v_mul_f32 v37, v37, v21
    v_mul_f32 v38, v38, v21
    v_mul_f32 v39, v39, v21
    ds_read_b128 a[136:139], v3 offset:57344
    s_waitcnt lgkmcnt(5)
    v_mfma_f32_32x32x16_bf16 v[128:143], a[116:119], a[20:23], v[128:143]
    v_mul_f32 v40, v40, v21
    v_mul_f32 v41, v41, v21
    v_mul_f32 v42, v42, v21
    v_mul_f32 v43, v43, v21
    v_mul_f32 v44, v44, v21
    v_mul_f32 v45, v45, v21
    v_mul_f32 v46, v46, v21
    ds_read_b128 a[140:143], v4 offset:57344
    s_waitcnt lgkmcnt(5)
    v_mfma_f32_32x32x16_bf16 v[128:143], a[120:123], a[24:27], v[128:143]
    v_mul_f32 v47, v47, v21
    v_mul_f32 v48, v48, v21
    v_mul_f32 v49, v49, v21
    v_mul_f32 v50, v50, v21
    v_mul_f32 v51, v51, v21
    v_mul_f32 v52, v52, v21
    v_mul_f32 v53, v53, v21
    ds_read_b128 a[144:147], v5 offset:57344
    s_waitcnt lgkmcnt(5)
    v_mfma_f32_32x32x16_bf16 v[128:143], a[124:127], a[28:31], v[128:143]
    v_mul_f32 v54, v54, v21
    v_mul_f32 v55, v55, v21
    v_mul_f32 v56, v56, v21
    v_mul_f32 v57, v57, v21
    v_mul_f32 v58, v58, v21
    v_mul_f32 v59, v59, v21
    v_mul_f32 v60, v60, v21
    ds_read_b128 a[148:151], v6 offset:57344
    s_waitcnt lgkmcnt(5)
    v_mfma_f32_32x32x16_bf16 v[144:159], a[128:131], a[0:3], 0
    v_mul_f32 v61, v61, v21
    v_mul_f32 v62, v62, v21
    v_mul_f32 v63, v63, v21
    v_mul_f32 v64, v64, v21
    v_mul_f32 v65, v65, v21
    v_mul_f32 v66, v66, v21
    v_mul_f32 v67, v67, v21
    ds_read_b128 a[152:155], v7 offset:57344
    s_waitcnt lgkmcnt(5)
    v_mfma_f32_32x32x16_bf16 v[144:159], a[132:135], a[4:7], v[144:159]
    v_mul_f32 v68, v68, v21
    v_mul_f32 v69, v69, v21
    v_mul_f32 v70, v70, v21
    v_mul_f32 v71, v71, v21
    v_mul_f32 v72, v72, v21
    v_mul_f32 v73, v73, v21
    v_mul_f32 v74, v74, v21
    ds_read_b128 a[156:159], v8 offset:57344
    s_waitcnt lgkmcnt(5)
    v_mfma_f32_32x32x16_bf16 v[144:159], a[136:139], a[8:11], v[144:159]
    v_mul_f32 v75, v75, v21
    v_mul_f32 v76, v76, v21
    v_mul_f32 v77, v77, v21
    v_mul_f32 v78, v78, v21
    v_mul_f32 v79, v79, v21
    v_mul_f32 v80, v80, v21
    v_mul_f32 v81, v81, v21
    s_waitcnt lgkmcnt(4)
    v_mfma_f32_32x32x16_bf16 v[144:159], a[140:143], a[12:15], v[144:159]
    v_mul_f32 v82, v82, v21
    v_mul_f32 v83, v83, v21
    v_mul_f32 v84, v84, v21
    v_mul_f32 v85, v85, v21
    v_mul_f32 v86, v86, v21
    v_mul_f32 v87, v87, v21
    v_mul_f32 v88, v88, v21
    s_waitcnt lgkmcnt(3)
    v_mfma_f32_32x32x16_bf16 v[144:159], a[144:147], a[16:19], v[144:159]
    v_mul_f32 v89, v89, v21
    v_mul_f32 v90, v90, v21
    v_mul_f32 v91, v91, v21
    v_mul_f32 v92, v92, v21
    v_mul_f32 v93, v93, v21
    v_mul_f32 v94, v94, v21
    v_mul_f32 v95, v95, v21
    s_waitcnt lgkmcnt(2)
    v_mfma_f32_32x32x16_bf16 v[144:159], a[148:151], a[20:23], v[144:159]
    s_waitcnt lgkmcnt(1)
    v_mfma_f32_32x32x16_bf16 v[144:159], a[152:155], a[24:27], v[144:159]
    s_waitcnt lgkmcnt(0)
    v_mfma_f32_32x32x16_bf16 v[144:159], a[156:159], a[28:31], v[144:159]
    s_waitcnt vmcnt(32)
    s_barrier
    s_cmp_lt_u32 s3, 2
    s_cbranch_scc1 L_role_26
    s_add_u32 s48, s52, 49152
    s_mov_b32 m0, s48
    s_add_u32 s48, s51, 180224
    s_and_b32 s48, s48, 0x3ffff
    s_add_u32 s48, s48, s52
    buffer_load_dwordx4 v13, s[16:19], s48 offen offset:0 nt lds
    buffer_load_dwordx4 v14, s[16:19], s48 offen offset:1024 nt lds
    buffer_load_dwordx4 v15, s[16:19], s48 offen offset:2048 nt lds
    buffer_load_dwordx4 v16, s[16:19], s48 offen offset:3072 nt lds
    s_add_u32 s48, s52, 53248
    s_mov_b32 m0, s48
    s_add_u32 s48, s51, 180224
    s_and_b32 s48, s48, 0x3ffff
    s_add_u32 s48, s48, s52
    s_add_u32 s48, s48, 4096
    buffer_load_dwordx4 v13, s[16:19], s48 offen offset:0 nt lds
    buffer_load_dwordx4 v14, s[16:19], s48 offen offset:1024 nt lds
    buffer_load_dwordx4 v15, s[16:19], s48 offen offset:2048 nt lds
    buffer_load_dwordx4 v16, s[16:19], s48 offen offset:3072 nt lds
    s_add_u32 s48, s52, 81920
    s_mov_b32 m0, s48
    s_add_u32 s48, s51, 147456
    s_and_b32 s48, s48, 0x3ffff
    s_add_u32 s48, s48, s52
    buffer_load_dwordx4 v17, s[20:23], s48 offen offset:0 nt lds
    buffer_load_dwordx4 v17, s[20:23], s48 offen offset:1024 nt lds
    buffer_load_dwordx4 v17, s[20:23], s48 offen offset:2048 nt lds
    buffer_load_dwordx4 v17, s[20:23], s48 offen offset:3072 nt lds
    s_add_u32 s48, s52, 86016
    s_mov_b32 m0, s48
    s_add_u32 s48, s51, 147456
    s_and_b32 s48, s48, 0x3ffff
    s_add_u32 s48, s48, s52
    s_add_u32 s48, s48, 4096
    buffer_load_dwordx4 v17, s[20:23], s48 offen offset:0 nt lds
    buffer_load_dwordx4 v17, s[20:23], s48 offen offset:1024 nt lds
    buffer_load_dwordx4 v17, s[20:23], s48 offen offset:2048 nt lds
    buffer_load_dwordx4 v17, s[20:23], s48 offen offset:3072 nt lds
L_role_26:
    ds_read_b64_tr_b16 a[32:33], v9 offset:32768
    ds_read_b64_tr_b16 a[34:35], v9 offset:34816
    ds_read_b64_tr_b16 a[36:37], v10 offset:32768
    ds_read_b64_tr_b16 a[38:39], v10 offset:34816
    ds_read_b64_tr_b16 a[40:41], v11 offset:32768
    ds_read_b64_tr_b16 a[42:43], v11 offset:34816
    ds_read_b64_tr_b16 a[44:45], v12 offset:32768
    ds_read_b64_tr_b16 a[46:47], v12 offset:34816
    ds_read_b64_tr_b16 a[48:49], v9 offset:36864
    ds_read_b64_tr_b16 a[50:51], v9 offset:38912
    ds_read_b64_tr_b16 a[52:53], v10 offset:36864
    ds_read_b64_tr_b16 a[54:55], v10 offset:38912
    s_waitcnt lgkmcnt(10)
    v_mfma_f32_32x32x16_bf16 v[32:47], a[32:35], v[160:163], v[32:47]
    v_max3_f32 v22, v128, v129, v130
    v_max3_f32 v23, v131, v132, v133
    v_max3_f32 v22, v22, v134, v135
    v_max3_f32 v23, v23, v136, v137
    v_max3_f32 v22, v22, v138, v139
    v_max3_f32 v23, v23, v140, v141
    v_max3_f32 v22, v22, v142, v143
    ds_read_b64_tr_b16 a[56:57], v11 offset:36864
    ds_read_b64_tr_b16 a[58:59], v11 offset:38912
    s_waitcnt lgkmcnt(10)
    v_mfma_f32_32x32x16_bf16 v[48:63], a[36:39], v[160:163], v[48:63]
    v_max3_f32 v23, v23, v144, v145
    v_max3_f32 v22, v22, v146, v147
    v_max3_f32 v23, v23, v148, v149
    v_max3_f32 v22, v22, v150, v151
    v_max3_f32 v23, v23, v152, v153
    v_max3_f32 v22, v22, v154, v155
    v_max3_f32 v23, v23, v156, v157
    ds_read_b64_tr_b16 a[60:61], v12 offset:36864
    ds_read_b64_tr_b16 a[62:63], v12 offset:38912
    s_waitcnt lgkmcnt(10)
    v_mfma_f32_32x32x16_bf16 v[64:79], a[40:43], v[160:163], v[64:79]
    v_max3_f32 v22, v22, v158, v159
    v_max_f32 v22, v22, v23
    v_mov_b32 v23, v22
    s_nop 1
    v_permlane32_swap_b32 v22, v23
    s_nop 1
    v_max3_f32 v19, v18, v22, v23
    ds_read_b64_tr_b16 a[64:65], v9 offset:40960
    ds_read_b64_tr_b16 a[66:67], v9 offset:43008
    s_waitcnt lgkmcnt(10)
    v_mfma_f32_32x32x16_bf16 v[80:95], a[44:47], v[160:163], v[80:95]
    v_sub_f32 v22, v18, v19
    v_mul_f32 v24, s50, v19
    v_mul_f32 v22, s49, v22
    v_mov_b32 v18, v19
    v_exp_f32 v21, v22
    v_fma_f32 v128, v128, s49, v24
    v_fma_f32 v129, v129, s49, v24
    ds_read_b64_tr_b16 a[68:69], v10 offset:40960
    ds_read_b64_tr_b16 a[70:71], v10 offset:43008
    s_waitcnt lgkmcnt(10)
    v_mfma_f32_32x32x16_bf16 v[32:47], a[48:51], v[164:167], v[32:47]
    v_exp_f32 v128, v128
    v_fma_f32 v130, v130, s49, v24
    v_exp_f32 v129, v129
    v_fma_f32 v131, v131, s49, v24
    v_exp_f32 v130, v130
    v_fma_f32 v132, v132, s49, v24
    v_exp_f32 v131, v131
    ds_read_b64_tr_b16 a[72:73], v11 offset:40960
    ds_read_b64_tr_b16 a[74:75], v11 offset:43008
    s_waitcnt lgkmcnt(10)
    v_mfma_f32_32x32x16_bf16 v[48:63], a[52:55], v[164:167], v[48:63]
    v_fma_f32 v133, v133, s49, v24
    v_exp_f32 v132, v132
    v_fma_f32 v134, v134, s49, v24
    v_exp_f32 v133, v133
    v_fma_f32 v135, v135, s49, v24
    v_exp_f32 v134, v134
    v_fma_f32 v136, v136, s49, v24
    ds_read_b64_tr_b16 a[76:77], v12 offset:40960
    ds_read_b64_tr_b16 a[78:79], v12 offset:43008
    s_waitcnt lgkmcnt(10)
    v_mfma_f32_32x32x16_bf16 v[64:79], a[56:59], v[164:167], v[64:79]
    v_exp_f32 v135, v135
    v_fma_f32 v137, v137, s49, v24
    v_exp_f32 v136, v136
    v_fma_f32 v138, v138, s49, v24
    v_exp_f32 v137, v137
    v_fma_f32 v139, v139, s49, v24
    v_exp_f32 v138, v138
    ds_read_b64_tr_b16 a[80:81], v9 offset:45056
    ds_read_b64_tr_b16 a[82:83], v9 offset:47104
    s_waitcnt lgkmcnt(10)
    v_mfma_f32_32x32x16_bf16 v[80:95], a[60:63], v[164:167], v[80:95]
    v_fma_f32 v140, v140, s49, v24
    v_exp_f32 v139, v139
    v_fma_f32 v141, v141, s49, v24
    v_exp_f32 v140, v140
    v_fma_f32 v142, v142, s49, v24
    v_exp_f32 v141, v141
    v_fma_f32 v143, v143, s49, v24
    ds_read_b64_tr_b16 a[84:85], v10 offset:45056
    ds_read_b64_tr_b16 a[86:87], v10 offset:47104
    s_waitcnt lgkmcnt(10)
    v_mfma_f32_32x32x16_bf16 v[32:47], a[64:67], v[168:171], v[32:47]
    v_exp_f32 v142, v142
    v_fma_f32 v144, v144, s49, v24
    v_exp_f32 v143, v143
    v_fma_f32 v145, v145, s49, v24
    v_exp_f32 v144, v144
    v_fma_f32 v146, v146, s49, v24
    v_exp_f32 v145, v145
    ds_read_b64_tr_b16 a[88:89], v11 offset:45056
    ds_read_b64_tr_b16 a[90:91], v11 offset:47104
    s_waitcnt lgkmcnt(10)
    v_mfma_f32_32x32x16_bf16 v[48:63], a[68:71], v[168:171], v[48:63]
    v_fma_f32 v147, v147, s49, v24
    v_exp_f32 v146, v146
    v_fma_f32 v148, v148, s49, v24
    v_exp_f32 v147, v147
    v_fma_f32 v149, v149, s49, v24
    v_exp_f32 v148, v148
    v_fma_f32 v150, v150, s49, v24
    ds_read_b64_tr_b16 a[92:93], v12 offset:45056
    ds_read_b64_tr_b16 a[94:95], v12 offset:47104
    s_waitcnt lgkmcnt(10)
    v_mfma_f32_32x32x16_bf16 v[64:79], a[72:75], v[168:171], v[64:79]
    v_exp_f32 v149, v149
    v_fma_f32 v151, v151, s49, v24
    v_exp_f32 v150, v150
    v_fma_f32 v152, v152, s49, v24
    v_exp_f32 v151, v151
    v_fma_f32 v153, v153, s49, v24
    v_exp_f32 v152, v152
    ds_read_b128 a[96:99], v1 offset:0
    s_waitcnt lgkmcnt(9)
    v_mfma_f32_32x32x16_bf16 v[80:95], a[76:79], v[168:171], v[80:95]
    v_fma_f32 v154, v154, s49, v24
    v_exp_f32 v153, v153
    v_fma_f32 v155, v155, s49, v24
    v_exp_f32 v154, v154
    v_fma_f32 v156, v156, s49, v24
    v_exp_f32 v155, v155
    v_fma_f32 v157, v157, s49, v24
    ds_read_b128 a[100:103], v2 offset:0
    s_waitcnt lgkmcnt(8)
    v_mfma_f32_32x32x16_bf16 v[32:47], a[80:83], v[172:175], v[32:47]
    v_exp_f32 v156, v156
    v_fma_f32 v158, v158, s49, v24
    v_exp_f32 v157, v157
    v_fma_f32 v159, v159, s49, v24
    v_exp_f32 v158, v158
    v_exp_f32 v159, v159
    v_mul_f32 v20, v20, v21
    ds_read_b128 a[104:107], v3 offset:0
    s_waitcnt lgkmcnt(7)
    v_mfma_f32_32x32x16_bf16 v[48:63], a[84:87], v[172:175], v[48:63]
    v_add_f32 v22, v128, v129
    v_add_f32 v23, v130, v131
    v_add_f32 v22, v22, v132
    v_add_f32 v23, v23, v133
    v_add_f32 v22, v22, v134
    v_add_f32 v23, v23, v135
    v_add_f32 v22, v22, v136
    ds_read_b128 a[108:111], v4 offset:0
    s_waitcnt lgkmcnt(6)
    v_mfma_f32_32x32x16_bf16 v[64:79], a[88:91], v[172:175], v[64:79]
    v_add_f32 v23, v23, v137
    v_add_f32 v22, v22, v138
    v_add_f32 v23, v23, v139
    v_add_f32 v22, v22, v140
    v_add_f32 v23, v23, v141
    v_add_f32 v22, v22, v142
    v_add_f32 v23, v23, v143
    ds_read_b128 a[112:115], v5 offset:0
    s_waitcnt lgkmcnt(5)
    v_mfma_f32_32x32x16_bf16 v[80:95], a[92:95], v[172:175], v[80:95]
    v_add_f32 v22, v22, v144
    v_add_f32 v23, v23, v145
    v_add_f32 v22, v22, v146
    v_add_f32 v23, v23, v147
    v_add_f32 v22, v22, v148
    v_add_f32 v23, v23, v149
    v_add_f32 v22, v22, v150
    ds_read_b128 a[116:119], v6 offset:0
    s_waitcnt lgkmcnt(5)
    v_mfma_f32_32x32x16_bf16 v[96:111], a[96:99], a[0:3], 0
    v_add_f32 v23, v23, v151
    v_add_f32 v22, v22, v152
    v_add_f32 v23, v23, v153
    v_add_f32 v22, v22, v154
    v_add_f32 v23, v23, v155
    v_add_f32 v22, v22, v156
    v_add_f32 v23, v23, v157
    ds_read_b128 a[120:123], v7 offset:0
    s_waitcnt lgkmcnt(5)
    v_mfma_f32_32x32x16_bf16 v[96:111], a[100:103], a[4:7], v[96:111]
    v_add_f32 v22, v22, v158
    v_add_f32 v23, v23, v159
    v_add_f32 v22, v22, v23
    v_add_f32 v20, v20, v22
    v_cvt_pk_bf16_f32 v160, v128, v129
    v_cvt_pk_bf16_f32 v161, v130, v131
    v_cvt_pk_bf16_f32 v162, v132, v133
    ds_read_b128 a[124:127], v8 offset:0
    s_waitcnt lgkmcnt(5)
    v_mfma_f32_32x32x16_bf16 v[96:111], a[104:107], a[8:11], v[96:111]
    v_cvt_pk_bf16_f32 v163, v134, v135
    v_cvt_pk_bf16_f32 v164, v136, v137
    v_cvt_pk_bf16_f32 v165, v138, v139
    v_cvt_pk_bf16_f32 v166, v140, v141
    v_cvt_pk_bf16_f32 v167, v142, v143
    v_cvt_pk_bf16_f32 v168, v144, v145
    v_cvt_pk_bf16_f32 v169, v146, v147
    ds_read_b128 a[128:131], v1 offset:8192
    s_waitcnt lgkmcnt(5)
    v_mfma_f32_32x32x16_bf16 v[96:111], a[108:111], a[12:15], v[96:111]
    v_cvt_pk_bf16_f32 v170, v148, v149
    v_cvt_pk_bf16_f32 v171, v150, v151
    v_cvt_pk_bf16_f32 v172, v152, v153
    v_cvt_pk_bf16_f32 v173, v154, v155
    v_cvt_pk_bf16_f32 v174, v156, v157
    v_cvt_pk_bf16_f32 v175, v158, v159
    v_mul_f32 v32, v32, v21
    ds_read_b128 a[132:135], v2 offset:8192
    s_waitcnt lgkmcnt(5)
    v_mfma_f32_32x32x16_bf16 v[96:111], a[112:115], a[16:19], v[96:111]
    v_mul_f32 v33, v33, v21
    v_mul_f32 v34, v34, v21
    v_mul_f32 v35, v35, v21
    v_mul_f32 v36, v36, v21
    v_mul_f32 v37, v37, v21
    v_mul_f32 v38, v38, v21
    v_mul_f32 v39, v39, v21
    ds_read_b128 a[136:139], v3 offset:8192
    s_waitcnt lgkmcnt(5)
    v_mfma_f32_32x32x16_bf16 v[96:111], a[116:119], a[20:23], v[96:111]
    v_mul_f32 v40, v40, v21
    v_mul_f32 v41, v41, v21
    v_mul_f32 v42, v42, v21
    v_mul_f32 v43, v43, v21
    v_mul_f32 v44, v44, v21
    v_mul_f32 v45, v45, v21
    v_mul_f32 v46, v46, v21
    ds_read_b128 a[140:143], v4 offset:8192
    s_waitcnt lgkmcnt(5)
    v_mfma_f32_32x32x16_bf16 v[96:111], a[120:123], a[24:27], v[96:111]
    v_mul_f32 v47, v47, v21
    v_mul_f32 v48, v48, v21
    v_mul_f32 v49, v49, v21
    v_mul_f32 v50, v50, v21
    v_mul_f32 v51, v51, v21
    v_mul_f32 v52, v52, v21
    v_mul_f32 v53, v53, v21
    ds_read_b128 a[144:147], v5 offset:8192
    s_waitcnt lgkmcnt(5)
    v_mfma_f32_32x32x16_bf16 v[96:111], a[124:127], a[28:31], v[96:111]
    v_mul_f32 v54, v54, v21
    v_mul_f32 v55, v55, v21
    v_mul_f32 v56, v56, v21
    v_mul_f32 v57, v57, v21
    v_mul_f32 v58, v58, v21
    v_mul_f32 v59, v59, v21
    v_mul_f32 v60, v60, v21
    ds_read_b128 a[148:151], v6 offset:8192
    s_waitcnt lgkmcnt(5)
    v_mfma_f32_32x32x16_bf16 v[112:127], a[128:131], a[0:3], 0
    v_mul_f32 v61, v61, v21
    v_mul_f32 v62, v62, v21
    v_mul_f32 v63, v63, v21
    v_mul_f32 v64, v64, v21
    v_mul_f32 v65, v65, v21
    v_mul_f32 v66, v66, v21
    v_mul_f32 v67, v67, v21
    ds_read_b128 a[152:155], v7 offset:8192
    s_waitcnt lgkmcnt(5)
    v_mfma_f32_32x32x16_bf16 v[112:127], a[132:135], a[4:7], v[112:127]
    v_mul_f32 v68, v68, v21
    v_mul_f32 v69, v69, v21
    v_mul_f32 v70, v70, v21
    v_mul_f32 v71, v71, v21
    v_mul_f32 v72, v72, v21
    v_mul_f32 v73, v73, v21
    v_mul_f32 v74, v74, v21
    ds_read_b128 a[156:159], v8 offset:8192
    s_waitcnt lgkmcnt(5)
    v_mfma_f32_32x32x16_bf16 v[112:127], a[136:139], a[8:11], v[112:127]
    v_mul_f32 v75, v75, v21
    v_mul_f32 v76, v76, v21
    v_mul_f32 v77, v77, v21
    v_mul_f32 v78, v78, v21
    v_mul_f32 v79, v79, v21
    v_mul_f32 v80, v80, v21
    v_mul_f32 v81, v81, v21
    s_waitcnt lgkmcnt(4)
    v_mfma_f32_32x32x16_bf16 v[112:127], a[140:143], a[12:15], v[112:127]
    v_mul_f32 v82, v82, v21
    v_mul_f32 v83, v83, v21
    v_mul_f32 v84, v84, v21
    v_mul_f32 v85, v85, v21
    v_mul_f32 v86, v86, v21
    v_mul_f32 v87, v87, v21
    v_mul_f32 v88, v88, v21
    s_waitcnt lgkmcnt(3)
    v_mfma_f32_32x32x16_bf16 v[112:127], a[144:147], a[16:19], v[112:127]
    v_mul_f32 v89, v89, v21
    v_mul_f32 v90, v90, v21
    v_mul_f32 v91, v91, v21
    v_mul_f32 v92, v92, v21
    v_mul_f32 v93, v93, v21
    v_mul_f32 v94, v94, v21
    v_mul_f32 v95, v95, v21
    s_waitcnt lgkmcnt(2)
    v_mfma_f32_32x32x16_bf16 v[112:127], a[148:151], a[20:23], v[112:127]
    s_waitcnt lgkmcnt(1)
    v_mfma_f32_32x32x16_bf16 v[112:127], a[152:155], a[24:27], v[112:127]
    s_waitcnt lgkmcnt(0)
    v_mfma_f32_32x32x16_bf16 v[112:127], a[156:159], a[28:31], v[112:127]
    s_waitcnt vmcnt(32)
    s_barrier
    s_cmp_lt_u32 s3, 2
    s_cbranch_scc1 L_role_27
    s_add_u32 s48, s52, 0
    s_mov_b32 m0, s48
    s_add_u32 s48, s51, 196608
    s_and_b32 s48, s48, 0x3ffff
    s_add_u32 s48, s48, s52
    buffer_load_dwordx4 v13, s[16:19], s48 offen offset:0 nt lds
    buffer_load_dwordx4 v14, s[16:19], s48 offen offset:1024 nt lds
    buffer_load_dwordx4 v15, s[16:19], s48 offen offset:2048 nt lds
    buffer_load_dwordx4 v16, s[16:19], s48 offen offset:3072 nt lds
    s_add_u32 s48, s52, 4096
    s_mov_b32 m0, s48
    s_add_u32 s48, s51, 196608
    s_and_b32 s48, s48, 0x3ffff
    s_add_u32 s48, s48, s52
    s_add_u32 s48, s48, 4096
    buffer_load_dwordx4 v13, s[16:19], s48 offen offset:0 nt lds
    buffer_load_dwordx4 v14, s[16:19], s48 offen offset:1024 nt lds
    buffer_load_dwordx4 v15, s[16:19], s48 offen offset:2048 nt lds
    buffer_load_dwordx4 v16, s[16:19], s48 offen offset:3072 nt lds
    s_add_u32 s48, s52, 98304
    s_mov_b32 m0, s48
    s_add_u32 s48, s51, 163840
    s_and_b32 s48, s48, 0x3ffff
    s_add_u32 s48, s48, s52
    buffer_load_dwordx4 v17, s[20:23], s48 offen offset:0 nt lds
    buffer_load_dwordx4 v17, s[20:23], s48 offen offset:1024 nt lds
    buffer_load_dwordx4 v17, s[20:23], s48 offen offset:2048 nt lds
    buffer_load_dwordx4 v17, s[20:23], s48 offen offset:3072 nt lds
    s_add_u32 s48, s52, 102400
    s_mov_b32 m0, s48
    s_add_u32 s48, s51, 163840
    s_and_b32 s48, s48, 0x3ffff
    s_add_u32 s48, s48, s52
    s_add_u32 s48, s48, 4096
    buffer_load_dwordx4 v17, s[20:23], s48 offen offset:0 nt lds
    buffer_load_dwordx4 v17, s[20:23], s48 offen offset:1024 nt lds
    buffer_load_dwordx4 v17, s[20:23], s48 offen offset:2048 nt lds
    buffer_load_dwordx4 v17, s[20:23], s48 offen offset:3072 nt lds
L_role_27:
    ds_read_b64_tr_b16 a[32:33], v9 offset:49152
    ds_read_b64_tr_b16 a[34:35], v9 offset:51200
    ds_read_b64_tr_b16 a[36:37], v10 offset:49152
    ds_read_b64_tr_b16 a[38:39], v10 offset:51200
    ds_read_b64_tr_b16 a[40:41], v11 offset:49152
    ds_read_b64_tr_b16 a[42:43], v11 offset:51200
    ds_read_b64_tr_b16 a[44:45], v12 offset:49152
    ds_read_b64_tr_b16 a[46:47], v12 offset:51200
    ds_read_b64_tr_b16 a[48:49], v9 offset:53248
    ds_read_b64_tr_b16 a[50:51], v9 offset:55296
    ds_read_b64_tr_b16 a[52:53], v10 offset:53248
    ds_read_b64_tr_b16 a[54:55], v10 offset:55296
    s_waitcnt lgkmcnt(10)
    v_mfma_f32_32x32x16_bf16 v[32:47], a[32:35], v[160:163], v[32:47]
    v_max3_f32 v22, v96, v97, v98
    v_max3_f32 v23, v99, v100, v101
    v_max3_f32 v22, v22, v102, v103
    v_max3_f32 v23, v23, v104, v105
    v_max3_f32 v22, v22, v106, v107
    v_max3_f32 v23, v23, v108, v109
    v_max3_f32 v22, v22, v110, v111
    ds_read_b64_tr_b16 a[56:57], v11 offset:53248
    ds_read_b64_tr_b16 a[58:59], v11 offset:55296
    s_waitcnt lgkmcnt(10)
    v_mfma_f32_32x32x16_bf16 v[48:63], a[36:39], v[160:163], v[48:63]
    v_max3_f32 v23, v23, v112, v113
    v_max3_f32 v22, v22, v114, v115
    v_max3_f32 v23, v23, v116, v117
    v_max3_f32 v22, v22, v118, v119
    v_max3_f32 v23, v23, v120, v121
    v_max3_f32 v22, v22, v122, v123
    v_max3_f32 v23, v23, v124, v125
    ds_read_b64_tr_b16 a[60:61], v12 offset:53248
    ds_read_b64_tr_b16 a[62:63], v12 offset:55296
    s_waitcnt lgkmcnt(10)
    v_mfma_f32_32x32x16_bf16 v[64:79], a[40:43], v[160:163], v[64:79]
    v_max3_f32 v22, v22, v126, v127
    v_max_f32 v22, v22, v23
    v_mov_b32 v23, v22
    s_nop 1
    v_permlane32_swap_b32 v22, v23
    s_nop 1
    v_max3_f32 v19, v18, v22, v23
    ds_read_b64_tr_b16 a[64:65], v9 offset:57344
    ds_read_b64_tr_b16 a[66:67], v9 offset:59392
    s_waitcnt lgkmcnt(10)
    v_mfma_f32_32x32x16_bf16 v[80:95], a[44:47], v[160:163], v[80:95]
    v_sub_f32 v22, v18, v19
    v_mul_f32 v24, s50, v19
    v_mul_f32 v22, s49, v22
    v_mov_b32 v18, v19
    v_exp_f32 v21, v22
    v_fma_f32 v96, v96, s49, v24
    v_fma_f32 v97, v97, s49, v24
    ds_read_b64_tr_b16 a[68:69], v10 offset:57344
    ds_read_b64_tr_b16 a[70:71], v10 offset:59392
    s_waitcnt lgkmcnt(10)
    v_mfma_f32_32x32x16_bf16 v[32:47], a[48:51], v[164:167], v[32:47]
    v_exp_f32 v96, v96
    v_fma_f32 v98, v98, s49, v24
    v_exp_f32 v97, v97
    v_fma_f32 v99, v99, s49, v24
    v_exp_f32 v98, v98
    v_fma_f32 v100, v100, s49, v24
    v_exp_f32 v99, v99
    ds_read_b64_tr_b16 a[72:73], v11 offset:57344
    ds_read_b64_tr_b16 a[74:75], v11 offset:59392
    s_waitcnt lgkmcnt(10)
    v_mfma_f32_32x32x16_bf16 v[48:63], a[52:55], v[164:167], v[48:63]
    v_fma_f32 v101, v101, s49, v24
    v_exp_f32 v100, v100
    v_fma_f32 v102, v102, s49, v24
    v_exp_f32 v101, v101
    v_fma_f32 v103, v103, s49, v24
    v_exp_f32 v102, v102
    v_fma_f32 v104, v104, s49, v24
    ds_read_b64_tr_b16 a[76:77], v12 offset:57344
    ds_read_b64_tr_b16 a[78:79], v12 offset:59392
    s_waitcnt lgkmcnt(10)
    v_mfma_f32_32x32x16_bf16 v[64:79], a[56:59], v[164:167], v[64:79]
    v_exp_f32 v103, v103
    v_fma_f32 v105, v105, s49, v24
    v_exp_f32 v104, v104
    v_fma_f32 v106, v106, s49, v24
    v_exp_f32 v105, v105
    v_fma_f32 v107, v107, s49, v24
    v_exp_f32 v106, v106
    ds_read_b64_tr_b16 a[80:81], v9 offset:61440
    ds_read_b64_tr_b16 a[82:83], v9 offset:63488
    s_waitcnt lgkmcnt(10)
    v_mfma_f32_32x32x16_bf16 v[80:95], a[60:63], v[164:167], v[80:95]
    v_fma_f32 v108, v108, s49, v24
    v_exp_f32 v107, v107
    v_fma_f32 v109, v109, s49, v24
    v_exp_f32 v108, v108
    v_fma_f32 v110, v110, s49, v24
    v_exp_f32 v109, v109
    v_fma_f32 v111, v111, s49, v24
    ds_read_b64_tr_b16 a[84:85], v10 offset:61440
    ds_read_b64_tr_b16 a[86:87], v10 offset:63488
    s_waitcnt lgkmcnt(10)
    v_mfma_f32_32x32x16_bf16 v[32:47], a[64:67], v[168:171], v[32:47]
    v_exp_f32 v110, v110
    v_fma_f32 v112, v112, s49, v24
    v_exp_f32 v111, v111
    v_fma_f32 v113, v113, s49, v24
    v_exp_f32 v112, v112
    v_fma_f32 v114, v114, s49, v24
    v_exp_f32 v113, v113
    ds_read_b64_tr_b16 a[88:89], v11 offset:61440
    ds_read_b64_tr_b16 a[90:91], v11 offset:63488
    s_waitcnt lgkmcnt(10)
    v_mfma_f32_32x32x16_bf16 v[48:63], a[68:71], v[168:171], v[48:63]
    v_fma_f32 v115, v115, s49, v24
    v_exp_f32 v114, v114
    v_fma_f32 v116, v116, s49, v24
    v_exp_f32 v115, v115
    v_fma_f32 v117, v117, s49, v24
    v_exp_f32 v116, v116
    v_fma_f32 v118, v118, s49, v24
    ds_read_b64_tr_b16 a[92:93], v12 offset:61440
    ds_read_b64_tr_b16 a[94:95], v12 offset:63488
    s_waitcnt lgkmcnt(10)
    v_mfma_f32_32x32x16_bf16 v[64:79], a[72:75], v[168:171], v[64:79]
    v_exp_f32 v117, v117
    v_fma_f32 v119, v119, s49, v24
    v_exp_f32 v118, v118
    v_fma_f32 v120, v120, s49, v24
    v_exp_f32 v119, v119
    v_fma_f32 v121, v121, s49, v24
    v_exp_f32 v120, v120
    ds_read_b128 a[96:99], v1 offset:16384
    s_waitcnt lgkmcnt(9)
    v_mfma_f32_32x32x16_bf16 v[80:95], a[76:79], v[168:171], v[80:95]
    v_fma_f32 v122, v122, s49, v24
    v_exp_f32 v121, v121
    v_fma_f32 v123, v123, s49, v24
    v_exp_f32 v122, v122
    v_fma_f32 v124, v124, s49, v24
    v_exp_f32 v123, v123
    v_fma_f32 v125, v125, s49, v24
    ds_read_b128 a[100:103], v2 offset:16384
    s_waitcnt lgkmcnt(8)
    v_mfma_f32_32x32x16_bf16 v[32:47], a[80:83], v[172:175], v[32:47]
    v_exp_f32 v124, v124
    v_fma_f32 v126, v126, s49, v24
    v_exp_f32 v125, v125
    v_fma_f32 v127, v127, s49, v24
    v_exp_f32 v126, v126
    v_exp_f32 v127, v127
    v_mul_f32 v20, v20, v21
    ds_read_b128 a[104:107], v3 offset:16384
    s_waitcnt lgkmcnt(7)
    v_mfma_f32_32x32x16_bf16 v[48:63], a[84:87], v[172:175], v[48:63]
    v_add_f32 v22, v96, v97
    v_add_f32 v23, v98, v99
    v_add_f32 v22, v22, v100
    v_add_f32 v23, v23, v101
    v_add_f32 v22, v22, v102
    v_add_f32 v23, v23, v103
    v_add_f32 v22, v22, v104
    ds_read_b128 a[108:111], v4 offset:16384
    s_waitcnt lgkmcnt(6)
    v_mfma_f32_32x32x16_bf16 v[64:79], a[88:91], v[172:175], v[64:79]
    v_add_f32 v23, v23, v105
    v_add_f32 v22, v22, v106
    v_add_f32 v23, v23, v107
    v_add_f32 v22, v22, v108
    v_add_f32 v23, v23, v109
    v_add_f32 v22, v22, v110
    v_add_f32 v23, v23, v111
    ds_read_b128 a[112:115], v5 offset:16384
    s_waitcnt lgkmcnt(5)
    v_mfma_f32_32x32x16_bf16 v[80:95], a[92:95], v[172:175], v[80:95]
    v_add_f32 v22, v22, v112
    v_add_f32 v23, v23, v113
    v_add_f32 v22, v22, v114
    v_add_f32 v23, v23, v115
    v_add_f32 v22, v22, v116
    v_add_f32 v23, v23, v117
    v_add_f32 v22, v22, v118
    ds_read_b128 a[116:119], v6 offset:16384
    s_waitcnt lgkmcnt(5)
    v_mfma_f32_32x32x16_bf16 v[128:143], a[96:99], a[0:3], 0
    v_add_f32 v23, v23, v119
    v_add_f32 v22, v22, v120
    v_add_f32 v23, v23, v121
    v_add_f32 v22, v22, v122
    v_add_f32 v23, v23, v123
    v_add_f32 v22, v22, v124
    v_add_f32 v23, v23, v125
    ds_read_b128 a[120:123], v7 offset:16384
    s_waitcnt lgkmcnt(5)
    v_mfma_f32_32x32x16_bf16 v[128:143], a[100:103], a[4:7], v[128:143]
    v_add_f32 v22, v22, v126
    v_add_f32 v23, v23, v127
    v_add_f32 v22, v22, v23
    v_add_f32 v20, v20, v22
    v_cvt_pk_bf16_f32 v160, v96, v97
    v_cvt_pk_bf16_f32 v161, v98, v99
    v_cvt_pk_bf16_f32 v162, v100, v101
    ds_read_b128 a[124:127], v8 offset:16384
    s_waitcnt lgkmcnt(5)
    v_mfma_f32_32x32x16_bf16 v[128:143], a[104:107], a[8:11], v[128:143]
    v_cvt_pk_bf16_f32 v163, v102, v103
    v_cvt_pk_bf16_f32 v164, v104, v105
    v_cvt_pk_bf16_f32 v165, v106, v107
    v_cvt_pk_bf16_f32 v166, v108, v109
    v_cvt_pk_bf16_f32 v167, v110, v111
    v_cvt_pk_bf16_f32 v168, v112, v113
    v_cvt_pk_bf16_f32 v169, v114, v115
    ds_read_b128 a[128:131], v1 offset:24576
    s_waitcnt lgkmcnt(5)
    v_mfma_f32_32x32x16_bf16 v[128:143], a[108:111], a[12:15], v[128:143]
    v_cvt_pk_bf16_f32 v170, v116, v117
    v_cvt_pk_bf16_f32 v171, v118, v119
    v_cvt_pk_bf16_f32 v172, v120, v121
    v_cvt_pk_bf16_f32 v173, v122, v123
    v_cvt_pk_bf16_f32 v174, v124, v125
    v_cvt_pk_bf16_f32 v175, v126, v127
    v_mul_f32 v32, v32, v21
    ds_read_b128 a[132:135], v2 offset:24576
    s_waitcnt lgkmcnt(5)
    v_mfma_f32_32x32x16_bf16 v[128:143], a[112:115], a[16:19], v[128:143]
    v_mul_f32 v33, v33, v21
    v_mul_f32 v34, v34, v21
    v_mul_f32 v35, v35, v21
    v_mul_f32 v36, v36, v21
    v_mul_f32 v37, v37, v21
    v_mul_f32 v38, v38, v21
    v_mul_f32 v39, v39, v21
    ds_read_b128 a[136:139], v3 offset:24576
    s_waitcnt lgkmcnt(5)
    v_mfma_f32_32x32x16_bf16 v[128:143], a[116:119], a[20:23], v[128:143]
    v_mul_f32 v40, v40, v21
    v_mul_f32 v41, v41, v21
    v_mul_f32 v42, v42, v21
    v_mul_f32 v43, v43, v21
    v_mul_f32 v44, v44, v21
    v_mul_f32 v45, v45, v21
    v_mul_f32 v46, v46, v21
    ds_read_b128 a[140:143], v4 offset:24576
    s_waitcnt lgkmcnt(5)
    v_mfma_f32_32x32x16_bf16 v[128:143], a[120:123], a[24:27], v[128:143]
    v_mul_f32 v47, v47, v21
    v_mul_f32 v48, v48, v21
    v_mul_f32 v49, v49, v21
    v_mul_f32 v50, v50, v21
    v_mul_f32 v51, v51, v21
    v_mul_f32 v52, v52, v21
    v_mul_f32 v53, v53, v21
    ds_read_b128 a[144:147], v5 offset:24576
    s_waitcnt lgkmcnt(5)
    v_mfma_f32_32x32x16_bf16 v[128:143], a[124:127], a[28:31], v[128:143]
    v_mul_f32 v54, v54, v21
    v_mul_f32 v55, v55, v21
    v_mul_f32 v56, v56, v21
    v_mul_f32 v57, v57, v21
    v_mul_f32 v58, v58, v21
    v_mul_f32 v59, v59, v21
    v_mul_f32 v60, v60, v21
    ds_read_b128 a[148:151], v6 offset:24576
    s_waitcnt lgkmcnt(5)
    v_mfma_f32_32x32x16_bf16 v[144:159], a[128:131], a[0:3], 0
    v_mul_f32 v61, v61, v21
    v_mul_f32 v62, v62, v21
    v_mul_f32 v63, v63, v21
    v_mul_f32 v64, v64, v21
    v_mul_f32 v65, v65, v21
    v_mul_f32 v66, v66, v21
    v_mul_f32 v67, v67, v21
    ds_read_b128 a[152:155], v7 offset:24576
    s_waitcnt lgkmcnt(5)
    v_mfma_f32_32x32x16_bf16 v[144:159], a[132:135], a[4:7], v[144:159]
    v_mul_f32 v68, v68, v21
    v_mul_f32 v69, v69, v21
    v_mul_f32 v70, v70, v21
    v_mul_f32 v71, v71, v21
    v_mul_f32 v72, v72, v21
    v_mul_f32 v73, v73, v21
    v_mul_f32 v74, v74, v21
    ds_read_b128 a[156:159], v8 offset:24576
    s_waitcnt lgkmcnt(5)
    v_mfma_f32_32x32x16_bf16 v[144:159], a[136:139], a[8:11], v[144:159]
    v_mul_f32 v75, v75, v21
    v_mul_f32 v76, v76, v21
    v_mul_f32 v77, v77, v21
    v_mul_f32 v78, v78, v21
    v_mul_f32 v79, v79, v21
    v_mul_f32 v80, v80, v21
    v_mul_f32 v81, v81, v21
    s_waitcnt lgkmcnt(4)
    v_mfma_f32_32x32x16_bf16 v[144:159], a[140:143], a[12:15], v[144:159]
    v_mul_f32 v82, v82, v21
    v_mul_f32 v83, v83, v21
    v_mul_f32 v84, v84, v21
    v_mul_f32 v85, v85, v21
    v_mul_f32 v86, v86, v21
    v_mul_f32 v87, v87, v21
    v_mul_f32 v88, v88, v21
    s_waitcnt lgkmcnt(3)
    v_mfma_f32_32x32x16_bf16 v[144:159], a[144:147], a[16:19], v[144:159]
    v_mul_f32 v89, v89, v21
    v_mul_f32 v90, v90, v21
    v_mul_f32 v91, v91, v21
    v_mul_f32 v92, v92, v21
    v_mul_f32 v93, v93, v21
    v_mul_f32 v94, v94, v21
    v_mul_f32 v95, v95, v21
    s_waitcnt lgkmcnt(2)
    v_mfma_f32_32x32x16_bf16 v[144:159], a[148:151], a[20:23], v[144:159]
    s_waitcnt lgkmcnt(1)
    v_mfma_f32_32x32x16_bf16 v[144:159], a[152:155], a[24:27], v[144:159]
    s_waitcnt lgkmcnt(0)
    v_mfma_f32_32x32x16_bf16 v[144:159], a[156:159], a[28:31], v[144:159]
    s_waitcnt vmcnt(32)
    s_barrier
    s_cmp_lt_u32 s3, 2
    s_cbranch_scc1 L_role_28
    s_add_u32 s48, s52, 16384
    s_mov_b32 m0, s48
    s_add_u32 s48, s51, 212992
    s_and_b32 s48, s48, 0x3ffff
    s_add_u32 s48, s48, s52
    buffer_load_dwordx4 v13, s[16:19], s48 offen offset:0 nt lds
    buffer_load_dwordx4 v14, s[16:19], s48 offen offset:1024 nt lds
    buffer_load_dwordx4 v15, s[16:19], s48 offen offset:2048 nt lds
    buffer_load_dwordx4 v16, s[16:19], s48 offen offset:3072 nt lds
    s_add_u32 s48, s52, 20480
    s_mov_b32 m0, s48
    s_add_u32 s48, s51, 212992
    s_and_b32 s48, s48, 0x3ffff
    s_add_u32 s48, s48, s52
    s_add_u32 s48, s48, 4096
    buffer_load_dwordx4 v13, s[16:19], s48 offen offset:0 nt lds
    buffer_load_dwordx4 v14, s[16:19], s48 offen offset:1024 nt lds
    buffer_load_dwordx4 v15, s[16:19], s48 offen offset:2048 nt lds
    buffer_load_dwordx4 v16, s[16:19], s48 offen offset:3072 nt lds
    s_add_u32 s48, s52, 114688
    s_mov_b32 m0, s48
    s_add_u32 s48, s51, 180224
    s_and_b32 s48, s48, 0x3ffff
    s_add_u32 s48, s48, s52
    buffer_load_dwordx4 v17, s[20:23], s48 offen offset:0 nt lds
    buffer_load_dwordx4 v17, s[20:23], s48 offen offset:1024 nt lds
    buffer_load_dwordx4 v17, s[20:23], s48 offen offset:2048 nt lds
    buffer_load_dwordx4 v17, s[20:23], s48 offen offset:3072 nt lds
    s_add_u32 s48, s52, 118784
    s_mov_b32 m0, s48
    s_add_u32 s48, s51, 180224
    s_and_b32 s48, s48, 0x3ffff
    s_add_u32 s48, s48, s52
    s_add_u32 s48, s48, 4096
    buffer_load_dwordx4 v17, s[20:23], s48 offen offset:0 nt lds
    buffer_load_dwordx4 v17, s[20:23], s48 offen offset:1024 nt lds
    buffer_load_dwordx4 v17, s[20:23], s48 offen offset:2048 nt lds
    buffer_load_dwordx4 v17, s[20:23], s48 offen offset:3072 nt lds
L_role_28:
    ds_read_b64_tr_b16 a[32:33], v9 offset:0
    ds_read_b64_tr_b16 a[34:35], v9 offset:2048
    ds_read_b64_tr_b16 a[36:37], v10 offset:0
    ds_read_b64_tr_b16 a[38:39], v10 offset:2048
    ds_read_b64_tr_b16 a[40:41], v11 offset:0
    ds_read_b64_tr_b16 a[42:43], v11 offset:2048
    ds_read_b64_tr_b16 a[44:45], v12 offset:0
    ds_read_b64_tr_b16 a[46:47], v12 offset:2048
    ds_read_b64_tr_b16 a[48:49], v9 offset:4096
    ds_read_b64_tr_b16 a[50:51], v9 offset:6144
    ds_read_b64_tr_b16 a[52:53], v10 offset:4096
    ds_read_b64_tr_b16 a[54:55], v10 offset:6144
    s_waitcnt lgkmcnt(10)
    v_mfma_f32_32x32x16_bf16 v[32:47], a[32:35], v[160:163], v[32:47]
    v_max3_f32 v22, v128, v129, v130
    v_max3_f32 v23, v131, v132, v133
    v_max3_f32 v22, v22, v134, v135
    v_max3_f32 v23, v23, v136, v137
    v_max3_f32 v22, v22, v138, v139
    v_max3_f32 v23, v23, v140, v141
    v_max3_f32 v22, v22, v142, v143
    ds_read_b64_tr_b16 a[56:57], v11 offset:4096
    ds_read_b64_tr_b16 a[58:59], v11 offset:6144
    s_waitcnt lgkmcnt(10)
    v_mfma_f32_32x32x16_bf16 v[48:63], a[36:39], v[160:163], v[48:63]
    v_max3_f32 v23, v23, v144, v145
    v_max3_f32 v22, v22, v146, v147
    v_max3_f32 v23, v23, v148, v149
    v_max3_f32 v22, v22, v150, v151
    v_max3_f32 v23, v23, v152, v153
    v_max3_f32 v22, v22, v154, v155
    v_max3_f32 v23, v23, v156, v157
    ds_read_b64_tr_b16 a[60:61], v12 offset:4096
    ds_read_b64_tr_b16 a[62:63], v12 offset:6144
    s_waitcnt lgkmcnt(10)
    v_mfma_f32_32x32x16_bf16 v[64:79], a[40:43], v[160:163], v[64:79]
    v_max3_f32 v22, v22, v158, v159
    v_max_f32 v22, v22, v23
    v_mov_b32 v23, v22
    s_nop 1
    v_permlane32_swap_b32 v22, v23
    s_nop 1
    v_max3_f32 v19, v18, v22, v23
    ds_read_b64_tr_b16 a[64:65], v9 offset:8192
    ds_read_b64_tr_b16 a[66:67], v9 offset:10240
    s_waitcnt lgkmcnt(10)
    v_mfma_f32_32x32x16_bf16 v[80:95], a[44:47], v[160:163], v[80:95]
    v_sub_f32 v22, v18, v19
    v_mul_f32 v24, s50, v19
    v_mul_f32 v22, s49, v22
    v_mov_b32 v18, v19
    v_exp_f32 v21, v22
    v_fma_f32 v128, v128, s49, v24
    v_fma_f32 v129, v129, s49, v24
    ds_read_b64_tr_b16 a[68:69], v10 offset:8192
    ds_read_b64_tr_b16 a[70:71], v10 offset:10240
    s_waitcnt lgkmcnt(10)
    v_mfma_f32_32x32x16_bf16 v[32:47], a[48:51], v[164:167], v[32:47]
    v_exp_f32 v128, v128
    v_fma_f32 v130, v130, s49, v24
    v_exp_f32 v129, v129
    v_fma_f32 v131, v131, s49, v24
    v_exp_f32 v130, v130
    v_fma_f32 v132, v132, s49, v24
    v_exp_f32 v131, v131
    ds_read_b64_tr_b16 a[72:73], v11 offset:8192
    ds_read_b64_tr_b16 a[74:75], v11 offset:10240
    s_waitcnt lgkmcnt(10)
    v_mfma_f32_32x32x16_bf16 v[48:63], a[52:55], v[164:167], v[48:63]
    v_fma_f32 v133, v133, s49, v24
    v_exp_f32 v132, v132
    v_fma_f32 v134, v134, s49, v24
    v_exp_f32 v133, v133
    v_fma_f32 v135, v135, s49, v24
    v_exp_f32 v134, v134
    v_fma_f32 v136, v136, s49, v24
    ds_read_b64_tr_b16 a[76:77], v12 offset:8192
    ds_read_b64_tr_b16 a[78:79], v12 offset:10240
    s_waitcnt lgkmcnt(10)
    v_mfma_f32_32x32x16_bf16 v[64:79], a[56:59], v[164:167], v[64:79]
    v_exp_f32 v135, v135
    v_fma_f32 v137, v137, s49, v24
    v_exp_f32 v136, v136
    v_fma_f32 v138, v138, s49, v24
    v_exp_f32 v137, v137
    v_fma_f32 v139, v139, s49, v24
    v_exp_f32 v138, v138
    ds_read_b64_tr_b16 a[80:81], v9 offset:12288
    ds_read_b64_tr_b16 a[82:83], v9 offset:14336
    s_waitcnt lgkmcnt(10)
    v_mfma_f32_32x32x16_bf16 v[80:95], a[60:63], v[164:167], v[80:95]
    v_fma_f32 v140, v140, s49, v24
    v_exp_f32 v139, v139
    v_fma_f32 v141, v141, s49, v24
    v_exp_f32 v140, v140
    v_fma_f32 v142, v142, s49, v24
    v_exp_f32 v141, v141
    v_fma_f32 v143, v143, s49, v24
    ds_read_b64_tr_b16 a[84:85], v10 offset:12288
    ds_read_b64_tr_b16 a[86:87], v10 offset:14336
    s_waitcnt lgkmcnt(10)
    v_mfma_f32_32x32x16_bf16 v[32:47], a[64:67], v[168:171], v[32:47]
    v_exp_f32 v142, v142
    v_fma_f32 v144, v144, s49, v24
    v_exp_f32 v143, v143
    v_fma_f32 v145, v145, s49, v24
    v_exp_f32 v144, v144
    v_fma_f32 v146, v146, s49, v24
    v_exp_f32 v145, v145
    ds_read_b64_tr_b16 a[88:89], v11 offset:12288
    ds_read_b64_tr_b16 a[90:91], v11 offset:14336
    s_waitcnt lgkmcnt(10)
    v_mfma_f32_32x32x16_bf16 v[48:63], a[68:71], v[168:171], v[48:63]
    v_fma_f32 v147, v147, s49, v24
    v_exp_f32 v146, v146
    v_fma_f32 v148, v148, s49, v24
    v_exp_f32 v147, v147
    v_fma_f32 v149, v149, s49, v24
    v_exp_f32 v148, v148
    v_fma_f32 v150, v150, s49, v24
    ds_read_b64_tr_b16 a[92:93], v12 offset:12288
    ds_read_b64_tr_b16 a[94:95], v12 offset:14336
    s_waitcnt lgkmcnt(10)
    v_mfma_f32_32x32x16_bf16 v[64:79], a[72:75], v[168:171], v[64:79]
    v_exp_f32 v149, v149
    v_fma_f32 v151, v151, s49, v24
    v_exp_f32 v150, v150
    v_fma_f32 v152, v152, s49, v24
    v_exp_f32 v151, v151
    v_fma_f32 v153, v153, s49, v24
    v_exp_f32 v152, v152
    ds_read_b128 a[96:99], v1 offset:32768
    s_waitcnt lgkmcnt(9)
    v_mfma_f32_32x32x16_bf16 v[80:95], a[76:79], v[168:171], v[80:95]
    v_fma_f32 v154, v154, s49, v24
    v_exp_f32 v153, v153
    v_fma_f32 v155, v155, s49, v24
    v_exp_f32 v154, v154
    v_fma_f32 v156, v156, s49, v24
    v_exp_f32 v155, v155
    v_fma_f32 v157, v157, s49, v24
    ds_read_b128 a[100:103], v2 offset:32768
    s_waitcnt lgkmcnt(8)
    v_mfma_f32_32x32x16_bf16 v[32:47], a[80:83], v[172:175], v[32:47]
    v_exp_f32 v156, v156
    v_fma_f32 v158, v158, s49, v24
    v_exp_f32 v157, v157
    v_fma_f32 v159, v159, s49, v24
    v_exp_f32 v158, v158
    v_exp_f32 v159, v159
    v_mul_f32 v20, v20, v21
    ds_read_b128 a[104:107], v3 offset:32768
    s_waitcnt lgkmcnt(7)
    v_mfma_f32_32x32x16_bf16 v[48:63], a[84:87], v[172:175], v[48:63]
    v_add_f32 v22, v128, v129
    v_add_f32 v23, v130, v131
    v_add_f32 v22, v22, v132
    v_add_f32 v23, v23, v133
    v_add_f32 v22, v22, v134
    v_add_f32 v23, v23, v135
    v_add_f32 v22, v22, v136
    ds_read_b128 a[108:111], v4 offset:32768
    s_waitcnt lgkmcnt(6)
    v_mfma_f32_32x32x16_bf16 v[64:79], a[88:91], v[172:175], v[64:79]
    v_add_f32 v23, v23, v137
    v_add_f32 v22, v22, v138
    v_add_f32 v23, v23, v139
    v_add_f32 v22, v22, v140
    v_add_f32 v23, v23, v141
    v_add_f32 v22, v22, v142
    v_add_f32 v23, v23, v143
    ds_read_b128 a[112:115], v5 offset:32768
    s_waitcnt lgkmcnt(5)
    v_mfma_f32_32x32x16_bf16 v[80:95], a[92:95], v[172:175], v[80:95]
    v_add_f32 v22, v22, v144
    v_add_f32 v23, v23, v145
    v_add_f32 v22, v22, v146
    v_add_f32 v23, v23, v147
    v_add_f32 v22, v22, v148
    v_add_f32 v23, v23, v149
    v_add_f32 v22, v22, v150
    ds_read_b128 a[116:119], v6 offset:32768
    s_waitcnt lgkmcnt(5)
    v_mfma_f32_32x32x16_bf16 v[96:111], a[96:99], a[0:3], 0
    v_add_f32 v23, v23, v151
    v_add_f32 v22, v22, v152
    v_add_f32 v23, v23, v153
    v_add_f32 v22, v22, v154
    v_add_f32 v23, v23, v155
    v_add_f32 v22, v22, v156
    v_add_f32 v23, v23, v157
    ds_read_b128 a[120:123], v7 offset:32768
    s_waitcnt lgkmcnt(5)
    v_mfma_f32_32x32x16_bf16 v[96:111], a[100:103], a[4:7], v[96:111]
    v_add_f32 v22, v22, v158
    v_add_f32 v23, v23, v159
    v_add_f32 v22, v22, v23
    v_add_f32 v20, v20, v22
    v_cvt_pk_bf16_f32 v160, v128, v129
    v_cvt_pk_bf16_f32 v161, v130, v131
    v_cvt_pk_bf16_f32 v162, v132, v133
    ds_read_b128 a[124:127], v8 offset:32768
    s_waitcnt lgkmcnt(5)
    v_mfma_f32_32x32x16_bf16 v[96:111], a[104:107], a[8:11], v[96:111]
    v_cvt_pk_bf16_f32 v163, v134, v135
    v_cvt_pk_bf16_f32 v164, v136, v137
    v_cvt_pk_bf16_f32 v165, v138, v139
    v_cvt_pk_bf16_f32 v166, v140, v141
    v_cvt_pk_bf16_f32 v167, v142, v143
    v_cvt_pk_bf16_f32 v168, v144, v145
    v_cvt_pk_bf16_f32 v169, v146, v147
    ds_read_b128 a[128:131], v1 offset:40960
    s_waitcnt lgkmcnt(5)
    v_mfma_f32_32x32x16_bf16 v[96:111], a[108:111], a[12:15], v[96:111]
    v_cvt_pk_bf16_f32 v170, v148, v149
    v_cvt_pk_bf16_f32 v171, v150, v151
    v_cvt_pk_bf16_f32 v172, v152, v153
    v_cvt_pk_bf16_f32 v173, v154, v155
    v_cvt_pk_bf16_f32 v174, v156, v157
    v_cvt_pk_bf16_f32 v175, v158, v159
    v_mul_f32 v32, v32, v21
    ds_read_b128 a[132:135], v2 offset:40960
    s_waitcnt lgkmcnt(5)
    v_mfma_f32_32x32x16_bf16 v[96:111], a[112:115], a[16:19], v[96:111]
    v_mul_f32 v33, v33, v21
    v_mul_f32 v34, v34, v21
    v_mul_f32 v35, v35, v21
    v_mul_f32 v36, v36, v21
    v_mul_f32 v37, v37, v21
    v_mul_f32 v38, v38, v21
    v_mul_f32 v39, v39, v21
    ds_read_b128 a[136:139], v3 offset:40960
    s_waitcnt lgkmcnt(5)
    v_mfma_f32_32x32x16_bf16 v[96:111], a[116:119], a[20:23], v[96:111]
    v_mul_f32 v40, v40, v21
    v_mul_f32 v41, v41, v21
    v_mul_f32 v42, v42, v21
    v_mul_f32 v43, v43, v21
    v_mul_f32 v44, v44, v21
    v_mul_f32 v45, v45, v21
    v_mul_f32 v46, v46, v21
    ds_read_b128 a[140:143], v4 offset:40960
    s_waitcnt lgkmcnt(5)
    v_mfma_f32_32x32x16_bf16 v[96:111], a[120:123], a[24:27], v[96:111]
    v_mul_f32 v47, v47, v21
    v_mul_f32 v48, v48, v21
    v_mul_f32 v49, v49, v21
    v_mul_f32 v50, v50, v21
    v_mul_f32 v51, v51, v21
    v_mul_f32 v52, v52, v21
    v_mul_f32 v53, v53, v21
    ds_read_b128 a[144:147], v5 offset:40960
    s_waitcnt lgkmcnt(5)
    v_mfma_f32_32x32x16_bf16 v[96:111], a[124:127], a[28:31], v[96:111]
    v_mul_f32 v54, v54, v21
    v_mul_f32 v55, v55, v21
    v_mul_f32 v56, v56, v21
    v_mul_f32 v57, v57, v21
    v_mul_f32 v58, v58, v21
    v_mul_f32 v59, v59, v21
    v_mul_f32 v60, v60, v21
    ds_read_b128 a[148:151], v6 offset:40960
    s_waitcnt lgkmcnt(5)
    v_mfma_f32_32x32x16_bf16 v[112:127], a[128:131], a[0:3], 0
    v_mul_f32 v61, v61, v21
    v_mul_f32 v62, v62, v21
    v_mul_f32 v63, v63, v21
    v_mul_f32 v64, v64, v21
    v_mul_f32 v65, v65, v21
    v_mul_f32 v66, v66, v21
    v_mul_f32 v67, v67, v21
    ds_read_b128 a[152:155], v7 offset:40960
    s_waitcnt lgkmcnt(5)
    v_mfma_f32_32x32x16_bf16 v[112:127], a[132:135], a[4:7], v[112:127]
    v_mul_f32 v68, v68, v21
    v_mul_f32 v69, v69, v21
    v_mul_f32 v70, v70, v21
    v_mul_f32 v71, v71, v21
    v_mul_f32 v72, v72, v21
    v_mul_f32 v73, v73, v21
    v_mul_f32 v74, v74, v21
    ds_read_b128 a[156:159], v8 offset:40960
    s_waitcnt lgkmcnt(5)
    v_mfma_f32_32x32x16_bf16 v[112:127], a[136:139], a[8:11], v[112:127]
    v_mul_f32 v75, v75, v21
    v_mul_f32 v76, v76, v21
    v_mul_f32 v77, v77, v21
    v_mul_f32 v78, v78, v21
    v_mul_f32 v79, v79, v21
    v_mul_f32 v80, v80, v21
    v_mul_f32 v81, v81, v21
    s_waitcnt lgkmcnt(4)
    v_mfma_f32_32x32x16_bf16 v[112:127], a[140:143], a[12:15], v[112:127]
    v_mul_f32 v82, v82, v21
    v_mul_f32 v83, v83, v21
    v_mul_f32 v84, v84, v21
    v_mul_f32 v85, v85, v21
    v_mul_f32 v86, v86, v21
    v_mul_f32 v87, v87, v21
    v_mul_f32 v88, v88, v21
    s_waitcnt lgkmcnt(3)
    v_mfma_f32_32x32x16_bf16 v[112:127], a[144:147], a[16:19], v[112:127]
    v_mul_f32 v89, v89, v21
    v_mul_f32 v90, v90, v21
    v_mul_f32 v91, v91, v21
    v_mul_f32 v92, v92, v21
    v_mul_f32 v93, v93, v21
    v_mul_f32 v94, v94, v21
    v_mul_f32 v95, v95, v21
    s_waitcnt lgkmcnt(2)
    v_mfma_f32_32x32x16_bf16 v[112:127], a[148:151], a[20:23], v[112:127]
    s_waitcnt lgkmcnt(1)
    v_mfma_f32_32x32x16_bf16 v[112:127], a[152:155], a[24:27], v[112:127]
    s_waitcnt lgkmcnt(0)
    v_mfma_f32_32x32x16_bf16 v[112:127], a[156:159], a[28:31], v[112:127]
    s_waitcnt vmcnt(32)
    s_barrier
    s_cmp_lt_u32 s3, 2
    s_cbranch_scc1 L_role_29
    s_add_u32 s48, s52, 32768
    s_mov_b32 m0, s48
    s_add_u32 s48, s51, 229376
    s_and_b32 s48, s48, 0x3ffff
    s_add_u32 s48, s48, s52
    buffer_load_dwordx4 v13, s[16:19], s48 offen offset:0 nt lds
    buffer_load_dwordx4 v14, s[16:19], s48 offen offset:1024 nt lds
    buffer_load_dwordx4 v15, s[16:19], s48 offen offset:2048 nt lds
    buffer_load_dwordx4 v16, s[16:19], s48 offen offset:3072 nt lds
    s_add_u32 s48, s52, 36864
    s_mov_b32 m0, s48
    s_add_u32 s48, s51, 229376
    s_and_b32 s48, s48, 0x3ffff
    s_add_u32 s48, s48, s52
    s_add_u32 s48, s48, 4096
    buffer_load_dwordx4 v13, s[16:19], s48 offen offset:0 nt lds
    buffer_load_dwordx4 v14, s[16:19], s48 offen offset:1024 nt lds
    buffer_load_dwordx4 v15, s[16:19], s48 offen offset:2048 nt lds
    buffer_load_dwordx4 v16, s[16:19], s48 offen offset:3072 nt lds
    s_add_u32 s48, s52, 65536
    s_mov_b32 m0, s48
    s_add_u32 s48, s51, 196608
    s_and_b32 s48, s48, 0x3ffff
    s_add_u32 s48, s48, s52
    buffer_load_dwordx4 v17, s[20:23], s48 offen offset:0 nt lds
    buffer_load_dwordx4 v17, s[20:23], s48 offen offset:1024 nt lds
    buffer_load_dwordx4 v17, s[20:23], s48 offen offset:2048 nt lds
    buffer_load_dwordx4 v17, s[20:23], s48 offen offset:3072 nt lds
    s_add_u32 s48, s52, 69632
    s_mov_b32 m0, s48
    s_add_u32 s48, s51, 196608
    s_and_b32 s48, s48, 0x3ffff
    s_add_u32 s48, s48, s52
    s_add_u32 s48, s48, 4096
    buffer_load_dwordx4 v17, s[20:23], s48 offen offset:0 nt lds
    buffer_load_dwordx4 v17, s[20:23], s48 offen offset:1024 nt lds
    buffer_load_dwordx4 v17, s[20:23], s48 offen offset:2048 nt lds
    buffer_load_dwordx4 v17, s[20:23], s48 offen offset:3072 nt lds
L_role_29:
    ds_read_b64_tr_b16 a[32:33], v9 offset:16384
    ds_read_b64_tr_b16 a[34:35], v9 offset:18432
    ds_read_b64_tr_b16 a[36:37], v10 offset:16384
    ds_read_b64_tr_b16 a[38:39], v10 offset:18432
    ds_read_b64_tr_b16 a[40:41], v11 offset:16384
    ds_read_b64_tr_b16 a[42:43], v11 offset:18432
    ds_read_b64_tr_b16 a[44:45], v12 offset:16384
    ds_read_b64_tr_b16 a[46:47], v12 offset:18432
    ds_read_b64_tr_b16 a[48:49], v9 offset:20480
    ds_read_b64_tr_b16 a[50:51], v9 offset:22528
    ds_read_b64_tr_b16 a[52:53], v10 offset:20480
    ds_read_b64_tr_b16 a[54:55], v10 offset:22528
    s_waitcnt lgkmcnt(10)
    v_mfma_f32_32x32x16_bf16 v[32:47], a[32:35], v[160:163], v[32:47]
    v_max3_f32 v22, v96, v97, v98
    v_max3_f32 v23, v99, v100, v101
    v_max3_f32 v22, v22, v102, v103
    v_max3_f32 v23, v23, v104, v105
    v_max3_f32 v22, v22, v106, v107
    v_max3_f32 v23, v23, v108, v109
    v_max3_f32 v22, v22, v110, v111
    ds_read_b64_tr_b16 a[56:57], v11 offset:20480
    ds_read_b64_tr_b16 a[58:59], v11 offset:22528
    s_waitcnt lgkmcnt(10)
    v_mfma_f32_32x32x16_bf16 v[48:63], a[36:39], v[160:163], v[48:63]
    v_max3_f32 v23, v23, v112, v113
    v_max3_f32 v22, v22, v114, v115
    v_max3_f32 v23, v23, v116, v117
    v_max3_f32 v22, v22, v118, v119
    v_max3_f32 v23, v23, v120, v121
    v_max3_f32 v22, v22, v122, v123
    v_max3_f32 v23, v23, v124, v125
    ds_read_b64_tr_b16 a[60:61], v12 offset:20480
    ds_read_b64_tr_b16 a[62:63], v12 offset:22528
    s_waitcnt lgkmcnt(10)
    v_mfma_f32_32x32x16_bf16 v[64:79], a[40:43], v[160:163], v[64:79]
    v_max3_f32 v22, v22, v126, v127
    v_max_f32 v22, v22, v23
    v_mov_b32 v23, v22
    s_nop 1
    v_permlane32_swap_b32 v22, v23
    s_nop 1
    v_max3_f32 v19, v18, v22, v23
    ds_read_b64_tr_b16 a[64:65], v9 offset:24576
    ds_read_b64_tr_b16 a[66:67], v9 offset:26624
    s_waitcnt lgkmcnt(10)
    v_mfma_f32_32x32x16_bf16 v[80:95], a[44:47], v[160:163], v[80:95]
    v_sub_f32 v22, v18, v19
    v_mul_f32 v24, s50, v19
    v_mul_f32 v22, s49, v22
    v_mov_b32 v18, v19
    v_exp_f32 v21, v22
    v_fma_f32 v96, v96, s49, v24
    v_fma_f32 v97, v97, s49, v24
    ds_read_b64_tr_b16 a[68:69], v10 offset:24576
    ds_read_b64_tr_b16 a[70:71], v10 offset:26624
    s_waitcnt lgkmcnt(10)
    v_mfma_f32_32x32x16_bf16 v[32:47], a[48:51], v[164:167], v[32:47]
    v_exp_f32 v96, v96
    v_fma_f32 v98, v98, s49, v24
    v_exp_f32 v97, v97
    v_fma_f32 v99, v99, s49, v24
    v_exp_f32 v98, v98
    v_fma_f32 v100, v100, s49, v24
    v_exp_f32 v99, v99
    ds_read_b64_tr_b16 a[72:73], v11 offset:24576
    ds_read_b64_tr_b16 a[74:75], v11 offset:26624
    s_waitcnt lgkmcnt(10)
    v_mfma_f32_32x32x16_bf16 v[48:63], a[52:55], v[164:167], v[48:63]
    v_fma_f32 v101, v101, s49, v24
    v_exp_f32 v100, v100
    v_fma_f32 v102, v102, s49, v24
    v_exp_f32 v101, v101
    v_fma_f32 v103, v103, s49, v24
    v_exp_f32 v102, v102
    v_fma_f32 v104, v104, s49, v24
    ds_read_b64_tr_b16 a[76:77], v12 offset:24576
    ds_read_b64_tr_b16 a[78:79], v12 offset:26624
    s_waitcnt lgkmcnt(10)
    v_mfma_f32_32x32x16_bf16 v[64:79], a[56:59], v[164:167], v[64:79]
    v_exp_f32 v103, v103
    v_fma_f32 v105, v105, s49, v24
    v_exp_f32 v104, v104
    v_fma_f32 v106, v106, s49, v24
    v_exp_f32 v105, v105
    v_fma_f32 v107, v107, s49, v24
    v_exp_f32 v106, v106
    ds_read_b64_tr_b16 a[80:81], v9 offset:28672
    ds_read_b64_tr_b16 a[82:83], v9 offset:30720
    s_waitcnt lgkmcnt(10)
    v_mfma_f32_32x32x16_bf16 v[80:95], a[60:63], v[164:167], v[80:95]
    v_fma_f32 v108, v108, s49, v24
    v_exp_f32 v107, v107
    v_fma_f32 v109, v109, s49, v24
    v_exp_f32 v108, v108
    v_fma_f32 v110, v110, s49, v24
    v_exp_f32 v109, v109
    v_fma_f32 v111, v111, s49, v24
    ds_read_b64_tr_b16 a[84:85], v10 offset:28672
    ds_read_b64_tr_b16 a[86:87], v10 offset:30720
    s_waitcnt lgkmcnt(10)
    v_mfma_f32_32x32x16_bf16 v[32:47], a[64:67], v[168:171], v[32:47]
    v_exp_f32 v110, v110
    v_fma_f32 v112, v112, s49, v24
    v_exp_f32 v111, v111
    v_fma_f32 v113, v113, s49, v24
    v_exp_f32 v112, v112
    v_fma_f32 v114, v114, s49, v24
    v_exp_f32 v113, v113
    ds_read_b64_tr_b16 a[88:89], v11 offset:28672
    ds_read_b64_tr_b16 a[90:91], v11 offset:30720
    s_waitcnt lgkmcnt(10)
    v_mfma_f32_32x32x16_bf16 v[48:63], a[68:71], v[168:171], v[48:63]
    v_fma_f32 v115, v115, s49, v24
    v_exp_f32 v114, v114
    v_fma_f32 v116, v116, s49, v24
    v_exp_f32 v115, v115
    v_fma_f32 v117, v117, s49, v24
    v_exp_f32 v116, v116
    v_fma_f32 v118, v118, s49, v24
    ds_read_b64_tr_b16 a[92:93], v12 offset:28672
    ds_read_b64_tr_b16 a[94:95], v12 offset:30720
    s_waitcnt lgkmcnt(10)
    v_mfma_f32_32x32x16_bf16 v[64:79], a[72:75], v[168:171], v[64:79]
    v_exp_f32 v117, v117
    v_fma_f32 v119, v119, s49, v24
    v_exp_f32 v118, v118
    v_fma_f32 v120, v120, s49, v24
    v_exp_f32 v119, v119
    v_fma_f32 v121, v121, s49, v24
    v_exp_f32 v120, v120
    ds_read_b128 a[96:99], v1 offset:49152
    s_waitcnt lgkmcnt(9)
    v_mfma_f32_32x32x16_bf16 v[80:95], a[76:79], v[168:171], v[80:95]
    v_fma_f32 v122, v122, s49, v24
    v_exp_f32 v121, v121
    v_fma_f32 v123, v123, s49, v24
    v_exp_f32 v122, v122
    v_fma_f32 v124, v124, s49, v24
    v_exp_f32 v123, v123
    v_fma_f32 v125, v125, s49, v24
    ds_read_b128 a[100:103], v2 offset:49152
    s_waitcnt lgkmcnt(8)
    v_mfma_f32_32x32x16_bf16 v[32:47], a[80:83], v[172:175], v[32:47]
    v_exp_f32 v124, v124
    v_fma_f32 v126, v126, s49, v24
    v_exp_f32 v125, v125
    v_fma_f32 v127, v127, s49, v24
    v_exp_f32 v126, v126
    v_exp_f32 v127, v127
    v_mul_f32 v20, v20, v21
    ds_read_b128 a[104:107], v3 offset:49152
    s_waitcnt lgkmcnt(7)
    v_mfma_f32_32x32x16_bf16 v[48:63], a[84:87], v[172:175], v[48:63]
    v_add_f32 v22, v96, v97
    v_add_f32 v23, v98, v99
    v_add_f32 v22, v22, v100
    v_add_f32 v23, v23, v101
    v_add_f32 v22, v22, v102
    v_add_f32 v23, v23, v103
    v_add_f32 v22, v22, v104
    ds_read_b128 a[108:111], v4 offset:49152
    s_waitcnt lgkmcnt(6)
    v_mfma_f32_32x32x16_bf16 v[64:79], a[88:91], v[172:175], v[64:79]
    v_add_f32 v23, v23, v105
    v_add_f32 v22, v22, v106
    v_add_f32 v23, v23, v107
    v_add_f32 v22, v22, v108
    v_add_f32 v23, v23, v109
    v_add_f32 v22, v22, v110
    v_add_f32 v23, v23, v111
    ds_read_b128 a[112:115], v5 offset:49152
    s_waitcnt lgkmcnt(5)
    v_mfma_f32_32x32x16_bf16 v[80:95], a[92:95], v[172:175], v[80:95]
    v_add_f32 v22, v22, v112
    v_add_f32 v23, v23, v113
    v_add_f32 v22, v22, v114
    v_add_f32 v23, v23, v115
    v_add_f32 v22, v22, v116
    v_add_f32 v23, v23, v117
    v_add_f32 v22, v22, v118
    ds_read_b128 a[116:119], v6 offset:49152
    s_waitcnt lgkmcnt(5)
    v_mfma_f32_32x32x16_bf16 v[128:143], a[96:99], a[0:3], 0
    v_add_f32 v23, v23, v119
    v_add_f32 v22, v22, v120
    v_add_f32 v23, v23, v121
    v_add_f32 v22, v22, v122
    v_add_f32 v23, v23, v123
    v_add_f32 v22, v22, v124
    v_add_f32 v23, v23, v125
    ds_read_b128 a[120:123], v7 offset:49152
    s_waitcnt lgkmcnt(5)
    v_mfma_f32_32x32x16_bf16 v[128:143], a[100:103], a[4:7], v[128:143]
    v_add_f32 v22, v22, v126
    v_add_f32 v23, v23, v127
    v_add_f32 v22, v22, v23
    v_add_f32 v20, v20, v22
    v_cvt_pk_bf16_f32 v160, v96, v97
    v_cvt_pk_bf16_f32 v161, v98, v99
    v_cvt_pk_bf16_f32 v162, v100, v101
    ds_read_b128 a[124:127], v8 offset:49152
    s_waitcnt lgkmcnt(5)
    v_mfma_f32_32x32x16_bf16 v[128:143], a[104:107], a[8:11], v[128:143]
    v_cvt_pk_bf16_f32 v163, v102, v103
    v_cvt_pk_bf16_f32 v164, v104, v105
    v_cvt_pk_bf16_f32 v165, v106, v107
    v_cvt_pk_bf16_f32 v166, v108, v109
    v_cvt_pk_bf16_f32 v167, v110, v111
    v_cvt_pk_bf16_f32 v168, v112, v113
    v_cvt_pk_bf16_f32 v169, v114, v115
    ds_read_b128 a[128:131], v1 offset:57344
    s_waitcnt lgkmcnt(5)
    v_mfma_f32_32x32x16_bf16 v[128:143], a[108:111], a[12:15], v[128:143]
    v_cvt_pk_bf16_f32 v170, v116, v117
    v_cvt_pk_bf16_f32 v171, v118, v119
    v_cvt_pk_bf16_f32 v172, v120, v121
    v_cvt_pk_bf16_f32 v173, v122, v123
    v_cvt_pk_bf16_f32 v174, v124, v125
    v_cvt_pk_bf16_f32 v175, v126, v127
    v_mul_f32 v32, v32, v21
    ds_read_b128 a[132:135], v2 offset:57344
    s_waitcnt lgkmcnt(5)
    v_mfma_f32_32x32x16_bf16 v[128:143], a[112:115], a[16:19], v[128:143]
    v_mul_f32 v33, v33, v21
    v_mul_f32 v34, v34, v21
    v_mul_f32 v35, v35, v21
    v_mul_f32 v36, v36, v21
    v_mul_f32 v37, v37, v21
    v_mul_f32 v38, v38, v21
    v_mul_f32 v39, v39, v21
    ds_read_b128 a[136:139], v3 offset:57344
    s_waitcnt lgkmcnt(5)
    v_mfma_f32_32x32x16_bf16 v[128:143], a[116:119], a[20:23], v[128:143]
    v_mul_f32 v40, v40, v21
    v_mul_f32 v41, v41, v21
    v_mul_f32 v42, v42, v21
    v_mul_f32 v43, v43, v21
    v_mul_f32 v44, v44, v21
    v_mul_f32 v45, v45, v21
    v_mul_f32 v46, v46, v21
    ds_read_b128 a[140:143], v4 offset:57344
    s_waitcnt lgkmcnt(5)
    v_mfma_f32_32x32x16_bf16 v[128:143], a[120:123], a[24:27], v[128:143]
    v_mul_f32 v47, v47, v21
    v_mul_f32 v48, v48, v21
    v_mul_f32 v49, v49, v21
    v_mul_f32 v50, v50, v21
    v_mul_f32 v51, v51, v21
    v_mul_f32 v52, v52, v21
    v_mul_f32 v53, v53, v21
    ds_read_b128 a[144:147], v5 offset:57344
    s_waitcnt lgkmcnt(5)
    v_mfma_f32_32x32x16_bf16 v[128:143], a[124:127], a[28:31], v[128:143]
    v_mul_f32 v54, v54, v21
    v_mul_f32 v55, v55, v21
    v_mul_f32 v56, v56, v21
    v_mul_f32 v57, v57, v21
    v_mul_f32 v58, v58, v21
    v_mul_f32 v59, v59, v21
    v_mul_f32 v60, v60, v21
    ds_read_b128 a[148:151], v6 offset:57344
    s_waitcnt lgkmcnt(5)
    v_mfma_f32_32x32x16_bf16 v[144:159], a[128:131], a[0:3], 0
    v_mul_f32 v61, v61, v21
    v_mul_f32 v62, v62, v21
    v_mul_f32 v63, v63, v21
    v_mul_f32 v64, v64, v21
    v_mul_f32 v65, v65, v21
    v_mul_f32 v66, v66, v21
    v_mul_f32 v67, v67, v21
    ds_read_b128 a[152:155], v7 offset:57344
    s_waitcnt lgkmcnt(5)
    v_mfma_f32_32x32x16_bf16 v[144:159], a[132:135], a[4:7], v[144:159]
    v_mul_f32 v68, v68, v21
    v_mul_f32 v69, v69, v21
    v_mul_f32 v70, v70, v21
    v_mul_f32 v71, v71, v21
    v_mul_f32 v72, v72, v21
    v_mul_f32 v73, v73, v21
    v_mul_f32 v74, v74, v21
    ds_read_b128 a[156:159], v8 offset:57344
    s_waitcnt lgkmcnt(5)
    v_mfma_f32_32x32x16_bf16 v[144:159], a[136:139], a[8:11], v[144:159]
    v_mul_f32 v75, v75, v21
    v_mul_f32 v76, v76, v21
    v_mul_f32 v77, v77, v21
    v_mul_f32 v78, v78, v21
    v_mul_f32 v79, v79, v21
    v_mul_f32 v80, v80, v21
    v_mul_f32 v81, v81, v21
    s_waitcnt lgkmcnt(4)
    v_mfma_f32_32x32x16_bf16 v[144:159], a[140:143], a[12:15], v[144:159]
    v_mul_f32 v82, v82, v21
    v_mul_f32 v83, v83, v21
    v_mul_f32 v84, v84, v21
    v_mul_f32 v85, v85, v21
    v_mul_f32 v86, v86, v21
    v_mul_f32 v87, v87, v21
    v_mul_f32 v88, v88, v21
    s_waitcnt lgkmcnt(3)
    v_mfma_f32_32x32x16_bf16 v[144:159], a[144:147], a[16:19], v[144:159]
    v_mul_f32 v89, v89, v21
    v_mul_f32 v90, v90, v21
    v_mul_f32 v91, v91, v21
    v_mul_f32 v92, v92, v21
    v_mul_f32 v93, v93, v21
    v_mul_f32 v94, v94, v21
    v_mul_f32 v95, v95, v21
    s_waitcnt lgkmcnt(2)
    v_mfma_f32_32x32x16_bf16 v[144:159], a[148:151], a[20:23], v[144:159]
    s_waitcnt lgkmcnt(1)
    v_mfma_f32_32x32x16_bf16 v[144:159], a[152:155], a[24:27], v[144:159]
    s_waitcnt lgkmcnt(0)
    v_mfma_f32_32x32x16_bf16 v[144:159], a[156:159], a[28:31], v[144:159]
    s_waitcnt vmcnt(32)
    s_barrier
    s_cmp_lt_u32 s3, 2
    s_cbranch_scc1 L_role_30
    s_add_u32 s48, s52, 49152
    s_mov_b32 m0, s48
    s_add_u32 s48, s51, 245760
    s_and_b32 s48, s48, 0x3ffff
    s_add_u32 s48, s48, s52
    buffer_load_dwordx4 v13, s[16:19], s48 offen offset:0 nt lds
    buffer_load_dwordx4 v14, s[16:19], s48 offen offset:1024 nt lds
    buffer_load_dwordx4 v15, s[16:19], s48 offen offset:2048 nt lds
    buffer_load_dwordx4 v16, s[16:19], s48 offen offset:3072 nt lds
    s_add_u32 s48, s52, 53248
    s_mov_b32 m0, s48
    s_add_u32 s48, s51, 245760
    s_and_b32 s48, s48, 0x3ffff
    s_add_u32 s48, s48, s52
    s_add_u32 s48, s48, 4096
    buffer_load_dwordx4 v13, s[16:19], s48 offen offset:0 nt lds
    buffer_load_dwordx4 v14, s[16:19], s48 offen offset:1024 nt lds
    buffer_load_dwordx4 v15, s[16:19], s48 offen offset:2048 nt lds
    buffer_load_dwordx4 v16, s[16:19], s48 offen offset:3072 nt lds
    s_add_u32 s48, s52, 81920
    s_mov_b32 m0, s48
    s_add_u32 s48, s51, 212992
    s_and_b32 s48, s48, 0x3ffff
    s_add_u32 s48, s48, s52
    buffer_load_dwordx4 v17, s[20:23], s48 offen offset:0 nt lds
    buffer_load_dwordx4 v17, s[20:23], s48 offen offset:1024 nt lds
    buffer_load_dwordx4 v17, s[20:23], s48 offen offset:2048 nt lds
    buffer_load_dwordx4 v17, s[20:23], s48 offen offset:3072 nt lds
    s_add_u32 s48, s52, 86016
    s_mov_b32 m0, s48
    s_add_u32 s48, s51, 212992
    s_and_b32 s48, s48, 0x3ffff
    s_add_u32 s48, s48, s52
    s_add_u32 s48, s48, 4096
    buffer_load_dwordx4 v17, s[20:23], s48 offen offset:0 nt lds
    buffer_load_dwordx4 v17, s[20:23], s48 offen offset:1024 nt lds
    buffer_load_dwordx4 v17, s[20:23], s48 offen offset:2048 nt lds
    buffer_load_dwordx4 v17, s[20:23], s48 offen offset:3072 nt lds
L_role_30:
    ds_read_b64_tr_b16 a[32:33], v9 offset:32768
    ds_read_b64_tr_b16 a[34:35], v9 offset:34816
    ds_read_b64_tr_b16 a[36:37], v10 offset:32768
    ds_read_b64_tr_b16 a[38:39], v10 offset:34816
    ds_read_b64_tr_b16 a[40:41], v11 offset:32768
    ds_read_b64_tr_b16 a[42:43], v11 offset:34816
    ds_read_b64_tr_b16 a[44:45], v12 offset:32768
    ds_read_b64_tr_b16 a[46:47], v12 offset:34816
    ds_read_b64_tr_b16 a[48:49], v9 offset:36864
    ds_read_b64_tr_b16 a[50:51], v9 offset:38912
    ds_read_b64_tr_b16 a[52:53], v10 offset:36864
    ds_read_b64_tr_b16 a[54:55], v10 offset:38912
    s_waitcnt lgkmcnt(10)
    v_mfma_f32_32x32x16_bf16 v[32:47], a[32:35], v[160:163], v[32:47]
    v_max3_f32 v22, v128, v129, v130
    v_max3_f32 v23, v131, v132, v133
    v_max3_f32 v22, v22, v134, v135
    v_max3_f32 v23, v23, v136, v137
    v_max3_f32 v22, v22, v138, v139
    v_max3_f32 v23, v23, v140, v141
    v_max3_f32 v22, v22, v142, v143
    ds_read_b64_tr_b16 a[56:57], v11 offset:36864
    ds_read_b64_tr_b16 a[58:59], v11 offset:38912
    s_waitcnt lgkmcnt(10)
    v_mfma_f32_32x32x16_bf16 v[48:63], a[36:39], v[160:163], v[48:63]
    v_max3_f32 v23, v23, v144, v145
    v_max3_f32 v22, v22, v146, v147
    v_max3_f32 v23, v23, v148, v149
    v_max3_f32 v22, v22, v150, v151
    v_max3_f32 v23, v23, v152, v153
    v_max3_f32 v22, v22, v154, v155
    v_max3_f32 v23, v23, v156, v157
    ds_read_b64_tr_b16 a[60:61], v12 offset:36864
    ds_read_b64_tr_b16 a[62:63], v12 offset:38912
    s_waitcnt lgkmcnt(10)
    v_mfma_f32_32x32x16_bf16 v[64:79], a[40:43], v[160:163], v[64:79]
    v_max3_f32 v22, v22, v158, v159
    v_max_f32 v22, v22, v23
    v_mov_b32 v23, v22
    s_nop 1
    v_permlane32_swap_b32 v22, v23
    s_nop 1
    v_max3_f32 v19, v18, v22, v23
    ds_read_b64_tr_b16 a[64:65], v9 offset:40960
    ds_read_b64_tr_b16 a[66:67], v9 offset:43008
    s_waitcnt lgkmcnt(10)
    v_mfma_f32_32x32x16_bf16 v[80:95], a[44:47], v[160:163], v[80:95]
    v_sub_f32 v22, v18, v19
    v_mul_f32 v24, s50, v19
    v_mul_f32 v22, s49, v22
    v_mov_b32 v18, v19
    v_exp_f32 v21, v22
    v_fma_f32 v128, v128, s49, v24
    v_fma_f32 v129, v129, s49, v24
    ds_read_b64_tr_b16 a[68:69], v10 offset:40960
    ds_read_b64_tr_b16 a[70:71], v10 offset:43008
    s_waitcnt lgkmcnt(10)
    v_mfma_f32_32x32x16_bf16 v[32:47], a[48:51], v[164:167], v[32:47]
    v_exp_f32 v128, v128
    v_fma_f32 v130, v130, s49, v24
    v_exp_f32 v129, v129
    v_fma_f32 v131, v131, s49, v24
    v_exp_f32 v130, v130
    v_fma_f32 v132, v132, s49, v24
    v_exp_f32 v131, v131
    ds_read_b64_tr_b16 a[72:73], v11 offset:40960
    ds_read_b64_tr_b16 a[74:75], v11 offset:43008
    s_waitcnt lgkmcnt(10)
    v_mfma_f32_32x32x16_bf16 v[48:63], a[52:55], v[164:167], v[48:63]
    v_fma_f32 v133, v133, s49, v24
    v_exp_f32 v132, v132
    v_fma_f32 v134, v134, s49, v24
    v_exp_f32 v133, v133
    v_fma_f32 v135, v135, s49, v24
    v_exp_f32 v134, v134
    v_fma_f32 v136, v136, s49, v24
    ds_read_b64_tr_b16 a[76:77], v12 offset:40960
    ds_read_b64_tr_b16 a[78:79], v12 offset:43008
    s_waitcnt lgkmcnt(10)
    v_mfma_f32_32x32x16_bf16 v[64:79], a[56:59], v[164:167], v[64:79]
    v_exp_f32 v135, v135
    v_fma_f32 v137, v137, s49, v24
    v_exp_f32 v136, v136
    v_fma_f32 v138, v138, s49, v24
    v_exp_f32 v137, v137
    v_fma_f32 v139, v139, s49, v24
    v_exp_f32 v138, v138
    ds_read_b64_tr_b16 a[80:81], v9 offset:45056
    ds_read_b64_tr_b16 a[82:83], v9 offset:47104
    s_waitcnt lgkmcnt(10)
    v_mfma_f32_32x32x16_bf16 v[80:95], a[60:63], v[164:167], v[80:95]
    v_fma_f32 v140, v140, s49, v24
    v_exp_f32 v139, v139
    v_fma_f32 v141, v141, s49, v24
    v_exp_f32 v140, v140
    v_fma_f32 v142, v142, s49, v24
    v_exp_f32 v141, v141
    v_fma_f32 v143, v143, s49, v24
    ds_read_b64_tr_b16 a[84:85], v10 offset:45056
    ds_read_b64_tr_b16 a[86:87], v10 offset:47104
    s_waitcnt lgkmcnt(10)
    v_mfma_f32_32x32x16_bf16 v[32:47], a[64:67], v[168:171], v[32:47]
    v_exp_f32 v142, v142
    v_fma_f32 v144, v144, s49, v24
    v_exp_f32 v143, v143
    v_fma_f32 v145, v145, s49, v24
    v_exp_f32 v144, v144
    v_fma_f32 v146, v146, s49, v24
    v_exp_f32 v145, v145
    ds_read_b64_tr_b16 a[88:89], v11 offset:45056
    ds_read_b64_tr_b16 a[90:91], v11 offset:47104
    s_waitcnt lgkmcnt(10)
    v_mfma_f32_32x32x16_bf16 v[48:63], a[68:71], v[168:171], v[48:63]
    v_fma_f32 v147, v147, s49, v24
    v_exp_f32 v146, v146
    v_fma_f32 v148, v148, s49, v24
    v_exp_f32 v147, v147
    v_fma_f32 v149, v149, s49, v24
    v_exp_f32 v148, v148
    v_fma_f32 v150, v150, s49, v24
    ds_read_b64_tr_b16 a[92:93], v12 offset:45056
    ds_read_b64_tr_b16 a[94:95], v12 offset:47104
    s_waitcnt lgkmcnt(10)
    v_mfma_f32_32x32x16_bf16 v[64:79], a[72:75], v[168:171], v[64:79]
    v_exp_f32 v149, v149
    v_fma_f32 v151, v151, s49, v24
    v_exp_f32 v150, v150
    v_fma_f32 v152, v152, s49, v24
    v_exp_f32 v151, v151
    v_fma_f32 v153, v153, s49, v24
    v_exp_f32 v152, v152
    ds_read_b128 a[96:99], v1 offset:0
    s_waitcnt lgkmcnt(9)
    v_mfma_f32_32x32x16_bf16 v[80:95], a[76:79], v[168:171], v[80:95]
    v_fma_f32 v154, v154, s49, v24
    v_exp_f32 v153, v153
    v_fma_f32 v155, v155, s49, v24
    v_exp_f32 v154, v154
    v_fma_f32 v156, v156, s49, v24
    v_exp_f32 v155, v155
    v_fma_f32 v157, v157, s49, v24
    ds_read_b128 a[100:103], v2 offset:0
    s_waitcnt lgkmcnt(8)
    v_mfma_f32_32x32x16_bf16 v[32:47], a[80:83], v[172:175], v[32:47]
    v_exp_f32 v156, v156
    v_fma_f32 v158, v158, s49, v24
    v_exp_f32 v157, v157
    v_fma_f32 v159, v159, s49, v24
    v_exp_f32 v158, v158
    v_exp_f32 v159, v159
    v_mul_f32 v20, v20, v21
    ds_read_b128 a[104:107], v3 offset:0
    s_waitcnt lgkmcnt(7)
    v_mfma_f32_32x32x16_bf16 v[48:63], a[84:87], v[172:175], v[48:63]
    v_add_f32 v22, v128, v129
    v_add_f32 v23, v130, v131
    v_add_f32 v22, v22, v132
    v_add_f32 v23, v23, v133
    v_add_f32 v22, v22, v134
    v_add_f32 v23, v23, v135
    v_add_f32 v22, v22, v136
    ds_read_b128 a[108:111], v4 offset:0
    s_waitcnt lgkmcnt(6)
    v_mfma_f32_32x32x16_bf16 v[64:79], a[88:91], v[172:175], v[64:79]
    v_add_f32 v23, v23, v137
    v_add_f32 v22, v22, v138
    v_add_f32 v23, v23, v139
    v_add_f32 v22, v22, v140
    v_add_f32 v23, v23, v141
    v_add_f32 v22, v22, v142
    v_add_f32 v23, v23, v143
    ds_read_b128 a[112:115], v5 offset:0
    s_waitcnt lgkmcnt(5)
    v_mfma_f32_32x32x16_bf16 v[80:95], a[92:95], v[172:175], v[80:95]
    v_add_f32 v22, v22, v144
    v_add_f32 v23, v23, v145
    v_add_f32 v22, v22, v146
    v_add_f32 v23, v23, v147
    v_add_f32 v22, v22, v148
    v_add_f32 v23, v23, v149
    v_add_f32 v22, v22, v150
    ds_read_b128 a[116:119], v6 offset:0
    s_waitcnt lgkmcnt(5)
    v_mfma_f32_32x32x16_bf16 v[96:111], a[96:99], a[0:3], 0
    v_add_f32 v23, v23, v151
    v_add_f32 v22, v22, v152
    v_add_f32 v23, v23, v153
    v_add_f32 v22, v22, v154
    v_add_f32 v23, v23, v155
    v_add_f32 v22, v22, v156
    v_add_f32 v23, v23, v157
    ds_read_b128 a[120:123], v7 offset:0
    s_waitcnt lgkmcnt(5)
    v_mfma_f32_32x32x16_bf16 v[96:111], a[100:103], a[4:7], v[96:111]
    v_add_f32 v22, v22, v158
    v_add_f32 v23, v23, v159
    v_add_f32 v22, v22, v23
    v_add_f32 v20, v20, v22
    v_cvt_pk_bf16_f32 v160, v128, v129
    v_cvt_pk_bf16_f32 v161, v130, v131
    v_cvt_pk_bf16_f32 v162, v132, v133
    ds_read_b128 a[124:127], v8 offset:0
    s_waitcnt lgkmcnt(5)
    v_mfma_f32_32x32x16_bf16 v[96:111], a[104:107], a[8:11], v[96:111]
    v_cvt_pk_bf16_f32 v163, v134, v135
    v_cvt_pk_bf16_f32 v164, v136, v137
    v_cvt_pk_bf16_f32 v165, v138, v139
    v_cvt_pk_bf16_f32 v166, v140, v141
    v_cvt_pk_bf16_f32 v167, v142, v143
    v_cvt_pk_bf16_f32 v168, v144, v145
    v_cvt_pk_bf16_f32 v169, v146, v147
    ds_read_b128 a[128:131], v1 offset:8192
    s_waitcnt lgkmcnt(5)
    v_mfma_f32_32x32x16_bf16 v[96:111], a[108:111], a[12:15], v[96:111]
    v_cvt_pk_bf16_f32 v170, v148, v149
    v_cvt_pk_bf16_f32 v171, v150, v151
    v_cvt_pk_bf16_f32 v172, v152, v153
    v_cvt_pk_bf16_f32 v173, v154, v155
    v_cvt_pk_bf16_f32 v174, v156, v157
    v_cvt_pk_bf16_f32 v175, v158, v159
    v_mul_f32 v32, v32, v21
    ds_read_b128 a[132:135], v2 offset:8192
    s_waitcnt lgkmcnt(5)
    v_mfma_f32_32x32x16_bf16 v[96:111], a[112:115], a[16:19], v[96:111]
    v_mul_f32 v33, v33, v21
    v_mul_f32 v34, v34, v21
    v_mul_f32 v35, v35, v21
    v_mul_f32 v36, v36, v21
    v_mul_f32 v37, v37, v21
    v_mul_f32 v38, v38, v21
    v_mul_f32 v39, v39, v21
    ds_read_b128 a[136:139], v3 offset:8192
    s_waitcnt lgkmcnt(5)
    v_mfma_f32_32x32x16_bf16 v[96:111], a[116:119], a[20:23], v[96:111]
    v_mul_f32 v40, v40, v21
    v_mul_f32 v41, v41, v21
    v_mul_f32 v42, v42, v21
    v_mul_f32 v43, v43, v21
    v_mul_f32 v44, v44, v21
    v_mul_f32 v45, v45, v21
    v_mul_f32 v46, v46, v21
    ds_read_b128 a[140:143], v4 offset:8192
    s_waitcnt lgkmcnt(5)
    v_mfma_f32_32x32x16_bf16 v[96:111], a[120:123], a[24:27], v[96:111]
    v_mul_f32 v47, v47, v21
    v_mul_f32 v48, v48, v21
    v_mul_f32 v49, v49, v21
    v_mul_f32 v50, v50, v21
    v_mul_f32 v51, v51, v21
    v_mul_f32 v52, v52, v21
    v_mul_f32 v53, v53, v21
    ds_read_b128 a[144:147], v5 offset:8192
    s_waitcnt lgkmcnt(5)
    v_mfma_f32_32x32x16_bf16 v[96:111], a[124:127], a[28:31], v[96:111]
    v_mul_f32 v54, v54, v21
    v_mul_f32 v55, v55, v21
    v_mul_f32 v56, v56, v21
    v_mul_f32 v57, v57, v21
    v_mul_f32 v58, v58, v21
    v_mul_f32 v59, v59, v21
    v_mul_f32 v60, v60, v21
    ds_read_b128 a[148:151], v6 offset:8192
    s_waitcnt lgkmcnt(5)
    v_mfma_f32_32x32x16_bf16 v[112:127], a[128:131], a[0:3], 0
    v_mul_f32 v61, v61, v21
    v_mul_f32 v62, v62, v21
    v_mul_f32 v63, v63, v21
    v_mul_f32 v64, v64, v21
    v_mul_f32 v65, v65, v21
    v_mul_f32 v66, v66, v21
    v_mul_f32 v67, v67, v21
    ds_read_b128 a[152:155], v7 offset:8192
    s_waitcnt lgkmcnt(5)
    v_mfma_f32_32x32x16_bf16 v[112:127], a[132:135], a[4:7], v[112:127]
    v_mul_f32 v68, v68, v21
    v_mul_f32 v69, v69, v21
    v_mul_f32 v70, v70, v21
    v_mul_f32 v71, v71, v21
    v_mul_f32 v72, v72, v21
    v_mul_f32 v73, v73, v21
    v_mul_f32 v74, v74, v21
    ds_read_b128 a[156:159], v8 offset:8192
    s_waitcnt lgkmcnt(5)
    v_mfma_f32_32x32x16_bf16 v[112:127], a[136:139], a[8:11], v[112:127]
    v_mul_f32 v75, v75, v21
    v_mul_f32 v76, v76, v21
    v_mul_f32 v77, v77, v21
    v_mul_f32 v78, v78, v21
    v_mul_f32 v79, v79, v21
    v_mul_f32 v80, v80, v21
    v_mul_f32 v81, v81, v21
    s_waitcnt lgkmcnt(4)
    v_mfma_f32_32x32x16_bf16 v[112:127], a[140:143], a[12:15], v[112:127]
    v_mul_f32 v82, v82, v21
    v_mul_f32 v83, v83, v21
    v_mul_f32 v84, v84, v21
    v_mul_f32 v85, v85, v21
    v_mul_f32 v86, v86, v21
    v_mul_f32 v87, v87, v21
    v_mul_f32 v88, v88, v21
    s_waitcnt lgkmcnt(3)
    v_mfma_f32_32x32x16_bf16 v[112:127], a[144:147], a[16:19], v[112:127]
    v_mul_f32 v89, v89, v21
    v_mul_f32 v90, v90, v21
    v_mul_f32 v91, v91, v21
    v_mul_f32 v92, v92, v21
    v_mul_f32 v93, v93, v21
    v_mul_f32 v94, v94, v21
    v_mul_f32 v95, v95, v21
    s_waitcnt lgkmcnt(2)
    v_mfma_f32_32x32x16_bf16 v[112:127], a[148:151], a[20:23], v[112:127]
    s_waitcnt lgkmcnt(1)
    v_mfma_f32_32x32x16_bf16 v[112:127], a[152:155], a[24:27], v[112:127]
    s_waitcnt lgkmcnt(0)
    v_mfma_f32_32x32x16_bf16 v[112:127], a[156:159], a[28:31], v[112:127]
    s_waitcnt vmcnt(32)
    s_barrier
    s_cmp_lt_u32 s3, 2
    s_cbranch_scc1 L_role_31
    s_add_u32 s48, s52, 98304
    s_mov_b32 m0, s48
    s_add_u32 s48, s51, 229376
    s_and_b32 s48, s48, 0x3ffff
    s_add_u32 s48, s48, s52
    buffer_load_dwordx4 v17, s[20:23], s48 offen offset:0 nt lds
    buffer_load_dwordx4 v17, s[20:23], s48 offen offset:1024 nt lds
    buffer_load_dwordx4 v17, s[20:23], s48 offen offset:2048 nt lds
    buffer_load_dwordx4 v17, s[20:23], s48 offen offset:3072 nt lds
    s_add_u32 s48, s52, 102400
    s_mov_b32 m0, s48
    s_add_u32 s48, s51, 229376
    s_and_b32 s48, s48, 0x3ffff
    s_add_u32 s48, s48, s52
    s_add_u32 s48, s48, 4096
    buffer_load_dwordx4 v17, s[20:23], s48 offen offset:0 nt lds
    buffer_load_dwordx4 v17, s[20:23], s48 offen offset:1024 nt lds
    buffer_load_dwordx4 v17, s[20:23], s48 offen offset:2048 nt lds
    buffer_load_dwordx4 v17, s[20:23], s48 offen offset:3072 nt lds
L_role_31:
    ds_read_b64_tr_b16 a[32:33], v9 offset:49152
    ds_read_b64_tr_b16 a[34:35], v9 offset:51200
    ds_read_b64_tr_b16 a[36:37], v10 offset:49152
    ds_read_b64_tr_b16 a[38:39], v10 offset:51200
    ds_read_b64_tr_b16 a[40:41], v11 offset:49152
    ds_read_b64_tr_b16 a[42:43], v11 offset:51200
    ds_read_b64_tr_b16 a[44:45], v12 offset:49152
    ds_read_b64_tr_b16 a[46:47], v12 offset:51200
    ds_read_b64_tr_b16 a[48:49], v9 offset:53248
    ds_read_b64_tr_b16 a[50:51], v9 offset:55296
    ds_read_b64_tr_b16 a[52:53], v10 offset:53248
    ds_read_b64_tr_b16 a[54:55], v10 offset:55296
    s_waitcnt lgkmcnt(10)
    v_mfma_f32_32x32x16_bf16 v[32:47], a[32:35], v[160:163], v[32:47]
    v_max3_f32 v22, v96, v97, v98
    v_max3_f32 v23, v99, v100, v101
    v_max3_f32 v22, v22, v102, v103
    v_max3_f32 v23, v23, v104, v105
    v_max3_f32 v22, v22, v106, v107
    v_max3_f32 v23, v23, v108, v109
    v_max3_f32 v22, v22, v110, v111
    ds_read_b64_tr_b16 a[56:57], v11 offset:53248
    ds_read_b64_tr_b16 a[58:59], v11 offset:55296
    s_waitcnt lgkmcnt(10)
    v_mfma_f32_32x32x16_bf16 v[48:63], a[36:39], v[160:163], v[48:63]
    v_max3_f32 v23, v23, v112, v113
    v_max3_f32 v22, v22, v114, v115
    v_max3_f32 v23, v23, v116, v117
    v_max3_f32 v22, v22, v118, v119
    v_max3_f32 v23, v23, v120, v121
    v_max3_f32 v22, v22, v122, v123
    v_max3_f32 v23, v23, v124, v125
    ds_read_b64_tr_b16 a[60:61], v12 offset:53248
    ds_read_b64_tr_b16 a[62:63], v12 offset:55296
    s_waitcnt lgkmcnt(10)
    v_mfma_f32_32x32x16_bf16 v[64:79], a[40:43], v[160:163], v[64:79]
    v_max3_f32 v22, v22, v126, v127
    v_max_f32 v22, v22, v23
    v_mov_b32 v23, v22
    s_nop 1
    v_permlane32_swap_b32 v22, v23
    s_nop 1
    v_max3_f32 v19, v18, v22, v23
    ds_read_b64_tr_b16 a[64:65], v9 offset:57344
    ds_read_b64_tr_b16 a[66:67], v9 offset:59392
    s_waitcnt lgkmcnt(10)
    v_mfma_f32_32x32x16_bf16 v[80:95], a[44:47], v[160:163], v[80:95]
    v_sub_f32 v22, v18, v19
    v_mul_f32 v24, s50, v19
    v_mul_f32 v22, s49, v22
    v_mov_b32 v18, v19
    v_exp_f32 v21, v22
    v_fma_f32 v96, v96, s49, v24
    v_fma_f32 v97, v97, s49, v24
    ds_read_b64_tr_b16 a[68:69], v10 offset:57344
    ds_read_b64_tr_b16 a[70:71], v10 offset:59392
    s_waitcnt lgkmcnt(10)
    v_mfma_f32_32x32x16_bf16 v[32:47], a[48:51], v[164:167], v[32:47]
    v_exp_f32 v96, v96
    v_fma_f32 v98, v98, s49, v24
    v_exp_f32 v97, v97
    v_fma_f32 v99, v99, s49, v24
    v_exp_f32 v98, v98
    v_fma_f32 v100, v100, s49, v24
    v_exp_f32 v99, v99
    ds_read_b64_tr_b16 a[72:73], v11 offset:57344
    ds_read_b64_tr_b16 a[74:75], v11 offset:59392
    s_waitcnt lgkmcnt(10)
    v_mfma_f32_32x32x16_bf16 v[48:63], a[52:55], v[164:167], v[48:63]
    v_fma_f32 v101, v101, s49, v24
    v_exp_f32 v100, v100
    v_fma_f32 v102, v102, s49, v24
    v_exp_f32 v101, v101
    v_fma_f32 v103, v103, s49, v24
    v_exp_f32 v102, v102
    v_fma_f32 v104, v104, s49, v24
    ds_read_b64_tr_b16 a[76:77], v12 offset:57344
    ds_read_b64_tr_b16 a[78:79], v12 offset:59392
    s_waitcnt lgkmcnt(10)
    v_mfma_f32_32x32x16_bf16 v[64:79], a[56:59], v[164:167], v[64:79]
    v_exp_f32 v103, v103
    v_fma_f32 v105, v105, s49, v24
    v_exp_f32 v104, v104
    v_fma_f32 v106, v106, s49, v24
    v_exp_f32 v105, v105
    v_fma_f32 v107, v107, s49, v24
    v_exp_f32 v106, v106
    ds_read_b64_tr_b16 a[80:81], v9 offset:61440
    ds_read_b64_tr_b16 a[82:83], v9 offset:63488
    s_waitcnt lgkmcnt(10)
    v_mfma_f32_32x32x16_bf16 v[80:95], a[60:63], v[164:167], v[80:95]
    v_fma_f32 v108, v108, s49, v24
    v_exp_f32 v107, v107
    v_fma_f32 v109, v109, s49, v24
    v_exp_f32 v108, v108
    v_fma_f32 v110, v110, s49, v24
    v_exp_f32 v109, v109
    v_fma_f32 v111, v111, s49, v24
    ds_read_b64_tr_b16 a[84:85], v10 offset:61440
    ds_read_b64_tr_b16 a[86:87], v10 offset:63488
    s_waitcnt lgkmcnt(10)
    v_mfma_f32_32x32x16_bf16 v[32:47], a[64:67], v[168:171], v[32:47]
    v_exp_f32 v110, v110
    v_fma_f32 v112, v112, s49, v24
    v_exp_f32 v111, v111
    v_fma_f32 v113, v113, s49, v24
    v_exp_f32 v112, v112
    v_fma_f32 v114, v114, s49, v24
    v_exp_f32 v113, v113
    ds_read_b64_tr_b16 a[88:89], v11 offset:61440
    ds_read_b64_tr_b16 a[90:91], v11 offset:63488
    s_waitcnt lgkmcnt(10)
    v_mfma_f32_32x32x16_bf16 v[48:63], a[68:71], v[168:171], v[48:63]
    v_fma_f32 v115, v115, s49, v24
    v_exp_f32 v114, v114
    v_fma_f32 v116, v116, s49, v24
    v_exp_f32 v115, v115
    v_fma_f32 v117, v117, s49, v24
    v_exp_f32 v116, v116
    v_fma_f32 v118, v118, s49, v24
    ds_read_b64_tr_b16 a[92:93], v12 offset:61440
    ds_read_b64_tr_b16 a[94:95], v12 offset:63488
    s_waitcnt lgkmcnt(10)
    v_mfma_f32_32x32x16_bf16 v[64:79], a[72:75], v[168:171], v[64:79]
    v_exp_f32 v117, v117
    v_fma_f32 v119, v119, s49, v24
    v_exp_f32 v118, v118
    v_fma_f32 v120, v120, s49, v24
    v_exp_f32 v119, v119
    v_fma_f32 v121, v121, s49, v24
    v_exp_f32 v120, v120
    ds_read_b128 a[96:99], v1 offset:16384
    s_waitcnt lgkmcnt(9)
    v_mfma_f32_32x32x16_bf16 v[80:95], a[76:79], v[168:171], v[80:95]
    v_fma_f32 v122, v122, s49, v24
    v_exp_f32 v121, v121
    v_fma_f32 v123, v123, s49, v24
    v_exp_f32 v122, v122
    v_fma_f32 v124, v124, s49, v24
    v_exp_f32 v123, v123
    v_fma_f32 v125, v125, s49, v24
    ds_read_b128 a[100:103], v2 offset:16384
    s_waitcnt lgkmcnt(8)
    v_mfma_f32_32x32x16_bf16 v[32:47], a[80:83], v[172:175], v[32:47]
    v_exp_f32 v124, v124
    v_fma_f32 v126, v126, s49, v24
    v_exp_f32 v125, v125
    v_fma_f32 v127, v127, s49, v24
    v_exp_f32 v126, v126
    v_exp_f32 v127, v127
    v_mul_f32 v20, v20, v21
    ds_read_b128 a[104:107], v3 offset:16384
    s_waitcnt lgkmcnt(7)
    v_mfma_f32_32x32x16_bf16 v[48:63], a[84:87], v[172:175], v[48:63]
    v_add_f32 v22, v96, v97
    v_add_f32 v23, v98, v99
    v_add_f32 v22, v22, v100
    v_add_f32 v23, v23, v101
    v_add_f32 v22, v22, v102
    v_add_f32 v23, v23, v103
    v_add_f32 v22, v22, v104
    ds_read_b128 a[108:111], v4 offset:16384
    s_waitcnt lgkmcnt(6)
    v_mfma_f32_32x32x16_bf16 v[64:79], a[88:91], v[172:175], v[64:79]
    v_add_f32 v23, v23, v105
    v_add_f32 v22, v22, v106
    v_add_f32 v23, v23, v107
    v_add_f32 v22, v22, v108
    v_add_f32 v23, v23, v109
    v_add_f32 v22, v22, v110
    v_add_f32 v23, v23, v111
    ds_read_b128 a[112:115], v5 offset:16384
    s_waitcnt lgkmcnt(5)
    v_mfma_f32_32x32x16_bf16 v[80:95], a[92:95], v[172:175], v[80:95]
    v_add_f32 v22, v22, v112
    v_add_f32 v23, v23, v113
    v_add_f32 v22, v22, v114
    v_add_f32 v23, v23, v115
    v_add_f32 v22, v22, v116
    v_add_f32 v23, v23, v117
    v_add_f32 v22, v22, v118
    ds_read_b128 a[116:119], v6 offset:16384
    s_waitcnt lgkmcnt(5)
    v_mfma_f32_32x32x16_bf16 v[128:143], a[96:99], a[0:3], 0
    v_add_f32 v23, v23, v119
    v_add_f32 v22, v22, v120
    v_add_f32 v23, v23, v121
    v_add_f32 v22, v22, v122
    v_add_f32 v23, v23, v123
    v_add_f32 v22, v22, v124
    v_add_f32 v23, v23, v125
    ds_read_b128 a[120:123], v7 offset:16384
    s_waitcnt lgkmcnt(5)
    v_mfma_f32_32x32x16_bf16 v[128:143], a[100:103], a[4:7], v[128:143]
    v_add_f32 v22, v22, v126
    v_add_f32 v23, v23, v127
    v_add_f32 v22, v22, v23
    v_add_f32 v20, v20, v22
    v_cvt_pk_bf16_f32 v160, v96, v97
    v_cvt_pk_bf16_f32 v161, v98, v99
    v_cvt_pk_bf16_f32 v162, v100, v101
    ds_read_b128 a[124:127], v8 offset:16384
    s_waitcnt lgkmcnt(5)
    v_mfma_f32_32x32x16_bf16 v[128:143], a[104:107], a[8:11], v[128:143]
    v_cvt_pk_bf16_f32 v163, v102, v103
    v_cvt_pk_bf16_f32 v164, v104, v105
    v_cvt_pk_bf16_f32 v165, v106, v107
    v_cvt_pk_bf16_f32 v166, v108, v109
    v_cvt_pk_bf16_f32 v167, v110, v111
    v_cvt_pk_bf16_f32 v168, v112, v113
    v_cvt_pk_bf16_f32 v169, v114, v115
    ds_read_b128 a[128:131], v1 offset:24576
    s_waitcnt lgkmcnt(5)
    v_mfma_f32_32x32x16_bf16 v[128:143], a[108:111], a[12:15], v[128:143]
    v_cvt_pk_bf16_f32 v170, v116, v117
    v_cvt_pk_bf16_f32 v171, v118, v119
    v_cvt_pk_bf16_f32 v172, v120, v121
    v_cvt_pk_bf16_f32 v173, v122, v123
    v_cvt_pk_bf16_f32 v174, v124, v125
    v_cvt_pk_bf16_f32 v175, v126, v127
    v_mul_f32 v32, v32, v21
    ds_read_b128 a[132:135], v2 offset:24576
    s_waitcnt lgkmcnt(5)
    v_mfma_f32_32x32x16_bf16 v[128:143], a[112:115], a[16:19], v[128:143]
    v_mul_f32 v33, v33, v21
    v_mul_f32 v34, v34, v21
    v_mul_f32 v35, v35, v21
    v_mul_f32 v36, v36, v21
    v_mul_f32 v37, v37, v21
    v_mul_f32 v38, v38, v21
    v_mul_f32 v39, v39, v21
    ds_read_b128 a[136:139], v3 offset:24576
    s_waitcnt lgkmcnt(5)
    v_mfma_f32_32x32x16_bf16 v[128:143], a[116:119], a[20:23], v[128:143]
    v_mul_f32 v40, v40, v21
    v_mul_f32 v41, v41, v21
    v_mul_f32 v42, v42, v21
    v_mul_f32 v43, v43, v21
    v_mul_f32 v44, v44, v21
    v_mul_f32 v45, v45, v21
    v_mul_f32 v46, v46, v21
    ds_read_b128 a[140:143], v4 offset:24576
    s_waitcnt lgkmcnt(5)
    v_mfma_f32_32x32x16_bf16 v[128:143], a[120:123], a[24:27], v[128:143]
    v_mul_f32 v47, v47, v21
    v_mul_f32 v48, v48, v21
    v_mul_f32 v49, v49, v21
    v_mul_f32 v50, v50, v21
    v_mul_f32 v51, v51, v21
    v_mul_f32 v52, v52, v21
    v_mul_f32 v53, v53, v21
    ds_read_b128 a[144:147], v5 offset:24576
    s_waitcnt lgkmcnt(5)
    v_mfma_f32_32x32x16_bf16 v[128:143], a[124:127], a[28:31], v[128:143]
    v_mul_f32 v54, v54, v21
    v_mul_f32 v55, v55, v21
    v_mul_f32 v56, v56, v21
    v_mul_f32 v57, v57, v21
    v_mul_f32 v58, v58, v21
    v_mul_f32 v59, v59, v21
    v_mul_f32 v60, v60, v21
    ds_read_b128 a[148:151], v6 offset:24576
    s_waitcnt lgkmcnt(5)
    v_mfma_f32_32x32x16_bf16 v[144:159], a[128:131], a[0:3], 0
    v_mul_f32 v61, v61, v21
    v_mul_f32 v62, v62, v21
    v_mul_f32 v63, v63, v21
    v_mul_f32 v64, v64, v21
    v_mul_f32 v65, v65, v21
    v_mul_f32 v66, v66, v21
    v_mul_f32 v67, v67, v21
    ds_read_b128 a[152:155], v7 offset:24576
    s_waitcnt lgkmcnt(5)
    v_mfma_f32_32x32x16_bf16 v[144:159], a[132:135], a[4:7], v[144:159]
    v_mul_f32 v68, v68, v21
    v_mul_f32 v69, v69, v21
    v_mul_f32 v70, v70, v21
    v_mul_f32 v71, v71, v21
    v_mul_f32 v72, v72, v21
    v_mul_f32 v73, v73, v21
    v_mul_f32 v74, v74, v21
    ds_read_b128 a[156:159], v8 offset:24576
    s_waitcnt lgkmcnt(5)
    v_mfma_f32_32x32x16_bf16 v[144:159], a[136:139], a[8:11], v[144:159]
    v_mul_f32 v75, v75, v21
    v_mul_f32 v76, v76, v21
    v_mul_f32 v77, v77, v21
    v_mul_f32 v78, v78, v21
    v_mul_f32 v79, v79, v21
    v_mul_f32 v80, v80, v21
    v_mul_f32 v81, v81, v21
    s_waitcnt lgkmcnt(4)
    v_mfma_f32_32x32x16_bf16 v[144:159], a[140:143], a[12:15], v[144:159]
    v_mul_f32 v82, v82, v21
    v_mul_f32 v83, v83, v21
    v_mul_f32 v84, v84, v21
    v_mul_f32 v85, v85, v21
    v_mul_f32 v86, v86, v21
    v_mul_f32 v87, v87, v21
    v_mul_f32 v88, v88, v21
    s_waitcnt lgkmcnt(3)
    v_mfma_f32_32x32x16_bf16 v[144:159], a[144:147], a[16:19], v[144:159]
    v_mul_f32 v89, v89, v21
    v_mul_f32 v90, v90, v21
    v_mul_f32 v91, v91, v21
    v_mul_f32 v92, v92, v21
    v_mul_f32 v93, v93, v21
    v_mul_f32 v94, v94, v21
    v_mul_f32 v95, v95, v21
    s_waitcnt lgkmcnt(2)
    v_mfma_f32_32x32x16_bf16 v[144:159], a[148:151], a[20:23], v[144:159]
    s_waitcnt lgkmcnt(1)
    v_mfma_f32_32x32x16_bf16 v[144:159], a[152:155], a[24:27], v[144:159]
    s_waitcnt lgkmcnt(0)
    v_mfma_f32_32x32x16_bf16 v[144:159], a[156:159], a[28:31], v[144:159]
    s_waitcnt vmcnt(24)
    s_barrier
    s_cmp_lt_u32 s3, 2
    s_cbranch_scc1 L_role_32
    s_add_u32 s48, s52, 114688
    s_mov_b32 m0, s48
    s_add_u32 s48, s51, 245760
    s_and_b32 s48, s48, 0x3ffff
    s_add_u32 s48, s48, s52
    buffer_load_dwordx4 v17, s[20:23], s48 offen offset:0 nt lds
    buffer_load_dwordx4 v17, s[20:23], s48 offen offset:1024 nt lds
    buffer_load_dwordx4 v17, s[20:23], s48 offen offset:2048 nt lds
    buffer_load_dwordx4 v17, s[20:23], s48 offen offset:3072 nt lds
    s_add_u32 s48, s52, 118784
    s_mov_b32 m0, s48
    s_add_u32 s48, s51, 245760
    s_and_b32 s48, s48, 0x3ffff
    s_add_u32 s48, s48, s52
    s_add_u32 s48, s48, 4096
    buffer_load_dwordx4 v17, s[20:23], s48 offen offset:0 nt lds
    buffer_load_dwordx4 v17, s[20:23], s48 offen offset:1024 nt lds
    buffer_load_dwordx4 v17, s[20:23], s48 offen offset:2048 nt lds
    buffer_load_dwordx4 v17, s[20:23], s48 offen offset:3072 nt lds
L_role_32:
    ds_read_b64_tr_b16 a[32:33], v9 offset:0
    ds_read_b64_tr_b16 a[34:35], v9 offset:2048
    ds_read_b64_tr_b16 a[36:37], v10 offset:0
    ds_read_b64_tr_b16 a[38:39], v10 offset:2048
    ds_read_b64_tr_b16 a[40:41], v11 offset:0
    ds_read_b64_tr_b16 a[42:43], v11 offset:2048
    ds_read_b64_tr_b16 a[44:45], v12 offset:0
    ds_read_b64_tr_b16 a[46:47], v12 offset:2048
    ds_read_b64_tr_b16 a[48:49], v9 offset:4096
    ds_read_b64_tr_b16 a[50:51], v9 offset:6144
    ds_read_b64_tr_b16 a[52:53], v10 offset:4096
    ds_read_b64_tr_b16 a[54:55], v10 offset:6144
    s_waitcnt lgkmcnt(10)
    v_mfma_f32_32x32x16_bf16 v[32:47], a[32:35], v[160:163], v[32:47]
    v_max3_f32 v22, v128, v129, v130
    v_max3_f32 v23, v131, v132, v133
    v_max3_f32 v22, v22, v134, v135
    v_max3_f32 v23, v23, v136, v137
    v_max3_f32 v22, v22, v138, v139
    v_max3_f32 v23, v23, v140, v141
    v_max3_f32 v22, v22, v142, v143
    ds_read_b64_tr_b16 a[56:57], v11 offset:4096
    ds_read_b64_tr_b16 a[58:59], v11 offset:6144
    s_waitcnt lgkmcnt(10)
    v_mfma_f32_32x32x16_bf16 v[48:63], a[36:39], v[160:163], v[48:63]
    v_max3_f32 v23, v23, v144, v145
    v_max3_f32 v22, v22, v146, v147
    v_max3_f32 v23, v23, v148, v149
    v_max3_f32 v22, v22, v150, v151
    v_max3_f32 v23, v23, v152, v153
    v_max3_f32 v22, v22, v154, v155
    v_max3_f32 v23, v23, v156, v157
    ds_read_b64_tr_b16 a[60:61], v12 offset:4096
    ds_read_b64_tr_b16 a[62:63], v12 offset:6144
    s_waitcnt lgkmcnt(10)
    v_mfma_f32_32x32x16_bf16 v[64:79], a[40:43], v[160:163], v[64:79]
    v_max3_f32 v22, v22, v158, v159
    v_max_f32 v22, v22, v23
    v_mov_b32 v23, v22
    s_nop 1
    v_permlane32_swap_b32 v22, v23
    s_nop 1
    v_max3_f32 v19, v18, v22, v23
    ds_read_b64_tr_b16 a[64:65], v9 offset:8192
    ds_read_b64_tr_b16 a[66:67], v9 offset:10240
    s_waitcnt lgkmcnt(10)
    v_mfma_f32_32x32x16_bf16 v[80:95], a[44:47], v[160:163], v[80:95]
    v_sub_f32 v22, v18, v19
    v_mul_f32 v24, s50, v19
    v_mul_f32 v22, s49, v22
    v_mov_b32 v18, v19
    v_exp_f32 v21, v22
    v_fma_f32 v128, v128, s49, v24
    v_fma_f32 v129, v129, s49, v24
    ds_read_b64_tr_b16 a[68:69], v10 offset:8192
    ds_read_b64_tr_b16 a[70:71], v10 offset:10240
    s_waitcnt lgkmcnt(10)
    v_mfma_f32_32x32x16_bf16 v[32:47], a[48:51], v[164:167], v[32:47]
    v_exp_f32 v128, v128
    v_fma_f32 v130, v130, s49, v24
    v_exp_f32 v129, v129
    v_fma_f32 v131, v131, s49, v24
    v_exp_f32 v130, v130
    v_fma_f32 v132, v132, s49, v24
    v_exp_f32 v131, v131
    ds_read_b64_tr_b16 a[72:73], v11 offset:8192
    ds_read_b64_tr_b16 a[74:75], v11 offset:10240
    s_waitcnt lgkmcnt(10)
    v_mfma_f32_32x32x16_bf16 v[48:63], a[52:55], v[164:167], v[48:63]
    v_fma_f32 v133, v133, s49, v24
    v_exp_f32 v132, v132
    v_fma_f32 v134, v134, s49, v24
    v_exp_f32 v133, v133
    v_fma_f32 v135, v135, s49, v24
    v_exp_f32 v134, v134
    v_fma_f32 v136, v136, s49, v24
    ds_read_b64_tr_b16 a[76:77], v12 offset:8192
    ds_read_b64_tr_b16 a[78:79], v12 offset:10240
    s_waitcnt lgkmcnt(10)
    v_mfma_f32_32x32x16_bf16 v[64:79], a[56:59], v[164:167], v[64:79]
    v_exp_f32 v135, v135
    v_fma_f32 v137, v137, s49, v24
    v_exp_f32 v136, v136
    v_fma_f32 v138, v138, s49, v24
    v_exp_f32 v137, v137
    v_fma_f32 v139, v139, s49, v24
    v_exp_f32 v138, v138
    ds_read_b64_tr_b16 a[80:81], v9 offset:12288
    ds_read_b64_tr_b16 a[82:83], v9 offset:14336
    s_waitcnt lgkmcnt(10)
    v_mfma_f32_32x32x16_bf16 v[80:95], a[60:63], v[164:167], v[80:95]
    v_fma_f32 v140, v140, s49, v24
    v_exp_f32 v139, v139
    v_fma_f32 v141, v141, s49, v24
    v_exp_f32 v140, v140
    v_fma_f32 v142, v142, s49, v24
    v_exp_f32 v141, v141
    v_fma_f32 v143, v143, s49, v24
    ds_read_b64_tr_b16 a[84:85], v10 offset:12288
    ds_read_b64_tr_b16 a[86:87], v10 offset:14336
    s_waitcnt lgkmcnt(10)
    v_mfma_f32_32x32x16_bf16 v[32:47], a[64:67], v[168:171], v[32:47]
    v_exp_f32 v142, v142
    v_fma_f32 v144, v144, s49, v24
    v_exp_f32 v143, v143
    v_fma_f32 v145, v145, s49, v24
    v_exp_f32 v144, v144
    v_fma_f32 v146, v146, s49, v24
    v_exp_f32 v145, v145
    ds_read_b64_tr_b16 a[88:89], v11 offset:12288
    ds_read_b64_tr_b16 a[90:91], v11 offset:14336
    s_waitcnt lgkmcnt(10)
    v_mfma_f32_32x32x16_bf16 v[48:63], a[68:71], v[168:171], v[48:63]
    v_fma_f32 v147, v147, s49, v24
    v_exp_f32 v146, v146
    v_fma_f32 v148, v148, s49, v24
    v_exp_f32 v147, v147
    v_fma_f32 v149, v149, s49, v24
    v_exp_f32 v148, v148
    v_fma_f32 v150, v150, s49, v24
    ds_read_b64_tr_b16 a[92:93], v12 offset:12288
    ds_read_b64_tr_b16 a[94:95], v12 offset:14336
    s_waitcnt lgkmcnt(10)
    v_mfma_f32_32x32x16_bf16 v[64:79], a[72:75], v[168:171], v[64:79]
    v_exp_f32 v149, v149
    v_fma_f32 v151, v151, s49, v24
    v_exp_f32 v150, v150
    v_fma_f32 v152, v152, s49, v24
    v_exp_f32 v151, v151
    v_fma_f32 v153, v153, s49, v24
    v_exp_f32 v152, v152
    ds_read_b128 a[96:99], v1 offset:32768
    s_waitcnt lgkmcnt(9)
    v_mfma_f32_32x32x16_bf16 v[80:95], a[76:79], v[168:171], v[80:95]
    v_fma_f32 v154, v154, s49, v24
    v_exp_f32 v153, v153
    v_fma_f32 v155, v155, s49, v24
    v_exp_f32 v154, v154
    v_fma_f32 v156, v156, s49, v24
    v_exp_f32 v155, v155
    v_fma_f32 v157, v157, s49, v24
    ds_read_b128 a[100:103], v2 offset:32768
    s_waitcnt lgkmcnt(8)
    v_mfma_f32_32x32x16_bf16 v[32:47], a[80:83], v[172:175], v[32:47]
    v_exp_f32 v156, v156
    v_fma_f32 v158, v158, s49, v24
    v_exp_f32 v157, v157
    v_fma_f32 v159, v159, s49, v24
    v_exp_f32 v158, v158
    v_exp_f32 v159, v159
    v_mul_f32 v20, v20, v21
    ds_read_b128 a[104:107], v3 offset:32768
    s_waitcnt lgkmcnt(7)
    v_mfma_f32_32x32x16_bf16 v[48:63], a[84:87], v[172:175], v[48:63]
    v_add_f32 v22, v128, v129
    v_add_f32 v23, v130, v131
    v_add_f32 v22, v22, v132
    v_add_f32 v23, v23, v133
    v_add_f32 v22, v22, v134
    v_add_f32 v23, v23, v135
    v_add_f32 v22, v22, v136
    ds_read_b128 a[108:111], v4 offset:32768
    s_waitcnt lgkmcnt(6)
    v_mfma_f32_32x32x16_bf16 v[64:79], a[88:91], v[172:175], v[64:79]
    v_add_f32 v23, v23, v137
    v_add_f32 v22, v22, v138
    v_add_f32 v23, v23, v139
    v_add_f32 v22, v22, v140
    v_add_f32 v23, v23, v141
    v_add_f32 v22, v22, v142
    v_add_f32 v23, v23, v143
    ds_read_b128 a[112:115], v5 offset:32768
    s_waitcnt lgkmcnt(5)
    v_mfma_f32_32x32x16_bf16 v[80:95], a[92:95], v[172:175], v[80:95]
    v_add_f32 v22, v22, v144
    v_add_f32 v23, v23, v145
    v_add_f32 v22, v22, v146
    v_add_f32 v23, v23, v147
    v_add_f32 v22, v22, v148
    v_add_f32 v23, v23, v149
    v_add_f32 v22, v22, v150
    ds_read_b128 a[116:119], v6 offset:32768
    s_waitcnt lgkmcnt(5)
    v_mfma_f32_32x32x16_bf16 v[96:111], a[96:99], a[0:3], 0
    v_add_f32 v23, v23, v151
    v_add_f32 v22, v22, v152
    v_add_f32 v23, v23, v153
    v_add_f32 v22, v22, v154
    v_add_f32 v23, v23, v155
    v_add_f32 v22, v22, v156
    v_add_f32 v23, v23, v157
    ds_read_b128 a[120:123], v7 offset:32768
    s_waitcnt lgkmcnt(5)
    v_mfma_f32_32x32x16_bf16 v[96:111], a[100:103], a[4:7], v[96:111]
    v_add_f32 v22, v22, v158
    v_add_f32 v23, v23, v159
    v_add_f32 v22, v22, v23
    v_add_f32 v20, v20, v22
    v_cvt_pk_bf16_f32 v160, v128, v129
    v_cvt_pk_bf16_f32 v161, v130, v131
    v_cvt_pk_bf16_f32 v162, v132, v133
    ds_read_b128 a[124:127], v8 offset:32768
    s_waitcnt lgkmcnt(5)
    v_mfma_f32_32x32x16_bf16 v[96:111], a[104:107], a[8:11], v[96:111]
    v_cvt_pk_bf16_f32 v163, v134, v135
    v_cvt_pk_bf16_f32 v164, v136, v137
    v_cvt_pk_bf16_f32 v165, v138, v139
    v_cvt_pk_bf16_f32 v166, v140, v141
    v_cvt_pk_bf16_f32 v167, v142, v143
    v_cvt_pk_bf16_f32 v168, v144, v145
    v_cvt_pk_bf16_f32 v169, v146, v147
    ds_read_b128 a[128:131], v1 offset:40960
    s_waitcnt lgkmcnt(5)
    v_mfma_f32_32x32x16_bf16 v[96:111], a[108:111], a[12:15], v[96:111]
    v_cvt_pk_bf16_f32 v170, v148, v149
    v_cvt_pk_bf16_f32 v171, v150, v151
    v_cvt_pk_bf16_f32 v172, v152, v153
    v_cvt_pk_bf16_f32 v173, v154, v155
    v_cvt_pk_bf16_f32 v174, v156, v157
    v_cvt_pk_bf16_f32 v175, v158, v159
    v_mul_f32 v32, v32, v21
    ds_read_b128 a[132:135], v2 offset:40960
    s_waitcnt lgkmcnt(5)
    v_mfma_f32_32x32x16_bf16 v[96:111], a[112:115], a[16:19], v[96:111]
    v_mul_f32 v33, v33, v21
    v_mul_f32 v34, v34, v21
    v_mul_f32 v35, v35, v21
    v_mul_f32 v36, v36, v21
    v_mul_f32 v37, v37, v21
    v_mul_f32 v38, v38, v21
    v_mul_f32 v39, v39, v21
    ds_read_b128 a[136:139], v3 offset:40960
    s_waitcnt lgkmcnt(5)
    v_mfma_f32_32x32x16_bf16 v[96:111], a[116:119], a[20:23], v[96:111]
    v_mul_f32 v40, v40, v21
    v_mul_f32 v41, v41, v21
    v_mul_f32 v42, v42, v21
    v_mul_f32 v43, v43, v21
    v_mul_f32 v44, v44, v21
    v_mul_f32 v45, v45, v21
    v_mul_f32 v46, v46, v21
    ds_read_b128 a[140:143], v4 offset:40960
    s_waitcnt lgkmcnt(5)
    v_mfma_f32_32x32x16_bf16 v[96:111], a[120:123], a[24:27], v[96:111]
    v_mul_f32 v47, v47, v21
    v_mul_f32 v48, v48, v21
    v_mul_f32 v49, v49, v21
    v_mul_f32 v50, v50, v21
    v_mul_f32 v51, v51, v21
    v_mul_f32 v52, v52, v21
    v_mul_f32 v53, v53, v21
    ds_read_b128 a[144:147], v5 offset:40960
    s_waitcnt lgkmcnt(5)
    v_mfma_f32_32x32x16_bf16 v[96:111], a[124:127], a[28:31], v[96:111]
    v_mul_f32 v54, v54, v21
    v_mul_f32 v55, v55, v21
    v_mul_f32 v56, v56, v21
    v_mul_f32 v57, v57, v21
    v_mul_f32 v58, v58, v21
    v_mul_f32 v59, v59, v21
    v_mul_f32 v60, v60, v21
    ds_read_b128 a[148:151], v6 offset:40960
    s_waitcnt lgkmcnt(5)
    v_mfma_f32_32x32x16_bf16 v[112:127], a[128:131], a[0:3], 0
    v_mul_f32 v61, v61, v21
    v_mul_f32 v62, v62, v21
    v_mul_f32 v63, v63, v21
    v_mul_f32 v64, v64, v21
    v_mul_f32 v65, v65, v21
    v_mul_f32 v66, v66, v21
    v_mul_f32 v67, v67, v21
    ds_read_b128 a[152:155], v7 offset:40960
    s_waitcnt lgkmcnt(5)
    v_mfma_f32_32x32x16_bf16 v[112:127], a[132:135], a[4:7], v[112:127]
    v_mul_f32 v68, v68, v21
    v_mul_f32 v69, v69, v21
    v_mul_f32 v70, v70, v21
    v_mul_f32 v71, v71, v21
    v_mul_f32 v72, v72, v21
    v_mul_f32 v73, v73, v21
    v_mul_f32 v74, v74, v21
    ds_read_b128 a[156:159], v8 offset:40960
    s_waitcnt lgkmcnt(5)
    v_mfma_f32_32x32x16_bf16 v[112:127], a[136:139], a[8:11], v[112:127]
    v_mul_f32 v75, v75, v21
    v_mul_f32 v76, v76, v21
    v_mul_f32 v77, v77, v21
    v_mul_f32 v78, v78, v21
    v_mul_f32 v79, v79, v21
    v_mul_f32 v80, v80, v21
    v_mul_f32 v81, v81, v21
    s_waitcnt lgkmcnt(4)
    v_mfma_f32_32x32x16_bf16 v[112:127], a[140:143], a[12:15], v[112:127]
    v_mul_f32 v82, v82, v21
    v_mul_f32 v83, v83, v21
    v_mul_f32 v84, v84, v21
    v_mul_f32 v85, v85, v21
    v_mul_f32 v86, v86, v21
    v_mul_f32 v87, v87, v21
    v_mul_f32 v88, v88, v21
    s_waitcnt lgkmcnt(3)
    v_mfma_f32_32x32x16_bf16 v[112:127], a[144:147], a[16:19], v[112:127]
    v_mul_f32 v89, v89, v21
    v_mul_f32 v90, v90, v21
    v_mul_f32 v91, v91, v21
    v_mul_f32 v92, v92, v21
    v_mul_f32 v93, v93, v21
    v_mul_f32 v94, v94, v21
    v_mul_f32 v95, v95, v21
    s_waitcnt lgkmcnt(2)
    v_mfma_f32_32x32x16_bf16 v[112:127], a[148:151], a[20:23], v[112:127]
    s_waitcnt lgkmcnt(1)
    v_mfma_f32_32x32x16_bf16 v[112:127], a[152:155], a[24:27], v[112:127]
    s_waitcnt lgkmcnt(0)
    v_mfma_f32_32x32x16_bf16 v[112:127], a[156:159], a[28:31], v[112:127]
    s_waitcnt vmcnt(16)
    s_barrier
    ds_read_b64_tr_b16 a[32:33], v9 offset:16384
    ds_read_b64_tr_b16 a[34:35], v9 offset:18432
    ds_read_b64_tr_b16 a[36:37], v10 offset:16384
    ds_read_b64_tr_b16 a[38:39], v10 offset:18432
    ds_read_b64_tr_b16 a[40:41], v11 offset:16384
    ds_read_b64_tr_b16 a[42:43], v11 offset:18432
    ds_read_b64_tr_b16 a[44:45], v12 offset:16384
    ds_read_b64_tr_b16 a[46:47], v12 offset:18432
    ds_read_b64_tr_b16 a[48:49], v9 offset:20480
    ds_read_b64_tr_b16 a[50:51], v9 offset:22528
    ds_read_b64_tr_b16 a[52:53], v10 offset:20480
    ds_read_b64_tr_b16 a[54:55], v10 offset:22528
    s_waitcnt lgkmcnt(10)
    v_mfma_f32_32x32x16_bf16 v[32:47], a[32:35], v[160:163], v[32:47]
    v_max3_f32 v22, v96, v97, v98
    v_max3_f32 v23, v99, v100, v101
    v_max3_f32 v22, v22, v102, v103
    v_max3_f32 v23, v23, v104, v105
    v_max3_f32 v22, v22, v106, v107
    v_max3_f32 v23, v23, v108, v109
    v_max3_f32 v22, v22, v110, v111
    ds_read_b64_tr_b16 a[56:57], v11 offset:20480
    ds_read_b64_tr_b16 a[58:59], v11 offset:22528
    s_waitcnt lgkmcnt(10)
    v_mfma_f32_32x32x16_bf16 v[48:63], a[36:39], v[160:163], v[48:63]
    v_max3_f32 v23, v23, v112, v113
    v_max3_f32 v22, v22, v114, v115
    v_max3_f32 v23, v23, v116, v117
    v_max3_f32 v22, v22, v118, v119
    v_max3_f32 v23, v23, v120, v121
    v_max3_f32 v22, v22, v122, v123
    v_max3_f32 v23, v23, v124, v125
    ds_read_b64_tr_b16 a[60:61], v12 offset:20480
    ds_read_b64_tr_b16 a[62:63], v12 offset:22528
    s_waitcnt lgkmcnt(10)
    v_mfma_f32_32x32x16_bf16 v[64:79], a[40:43], v[160:163], v[64:79]
    v_max3_f32 v22, v22, v126, v127
    v_max_f32 v22, v22, v23
    v_mov_b32 v23, v22
    s_nop 1
    v_permlane32_swap_b32 v22, v23
    s_nop 1
    v_max3_f32 v19, v18, v22, v23
    ds_read_b64_tr_b16 a[64:65], v9 offset:24576
    ds_read_b64_tr_b16 a[66:67], v9 offset:26624
    s_waitcnt lgkmcnt(10)
    v_mfma_f32_32x32x16_bf16 v[80:95], a[44:47], v[160:163], v[80:95]
    v_sub_f32 v22, v18, v19
    v_mul_f32 v24, s50, v19
    v_mul_f32 v22, s49, v22
    v_mov_b32 v18, v19
    v_exp_f32 v21, v22
    v_fma_f32 v96, v96, s49, v24
    v_fma_f32 v97, v97, s49, v24
    ds_read_b64_tr_b16 a[68:69], v10 offset:24576
    ds_read_b64_tr_b16 a[70:71], v10 offset:26624
    s_waitcnt lgkmcnt(10)
    v_mfma_f32_32x32x16_bf16 v[32:47], a[48:51], v[164:167], v[32:47]
    v_exp_f32 v96, v96
    v_fma_f32 v98, v98, s49, v24
    v_exp_f32 v97, v97
    v_fma_f32 v99, v99, s49, v24
    v_exp_f32 v98, v98
    v_fma_f32 v100, v100, s49, v24
    v_exp_f32 v99, v99
    ds_read_b64_tr_b16 a[72:73], v11 offset:24576
    ds_read_b64_tr_b16 a[74:75], v11 offset:26624
    s_waitcnt lgkmcnt(10)
    v_mfma_f32_32x32x16_bf16 v[48:63], a[52:55], v[164:167], v[48:63]
    v_fma_f32 v101, v101, s49, v24
    v_exp_f32 v100, v100
    v_fma_f32 v102, v102, s49, v24
    v_exp_f32 v101, v101
    v_fma_f32 v103, v103, s49, v24
    v_exp_f32 v102, v102
    v_fma_f32 v104, v104, s49, v24
    ds_read_b64_tr_b16 a[76:77], v12 offset:24576
    ds_read_b64_tr_b16 a[78:79], v12 offset:26624
    s_waitcnt lgkmcnt(10)
    v_mfma_f32_32x32x16_bf16 v[64:79], a[56:59], v[164:167], v[64:79]
    v_exp_f32 v103, v103
    v_fma_f32 v105, v105, s49, v24
    v_exp_f32 v104, v104
    v_fma_f32 v106, v106, s49, v24
    v_exp_f32 v105, v105
    v_fma_f32 v107, v107, s49, v24
    v_exp_f32 v106, v106
    ds_read_b64_tr_b16 a[80:81], v9 offset:28672
    ds_read_b64_tr_b16 a[82:83], v9 offset:30720
    s_waitcnt lgkmcnt(10)
    v_mfma_f32_32x32x16_bf16 v[80:95], a[60:63], v[164:167], v[80:95]
    v_fma_f32 v108, v108, s49, v24
    v_exp_f32 v107, v107
    v_fma_f32 v109, v109, s49, v24
    v_exp_f32 v108, v108
    v_fma_f32 v110, v110, s49, v24
    v_exp_f32 v109, v109
    v_fma_f32 v111, v111, s49, v24
    ds_read_b64_tr_b16 a[84:85], v10 offset:28672
    ds_read_b64_tr_b16 a[86:87], v10 offset:30720
    s_waitcnt lgkmcnt(10)
    v_mfma_f32_32x32x16_bf16 v[32:47], a[64:67], v[168:171], v[32:47]
    v_exp_f32 v110, v110
    v_fma_f32 v112, v112, s49, v24
    v_exp_f32 v111, v111
    v_fma_f32 v113, v113, s49, v24
    v_exp_f32 v112, v112
    v_fma_f32 v114, v114, s49, v24
    v_exp_f32 v113, v113
    ds_read_b64_tr_b16 a[88:89], v11 offset:28672
    ds_read_b64_tr_b16 a[90:91], v11 offset:30720
    s_waitcnt lgkmcnt(10)
    v_mfma_f32_32x32x16_bf16 v[48:63], a[68:71], v[168:171], v[48:63]
    v_fma_f32 v115, v115, s49, v24
    v_exp_f32 v114, v114
    v_fma_f32 v116, v116, s49, v24
    v_exp_f32 v115, v115
    v_fma_f32 v117, v117, s49, v24
    v_exp_f32 v116, v116
    v_fma_f32 v118, v118, s49, v24
    ds_read_b64_tr_b16 a[92:93], v12 offset:28672
    ds_read_b64_tr_b16 a[94:95], v12 offset:30720
    s_waitcnt lgkmcnt(10)
    v_mfma_f32_32x32x16_bf16 v[64:79], a[72:75], v[168:171], v[64:79]
    v_exp_f32 v117, v117
    v_fma_f32 v119, v119, s49, v24
    v_exp_f32 v118, v118
    v_fma_f32 v120, v120, s49, v24
    v_exp_f32 v119, v119
    v_fma_f32 v121, v121, s49, v24
    v_exp_f32 v120, v120
    ds_read_b128 a[96:99], v1 offset:49152
    s_waitcnt lgkmcnt(9)
    v_mfma_f32_32x32x16_bf16 v[80:95], a[76:79], v[168:171], v[80:95]
    v_fma_f32 v122, v122, s49, v24
    v_exp_f32 v121, v121
    v_fma_f32 v123, v123, s49, v24
    v_exp_f32 v122, v122
    v_fma_f32 v124, v124, s49, v24
    v_exp_f32 v123, v123
    v_fma_f32 v125, v125, s49, v24
    ds_read_b128 a[100:103], v2 offset:49152
    s_waitcnt lgkmcnt(8)
    v_mfma_f32_32x32x16_bf16 v[32:47], a[80:83], v[172:175], v[32:47]
    v_exp_f32 v124, v124
    v_fma_f32 v126, v126, s49, v24
    v_exp_f32 v125, v125
    v_fma_f32 v127, v127, s49, v24
    v_exp_f32 v126, v126
    v_exp_f32 v127, v127
    v_mul_f32 v20, v20, v21
    ds_read_b128 a[104:107], v3 offset:49152
    s_waitcnt lgkmcnt(7)
    v_mfma_f32_32x32x16_bf16 v[48:63], a[84:87], v[172:175], v[48:63]
    v_add_f32 v22, v96, v97
    v_add_f32 v23, v98, v99
    v_add_f32 v22, v22, v100
    v_add_f32 v23, v23, v101
    v_add_f32 v22, v22, v102
    v_add_f32 v23, v23, v103
    v_add_f32 v22, v22, v104
    ds_read_b128 a[108:111], v4 offset:49152
    s_waitcnt lgkmcnt(6)
    v_mfma_f32_32x32x16_bf16 v[64:79], a[88:91], v[172:175], v[64:79]
    v_add_f32 v23, v23, v105
    v_add_f32 v22, v22, v106
    v_add_f32 v23, v23, v107
    v_add_f32 v22, v22, v108
    v_add_f32 v23, v23, v109
    v_add_f32 v22, v22, v110
    v_add_f32 v23, v23, v111
    ds_read_b128 a[112:115], v5 offset:49152
    s_waitcnt lgkmcnt(5)
    v_mfma_f32_32x32x16_bf16 v[80:95], a[92:95], v[172:175], v[80:95]
    v_add_f32 v22, v22, v112
    v_add_f32 v23, v23, v113
    v_add_f32 v22, v22, v114
    v_add_f32 v23, v23, v115
    v_add_f32 v22, v22, v116
    v_add_f32 v23, v23, v117
    v_add_f32 v22, v22, v118
    ds_read_b128 a[116:119], v6 offset:49152
    s_waitcnt lgkmcnt(5)
    v_mfma_f32_32x32x16_bf16 v[128:143], a[96:99], a[0:3], 0
    v_add_f32 v23, v23, v119
    v_add_f32 v22, v22, v120
    v_add_f32 v23, v23, v121
    v_add_f32 v22, v22, v122
    v_add_f32 v23, v23, v123
    v_add_f32 v22, v22, v124
    v_add_f32 v23, v23, v125
    ds_read_b128 a[120:123], v7 offset:49152
    s_waitcnt lgkmcnt(5)
    v_mfma_f32_32x32x16_bf16 v[128:143], a[100:103], a[4:7], v[128:143]
    v_add_f32 v22, v22, v126
    v_add_f32 v23, v23, v127
    v_add_f32 v22, v22, v23
    v_add_f32 v20, v20, v22
    v_cvt_pk_bf16_f32 v160, v96, v97
    v_cvt_pk_bf16_f32 v161, v98, v99
    v_cvt_pk_bf16_f32 v162, v100, v101
    ds_read_b128 a[124:127], v8 offset:49152
    s_waitcnt lgkmcnt(5)
    v_mfma_f32_32x32x16_bf16 v[128:143], a[104:107], a[8:11], v[128:143]
    v_cvt_pk_bf16_f32 v163, v102, v103
    v_cvt_pk_bf16_f32 v164, v104, v105
    v_cvt_pk_bf16_f32 v165, v106, v107
    v_cvt_pk_bf16_f32 v166, v108, v109
    v_cvt_pk_bf16_f32 v167, v110, v111
    v_cvt_pk_bf16_f32 v168, v112, v113
    v_cvt_pk_bf16_f32 v169, v114, v115
    ds_read_b128 a[128:131], v1 offset:57344
    s_waitcnt lgkmcnt(5)
    v_mfma_f32_32x32x16_bf16 v[128:143], a[108:111], a[12:15], v[128:143]
    v_cvt_pk_bf16_f32 v170, v116, v117
    v_cvt_pk_bf16_f32 v171, v118, v119
    v_cvt_pk_bf16_f32 v172, v120, v121
    v_cvt_pk_bf16_f32 v173, v122, v123
    v_cvt_pk_bf16_f32 v174, v124, v125
    v_cvt_pk_bf16_f32 v175, v126, v127
    v_mul_f32 v32, v32, v21
    ds_read_b128 a[132:135], v2 offset:57344
    s_waitcnt lgkmcnt(5)
    v_mfma_f32_32x32x16_bf16 v[128:143], a[112:115], a[16:19], v[128:143]
    v_mul_f32 v33, v33, v21
    v_mul_f32 v34, v34, v21
    v_mul_f32 v35, v35, v21
    v_mul_f32 v36, v36, v21
    v_mul_f32 v37, v37, v21
    v_mul_f32 v38, v38, v21
    v_mul_f32 v39, v39, v21
    ds_read_b128 a[136:139], v3 offset:57344
    s_waitcnt lgkmcnt(5)
    v_mfma_f32_32x32x16_bf16 v[128:143], a[116:119], a[20:23], v[128:143]
    v_mul_f32 v40, v40, v21
    v_mul_f32 v41, v41, v21
    v_mul_f32 v42, v42, v21
    v_mul_f32 v43, v43, v21
    v_mul_f32 v44, v44, v21
    v_mul_f32 v45, v45, v21
    v_mul_f32 v46, v46, v21
    ds_read_b128 a[140:143], v4 offset:57344
    s_waitcnt lgkmcnt(5)
    v_mfma_f32_32x32x16_bf16 v[128:143], a[120:123], a[24:27], v[128:143]
    v_mul_f32 v47, v47, v21
    v_mul_f32 v48, v48, v21
    v_mul_f32 v49, v49, v21
    v_mul_f32 v50, v50, v21
    v_mul_f32 v51, v51, v21
    v_mul_f32 v52, v52, v21
    v_mul_f32 v53, v53, v21
    ds_read_b128 a[144:147], v5 offset:57344
    s_waitcnt lgkmcnt(5)
    v_mfma_f32_32x32x16_bf16 v[128:143], a[124:127], a[28:31], v[128:143]
    v_mul_f32 v54, v54, v21
    v_mul_f32 v55, v55, v21
    v_mul_f32 v56, v56, v21
    v_mul_f32 v57, v57, v21
    v_mul_f32 v58, v58, v21
    v_mul_f32 v59, v59, v21
    v_mul_f32 v60, v60, v21
    ds_read_b128 a[148:151], v6 offset:57344
    s_waitcnt lgkmcnt(5)
    v_mfma_f32_32x32x16_bf16 v[144:159], a[128:131], a[0:3], 0
    v_mul_f32 v61, v61, v21
    v_mul_f32 v62, v62, v21
    v_mul_f32 v63, v63, v21
    v_mul_f32 v64, v64, v21
    v_mul_f32 v65, v65, v21
    v_mul_f32 v66, v66, v21
    v_mul_f32 v67, v67, v21
    ds_read_b128 a[152:155], v7 offset:57344
    s_waitcnt lgkmcnt(5)
    v_mfma_f32_32x32x16_bf16 v[144:159], a[132:135], a[4:7], v[144:159]
    v_mul_f32 v68, v68, v21
    v_mul_f32 v69, v69, v21
    v_mul_f32 v70, v70, v21
    v_mul_f32 v71, v71, v21
    v_mul_f32 v72, v72, v21
    v_mul_f32 v73, v73, v21
    v_mul_f32 v74, v74, v21
    ds_read_b128 a[156:159], v8 offset:57344
    s_waitcnt lgkmcnt(5)
    v_mfma_f32_32x32x16_bf16 v[144:159], a[136:139], a[8:11], v[144:159]
    v_mul_f32 v75, v75, v21
    v_mul_f32 v76, v76, v21
    v_mul_f32 v77, v77, v21
    v_mul_f32 v78, v78, v21
    v_mul_f32 v79, v79, v21
    v_mul_f32 v80, v80, v21
    v_mul_f32 v81, v81, v21
    s_waitcnt lgkmcnt(4)
    v_mfma_f32_32x32x16_bf16 v[144:159], a[140:143], a[12:15], v[144:159]
    v_mul_f32 v82, v82, v21
    v_mul_f32 v83, v83, v21
    v_mul_f32 v84, v84, v21
    v_mul_f32 v85, v85, v21
    v_mul_f32 v86, v86, v21
    v_mul_f32 v87, v87, v21
    v_mul_f32 v88, v88, v21
    s_waitcnt lgkmcnt(3)
    v_mfma_f32_32x32x16_bf16 v[144:159], a[144:147], a[16:19], v[144:159]
    v_mul_f32 v89, v89, v21
    v_mul_f32 v90, v90, v21
    v_mul_f32 v91, v91, v21
    v_mul_f32 v92, v92, v21
    v_mul_f32 v93, v93, v21
    v_mul_f32 v94, v94, v21
    v_mul_f32 v95, v95, v21
    s_waitcnt lgkmcnt(2)
    v_mfma_f32_32x32x16_bf16 v[144:159], a[148:151], a[20:23], v[144:159]
    s_waitcnt lgkmcnt(1)
    v_mfma_f32_32x32x16_bf16 v[144:159], a[152:155], a[24:27], v[144:159]
    s_waitcnt lgkmcnt(0)
    v_mfma_f32_32x32x16_bf16 v[144:159], a[156:159], a[28:31], v[144:159]
    s_waitcnt vmcnt(8)
    s_barrier
    ds_read_b64_tr_b16 a[32:33], v9 offset:32768
    ds_read_b64_tr_b16 a[34:35], v9 offset:34816
    ds_read_b64_tr_b16 a[36:37], v10 offset:32768
    ds_read_b64_tr_b16 a[38:39], v10 offset:34816
    ds_read_b64_tr_b16 a[40:41], v11 offset:32768
    ds_read_b64_tr_b16 a[42:43], v11 offset:34816
    ds_read_b64_tr_b16 a[44:45], v12 offset:32768
    ds_read_b64_tr_b16 a[46:47], v12 offset:34816
    ds_read_b64_tr_b16 a[48:49], v9 offset:36864
    ds_read_b64_tr_b16 a[50:51], v9 offset:38912
    ds_read_b64_tr_b16 a[52:53], v10 offset:36864
    ds_read_b64_tr_b16 a[54:55], v10 offset:38912
    s_waitcnt lgkmcnt(10)
    v_mfma_f32_32x32x16_bf16 v[32:47], a[32:35], v[160:163], v[32:47]
    v_max3_f32 v22, v128, v129, v130
    v_max3_f32 v23, v131, v132, v133
    v_max3_f32 v22, v22, v134, v135
    v_max3_f32 v23, v23, v136, v137
    v_max3_f32 v22, v22, v138, v139
    v_max3_f32 v23, v23, v140, v141
    v_max3_f32 v22, v22, v142, v143
    v_max3_f32 v23, v23, v144, v145
    v_max3_f32 v22, v22, v146, v147
    v_max3_f32 v23, v23, v148, v149
    v_max3_f32 v22, v22, v150, v151
    v_max3_f32 v23, v23, v152, v153
    v_max3_f32 v22, v22, v154, v155
    ds_read_b64_tr_b16 a[56:57], v11 offset:36864
    ds_read_b64_tr_b16 a[58:59], v11 offset:38912
    s_waitcnt lgkmcnt(10)
    v_mfma_f32_32x32x16_bf16 v[48:63], a[36:39], v[160:163], v[48:63]
    v_max3_f32 v23, v23, v156, v157
    v_max3_f32 v22, v22, v158, v159
    v_max_f32 v22, v22, v23
    v_mov_b32 v23, v22
    s_nop 1
    v_permlane32_swap_b32 v22, v23
    s_nop 1
    v_max3_f32 v19, v18, v22, v23
    v_sub_f32 v22, v18, v19
    v_mul_f32 v24, s50, v19
    v_mul_f32 v22, s49, v22
    v_mov_b32 v18, v19
    v_exp_f32 v21, v22
    ds_read_b64_tr_b16 a[60:61], v12 offset:36864
    ds_read_b64_tr_b16 a[62:63], v12 offset:38912
    s_waitcnt lgkmcnt(10)
    v_mfma_f32_32x32x16_bf16 v[64:79], a[40:43], v[160:163], v[64:79]
    v_fma_f32 v128, v128, s49, v24
    v_fma_f32 v129, v129, s49, v24
    v_exp_f32 v128, v128
    v_fma_f32 v130, v130, s49, v24
    v_exp_f32 v129, v129
    v_fma_f32 v131, v131, s49, v24
    v_exp_f32 v130, v130
    v_fma_f32 v132, v132, s49, v24
    v_exp_f32 v131, v131
    v_fma_f32 v133, v133, s49, v24
    v_exp_f32 v132, v132
    v_fma_f32 v134, v134, s49, v24
    v_exp_f32 v133, v133
    ds_read_b64_tr_b16 a[64:65], v9 offset:40960
    ds_read_b64_tr_b16 a[66:67], v9 offset:43008
    s_waitcnt lgkmcnt(10)
    v_mfma_f32_32x32x16_bf16 v[80:95], a[44:47], v[160:163], v[80:95]
    v_fma_f32 v135, v135, s49, v24
    v_exp_f32 v134, v134
    v_fma_f32 v136, v136, s49, v24
    v_exp_f32 v135, v135
    v_fma_f32 v137, v137, s49, v24
    v_exp_f32 v136, v136
    v_fma_f32 v138, v138, s49, v24
    v_exp_f32 v137, v137
    v_fma_f32 v139, v139, s49, v24
    v_exp_f32 v138, v138
    v_fma_f32 v140, v140, s49, v24
    v_exp_f32 v139, v139
    v_fma_f32 v141, v141, s49, v24
    ds_read_b64_tr_b16 a[68:69], v10 offset:40960
    ds_read_b64_tr_b16 a[70:71], v10 offset:43008
    s_waitcnt lgkmcnt(10)
    v_mfma_f32_32x32x16_bf16 v[32:47], a[48:51], v[164:167], v[32:47]
    v_exp_f32 v140, v140
    v_fma_f32 v142, v142, s49, v24
    v_exp_f32 v141, v141
    v_fma_f32 v143, v143, s49, v24
    v_exp_f32 v142, v142
    v_fma_f32 v144, v144, s49, v24
    v_exp_f32 v143, v143
    v_fma_f32 v145, v145, s49, v24
    v_exp_f32 v144, v144
    v_fma_f32 v146, v146, s49, v24
    v_exp_f32 v145, v145
    v_fma_f32 v147, v147, s49, v24
    v_exp_f32 v146, v146
    ds_read_b64_tr_b16 a[72:73], v11 offset:40960
    ds_read_b64_tr_b16 a[74:75], v11 offset:43008
    s_waitcnt lgkmcnt(10)
    v_mfma_f32_32x32x16_bf16 v[48:63], a[52:55], v[164:167], v[48:63]
    v_fma_f32 v148, v148, s49, v24
    v_exp_f32 v147, v147
    v_fma_f32 v149, v149, s49, v24
    v_exp_f32 v148, v148
    v_fma_f32 v150, v150, s49, v24
    v_exp_f32 v149, v149
    v_fma_f32 v151, v151, s49, v24
    v_exp_f32 v150, v150
    v_fma_f32 v152, v152, s49, v24
    v_exp_f32 v151, v151
    v_fma_f32 v153, v153, s49, v24
    v_exp_f32 v152, v152
    v_fma_f32 v154, v154, s49, v24
    ds_read_b64_tr_b16 a[76:77], v12 offset:40960
    ds_read_b64_tr_b16 a[78:79], v12 offset:43008
    s_waitcnt lgkmcnt(10)
    v_mfma_f32_32x32x16_bf16 v[64:79], a[56:59], v[164:167], v[64:79]
    v_exp_f32 v153, v153
    v_fma_f32 v155, v155, s49, v24
    v_exp_f32 v154, v154
    v_fma_f32 v156, v156, s49, v24
    v_exp_f32 v155, v155
    v_fma_f32 v157, v157, s49, v24
    v_exp_f32 v156, v156
    v_fma_f32 v158, v158, s49, v24
    v_exp_f32 v157, v157
    v_fma_f32 v159, v159, s49, v24
    v_exp_f32 v158, v158
    v_exp_f32 v159, v159
    v_mul_f32 v20, v20, v21
    ds_read_b64_tr_b16 a[80:81], v9 offset:45056
    ds_read_b64_tr_b16 a[82:83], v9 offset:47104
    s_waitcnt lgkmcnt(10)
    v_mfma_f32_32x32x16_bf16 v[80:95], a[60:63], v[164:167], v[80:95]
    v_add_f32 v22, v128, v129
    v_add_f32 v23, v130, v131
    v_add_f32 v22, v22, v132
    v_add_f32 v23, v23, v133
    v_add_f32 v22, v22, v134
    v_add_f32 v23, v23, v135
    v_add_f32 v22, v22, v136
    v_add_f32 v23, v23, v137
    v_add_f32 v22, v22, v138
    v_add_f32 v23, v23, v139
    v_add_f32 v22, v22, v140
    v_add_f32 v23, v23, v141
    v_add_f32 v22, v22, v142
    ds_read_b64_tr_b16 a[84:85], v10 offset:45056
    ds_read_b64_tr_b16 a[86:87], v10 offset:47104
    s_waitcnt lgkmcnt(10)
    v_mfma_f32_32x32x16_bf16 v[32:47], a[64:67], v[168:171], v[32:47]
    v_add_f32 v23, v23, v143
    v_add_f32 v22, v22, v144
    v_add_f32 v23, v23, v145
    v_add_f32 v22, v22, v146
    v_add_f32 v23, v23, v147
    v_add_f32 v22, v22, v148
    v_add_f32 v23, v23, v149
    v_add_f32 v22, v22, v150
    v_add_f32 v23, v23, v151
    v_add_f32 v22, v22, v152
    v_add_f32 v23, v23, v153
    v_add_f32 v22, v22, v154
    v_add_f32 v23, v23, v155
    ds_read_b64_tr_b16 a[88:89], v11 offset:45056
    ds_read_b64_tr_b16 a[90:91], v11 offset:47104
    s_waitcnt lgkmcnt(10)
    v_mfma_f32_32x32x16_bf16 v[48:63], a[68:71], v[168:171], v[48:63]
    v_add_f32 v22, v22, v156
    v_add_f32 v23, v23, v157
    v_add_f32 v22, v22, v158
    v_add_f32 v23, v23, v159
    v_add_f32 v22, v22, v23
    v_add_f32 v20, v20, v22
    ds_read_b64_tr_b16 a[92:93], v12 offset:45056
    ds_read_b64_tr_b16 a[94:95], v12 offset:47104
    s_waitcnt lgkmcnt(10)
    v_mfma_f32_32x32x16_bf16 v[64:79], a[72:75], v[168:171], v[64:79]
    s_waitcnt lgkmcnt(8)
    v_mfma_f32_32x32x16_bf16 v[80:95], a[76:79], v[168:171], v[80:95]
    s_waitcnt lgkmcnt(6)
    v_mfma_f32_32x32x16_bf16 v[32:47], a[80:83], v[172:175], v[32:47]
    s_waitcnt lgkmcnt(4)
    v_mfma_f32_32x32x16_bf16 v[48:63], a[84:87], v[172:175], v[48:63]
    s_waitcnt lgkmcnt(2)
    v_mfma_f32_32x32x16_bf16 v[64:79], a[88:91], v[172:175], v[64:79]
    s_waitcnt lgkmcnt(0)
    v_mfma_f32_32x32x16_bf16 v[80:95], a[92:95], v[172:175], v[80:95]
    v_cvt_pk_bf16_f32 v160, v128, v129
    v_cvt_pk_bf16_f32 v161, v130, v131
    v_cvt_pk_bf16_f32 v162, v132, v133
    v_cvt_pk_bf16_f32 v163, v134, v135
    v_cvt_pk_bf16_f32 v164, v136, v137
    v_cvt_pk_bf16_f32 v165, v138, v139
    v_cvt_pk_bf16_f32 v166, v140, v141
    v_cvt_pk_bf16_f32 v167, v142, v143
    v_cvt_pk_bf16_f32 v168, v144, v145
    v_cvt_pk_bf16_f32 v169, v146, v147
    v_cvt_pk_bf16_f32 v170, v148, v149
    v_cvt_pk_bf16_f32 v171, v150, v151
    v_cvt_pk_bf16_f32 v172, v152, v153
    v_cvt_pk_bf16_f32 v173, v154, v155
    v_cvt_pk_bf16_f32 v174, v156, v157
    v_cvt_pk_bf16_f32 v175, v158, v159
    v_mul_f32 v32, v32, v21
    v_mul_f32 v33, v33, v21
    v_mul_f32 v34, v34, v21
    v_mul_f32 v35, v35, v21
    v_mul_f32 v36, v36, v21
    v_mul_f32 v37, v37, v21
    v_mul_f32 v38, v38, v21
    v_mul_f32 v39, v39, v21
    v_mul_f32 v40, v40, v21
    v_mul_f32 v41, v41, v21
    v_mul_f32 v42, v42, v21
    v_mul_f32 v43, v43, v21
    v_mul_f32 v44, v44, v21
    v_mul_f32 v45, v45, v21
    v_mul_f32 v46, v46, v21
    v_mul_f32 v47, v47, v21
    v_mul_f32 v48, v48, v21
    v_mul_f32 v49, v49, v21
    v_mul_f32 v50, v50, v21
    v_mul_f32 v51, v51, v21
    v_mul_f32 v52, v52, v21
    v_mul_f32 v53, v53, v21
    v_mul_f32 v54, v54, v21
    v_mul_f32 v55, v55, v21
    v_mul_f32 v56, v56, v21
    v_mul_f32 v57, v57, v21
    v_mul_f32 v58, v58, v21
    v_mul_f32 v59, v59, v21
    v_mul_f32 v60, v60, v21
    v_mul_f32 v61, v61, v21
    v_mul_f32 v62, v62, v21
    v_mul_f32 v63, v63, v21
    v_mul_f32 v64, v64, v21
    v_mul_f32 v65, v65, v21
    v_mul_f32 v66, v66, v21
    v_mul_f32 v67, v67, v21
    v_mul_f32 v68, v68, v21
    v_mul_f32 v69, v69, v21
    v_mul_f32 v70, v70, v21
    v_mul_f32 v71, v71, v21
    v_mul_f32 v72, v72, v21
    v_mul_f32 v73, v73, v21
    v_mul_f32 v74, v74, v21
    v_mul_f32 v75, v75, v21
    v_mul_f32 v76, v76, v21
    v_mul_f32 v77, v77, v21
    v_mul_f32 v78, v78, v21
    v_mul_f32 v79, v79, v21
    v_mul_f32 v80, v80, v21
    v_mul_f32 v81, v81, v21
    v_mul_f32 v82, v82, v21
    v_mul_f32 v83, v83, v21
    v_mul_f32 v84, v84, v21
    v_mul_f32 v85, v85, v21
    v_mul_f32 v86, v86, v21
    v_mul_f32 v87, v87, v21
    v_mul_f32 v88, v88, v21
    v_mul_f32 v89, v89, v21
    v_mul_f32 v90, v90, v21
    v_mul_f32 v91, v91, v21
    v_mul_f32 v92, v92, v21
    v_mul_f32 v93, v93, v21
    v_mul_f32 v94, v94, v21
    v_mul_f32 v95, v95, v21
    s_waitcnt vmcnt(0)
    s_barrier
    ds_read_b64_tr_b16 a[32:33], v9 offset:49152
    ds_read_b64_tr_b16 a[34:35], v9 offset:51200
    ds_read_b64_tr_b16 a[36:37], v10 offset:49152
    ds_read_b64_tr_b16 a[38:39], v10 offset:51200
    ds_read_b64_tr_b16 a[40:41], v11 offset:49152
    ds_read_b64_tr_b16 a[42:43], v11 offset:51200
    ds_read_b64_tr_b16 a[44:45], v12 offset:49152
    ds_read_b64_tr_b16 a[46:47], v12 offset:51200
    ds_read_b64_tr_b16 a[48:49], v9 offset:53248
    ds_read_b64_tr_b16 a[50:51], v9 offset:55296
    ds_read_b64_tr_b16 a[52:53], v10 offset:53248
    ds_read_b64_tr_b16 a[54:55], v10 offset:55296
    s_waitcnt lgkmcnt(10)
    v_mfma_f32_32x32x16_bf16 v[32:47], a[32:35], v[160:163], v[32:47]
    ds_read_b64_tr_b16 a[56:57], v11 offset:53248
    ds_read_b64_tr_b16 a[58:59], v11 offset:55296
    s_waitcnt lgkmcnt(10)
    v_mfma_f32_32x32x16_bf16 v[48:63], a[36:39], v[160:163], v[48:63]
    ds_read_b64_tr_b16 a[60:61], v12 offset:53248
    ds_read_b64_tr_b16 a[62:63], v12 offset:55296
    s_waitcnt lgkmcnt(10)
    v_mfma_f32_32x32x16_bf16 v[64:79], a[40:43], v[160:163], v[64:79]
    ds_read_b64_tr_b16 a[64:65], v9 offset:57344
    ds_read_b64_tr_b16 a[66:67], v9 offset:59392
    s_waitcnt lgkmcnt(10)
    v_mfma_f32_32x32x16_bf16 v[80:95], a[44:47], v[160:163], v[80:95]
    ds_read_b64_tr_b16 a[68:69], v10 offset:57344
    ds_read_b64_tr_b16 a[70:71], v10 offset:59392
    s_waitcnt lgkmcnt(10)
    v_mfma_f32_32x32x16_bf16 v[32:47], a[48:51], v[164:167], v[32:47]
    ds_read_b64_tr_b16 a[72:73], v11 offset:57344
    ds_read_b64_tr_b16 a[74:75], v11 offset:59392
    s_waitcnt lgkmcnt(10)
    v_mfma_f32_32x32x16_bf16 v[48:63], a[52:55], v[164:167], v[48:63]
    ds_read_b64_tr_b16 a[76:77], v12 offset:57344
    ds_read_b64_tr_b16 a[78:79], v12 offset:59392
    s_waitcnt lgkmcnt(10)
    v_mfma_f32_32x32x16_bf16 v[64:79], a[56:59], v[164:167], v[64:79]
    ds_read_b64_tr_b16 a[80:81], v9 offset:61440
    ds_read_b64_tr_b16 a[82:83], v9 offset:63488
    s_waitcnt lgkmcnt(10)
    v_mfma_f32_32x32x16_bf16 v[80:95], a[60:63], v[164:167], v[80:95]
    ds_read_b64_tr_b16 a[84:85], v10 offset:61440
    ds_read_b64_tr_b16 a[86:87], v10 offset:63488
    s_waitcnt lgkmcnt(10)
    v_mfma_f32_32x32x16_bf16 v[32:47], a[64:67], v[168:171], v[32:47]
    ds_read_b64_tr_b16 a[88:89], v11 offset:61440
    ds_read_b64_tr_b16 a[90:91], v11 offset:63488
    s_waitcnt lgkmcnt(10)
    v_mfma_f32_32x32x16_bf16 v[48:63], a[68:71], v[168:171], v[48:63]
    ds_read_b64_tr_b16 a[92:93], v12 offset:61440
    ds_read_b64_tr_b16 a[94:95], v12 offset:63488
    s_waitcnt lgkmcnt(10)
    v_mfma_f32_32x32x16_bf16 v[64:79], a[72:75], v[168:171], v[64:79]
    s_waitcnt lgkmcnt(8)
    v_mfma_f32_32x32x16_bf16 v[80:95], a[76:79], v[168:171], v[80:95]
    s_waitcnt lgkmcnt(6)
    v_mfma_f32_32x32x16_bf16 v[32:47], a[80:83], v[172:175], v[32:47]
    s_waitcnt lgkmcnt(4)
    v_mfma_f32_32x32x16_bf16 v[48:63], a[84:87], v[172:175], v[48:63]
    s_waitcnt lgkmcnt(2)
    v_mfma_f32_32x32x16_bf16 v[64:79], a[88:91], v[172:175], v[64:79]
    s_waitcnt lgkmcnt(0)
    v_mfma_f32_32x32x16_bf16 v[80:95], a[92:95], v[172:175], v[80:95]
    s_nop 15
    v_mov_b32 v23, v20
    s_nop 1
    v_permlane32_swap_b32 v20, v23
    s_nop 1
    v_add_f32 v20, v20, v23
    v_rcp_f32 v20, v20
    s_lshl_b32 s30, s3, 13
    v_and_b32 v31, 31, v0
    v_and_b32 v22, 15, v31
    v_lshlrev_b32 v31, 8, v31
    v_lshrrev_b32 v19, 5, v0
    v_lshl_add_u32 v31, v19, 3, v31
    v_add_u32 v31, s30, v31
    v_mul_f32 v32, v32, v20
    v_mul_f32 v33, v33, v20
    v_mul_f32 v34, v34, v20
    v_mul_f32 v35, v35, v20
    v_cvt_pk_bf16_f32 v96, v32, v33
    v_cvt_pk_bf16_f32 v97, v34, v35
    v_xor_b32 v18, 0, v22
    v_lshl_add_u32 v18, v18, 4, v31
    ds_write_b64 v18, v[96:97]
    v_mul_f32 v36, v36, v20
    v_mul_f32 v37, v37, v20
    v_mul_f32 v38, v38, v20
    v_mul_f32 v39, v39, v20
    v_cvt_pk_bf16_f32 v98, v36, v37
    v_cvt_pk_bf16_f32 v99, v38, v39
    v_xor_b32 v18, 1, v22
    v_lshl_add_u32 v18, v18, 4, v31
    ds_write_b64 v18, v[98:99]
    v_mul_f32 v40, v40, v20
    v_mul_f32 v41, v41, v20
    v_mul_f32 v42, v42, v20
    v_mul_f32 v43, v43, v20
    v_cvt_pk_bf16_f32 v100, v40, v41
    v_cvt_pk_bf16_f32 v101, v42, v43
    v_xor_b32 v18, 2, v22
    v_lshl_add_u32 v18, v18, 4, v31
    ds_write_b64 v18, v[100:101]
    v_mul_f32 v44, v44, v20
    v_mul_f32 v45, v45, v20
    v_mul_f32 v46, v46, v20
    v_mul_f32 v47, v47, v20
    v_cvt_pk_bf16_f32 v102, v44, v45
    v_cvt_pk_bf16_f32 v103, v46, v47
    v_xor_b32 v18, 3, v22
    v_lshl_add_u32 v18, v18, 4, v31
    ds_write_b64 v18, v[102:103]
    v_mul_f32 v48, v48, v20
    v_mul_f32 v49, v49, v20
    v_mul_f32 v50, v50, v20
    v_mul_f32 v51, v51, v20
    v_cvt_pk_bf16_f32 v104, v48, v49
    v_cvt_pk_bf16_f32 v105, v50, v51
    v_xor_b32 v18, 4, v22
    v_lshl_add_u32 v18, v18, 4, v31
    ds_write_b64 v18, v[104:105]
    v_mul_f32 v52, v52, v20
    v_mul_f32 v53, v53, v20
    v_mul_f32 v54, v54, v20
    v_mul_f32 v55, v55, v20
    v_cvt_pk_bf16_f32 v106, v52, v53
    v_cvt_pk_bf16_f32 v107, v54, v55
    v_xor_b32 v18, 5, v22
    v_lshl_add_u32 v18, v18, 4, v31
    ds_write_b64 v18, v[106:107]
    v_mul_f32 v56, v56, v20
    v_mul_f32 v57, v57, v20
    v_mul_f32 v58, v58, v20
    v_mul_f32 v59, v59, v20
    v_cvt_pk_bf16_f32 v108, v56, v57
    v_cvt_pk_bf16_f32 v109, v58, v59
    v_xor_b32 v18, 6, v22
    v_lshl_add_u32 v18, v18, 4, v31
    ds_write_b64 v18, v[108:109]
    v_mul_f32 v60, v60, v20
    v_mul_f32 v61, v61, v20
    v_mul_f32 v62, v62, v20
    v_mul_f32 v63, v63, v20
    v_cvt_pk_bf16_f32 v110, v60, v61
    v_cvt_pk_bf16_f32 v111, v62, v63
    v_xor_b32 v18, 7, v22
    v_lshl_add_u32 v18, v18, 4, v31
    ds_write_b64 v18, v[110:111]
    v_mul_f32 v64, v64, v20
    v_mul_f32 v65, v65, v20
    v_mul_f32 v66, v66, v20
    v_mul_f32 v67, v67, v20
    v_cvt_pk_bf16_f32 v112, v64, v65
    v_cvt_pk_bf16_f32 v113, v66, v67
    v_xor_b32 v18, 8, v22
    v_lshl_add_u32 v18, v18, 4, v31
    ds_write_b64 v18, v[112:113]
    v_mul_f32 v68, v68, v20
    v_mul_f32 v69, v69, v20
    v_mul_f32 v70, v70, v20
    v_mul_f32 v71, v71, v20
    v_cvt_pk_bf16_f32 v114, v68, v69
    v_cvt_pk_bf16_f32 v115, v70, v71
    v_xor_b32 v18, 9, v22
    v_lshl_add_u32 v18, v18, 4, v31
    ds_write_b64 v18, v[114:115]
    v_mul_f32 v72, v72, v20
    v_mul_f32 v73, v73, v20
    v_mul_f32 v74, v74, v20
    v_mul_f32 v75, v75, v20
    v_cvt_pk_bf16_f32 v116, v72, v73
    v_cvt_pk_bf16_f32 v117, v74, v75
    v_xor_b32 v18, 10, v22
    v_lshl_add_u32 v18, v18, 4, v31
    ds_write_b64 v18, v[116:117]
    v_mul_f32 v76, v76, v20
    v_mul_f32 v77, v77, v20
    v_mul_f32 v78, v78, v20
    v_mul_f32 v79, v79, v20
    v_cvt_pk_bf16_f32 v118, v76, v77
    v_cvt_pk_bf16_f32 v119, v78, v79
    v_xor_b32 v18, 11, v22
    v_lshl_add_u32 v18, v18, 4, v31
    ds_write_b64 v18, v[118:119]
    v_mul_f32 v80, v80, v20
    v_mul_f32 v81, v81, v20
    v_mul_f32 v82, v82, v20
    v_mul_f32 v83, v83, v20
    v_cvt_pk_bf16_f32 v120, v80, v81
    v_cvt_pk_bf16_f32 v121, v82, v83
    v_xor_b32 v18, 12, v22
    v_lshl_add_u32 v18, v18, 4, v31
    ds_write_b64 v18, v[120:121]
    v_mul_f32 v84, v84, v20
    v_mul_f32 v85, v85, v20
    v_mul_f32 v86, v86, v20
    v_mul_f32 v87, v87, v20
    v_cvt_pk_bf16_f32 v122, v84, v85
    v_cvt_pk_bf16_f32 v123, v86, v87
    v_xor_b32 v18, 13, v22
    v_lshl_add_u32 v18, v18, 4, v31
    ds_write_b64 v18, v[122:123]
    v_mul_f32 v88, v88, v20
    v_mul_f32 v89, v89, v20
    v_mul_f32 v90, v90, v20
    v_mul_f32 v91, v91, v20
    v_cvt_pk_bf16_f32 v124, v88, v89
    v_cvt_pk_bf16_f32 v125, v90, v91
    v_xor_b32 v18, 14, v22
    v_lshl_add_u32 v18, v18, 4, v31
    ds_write_b64 v18, v[124:125]
    v_mul_f32 v92, v92, v20
    v_mul_f32 v93, v93, v20
    v_mul_f32 v94, v94, v20
    v_mul_f32 v95, v95, v20
    v_cvt_pk_bf16_f32 v126, v92, v93
    v_cvt_pk_bf16_f32 v127, v94, v95
    v_xor_b32 v18, 15, v22
    v_lshl_add_u32 v18, v18, 4, v31
    ds_write_b64 v18, v[126:127]
    v_lshrrev_b32 v19, 4, v0
    v_and_b32 v22, 15, v0
    s_lshl_b32 s31, s3, 15
    s_waitcnt lgkmcnt(0)
    v_add_u32 v18, 0, v19
    v_xor_b32 v21, v18, v22
    v_and_b32 v21, 15, v21
    v_lshlrev_b32 v21, 4, v21
    v_lshl_add_u32 v21, v18, 8, v21
    v_add_u32 v21, s30, v21
    ds_read_b128 v[32:35], v21
    v_add_u32 v18, 4, v19
    v_xor_b32 v21, v18, v22
    v_and_b32 v21, 15, v21
    v_lshlrev_b32 v21, 4, v21
    v_lshl_add_u32 v21, v18, 8, v21
    v_add_u32 v21, s30, v21
    ds_read_b128 v[36:39], v21
    v_add_u32 v18, 8, v19
    v_xor_b32 v21, v18, v22
    v_and_b32 v21, 15, v21
    v_lshlrev_b32 v21, 4, v21
    v_lshl_add_u32 v21, v18, 8, v21
    v_add_u32 v21, s30, v21
    ds_read_b128 v[40:43], v21
    v_add_u32 v18, 12, v19
    v_xor_b32 v21, v18, v22
    v_and_b32 v21, 15, v21
    v_lshlrev_b32 v21, 4, v21
    v_lshl_add_u32 v21, v18, 8, v21
    v_add_u32 v21, s30, v21
    ds_read_b128 v[44:47], v21
    v_add_u32 v18, 16, v19
    v_xor_b32 v21, v18, v22
    v_and_b32 v21, 15, v21
    v_lshlrev_b32 v21, 4, v21
    v_lshl_add_u32 v21, v18, 8, v21
    v_add_u32 v21, s30, v21
    ds_read_b128 v[48:51], v21
    v_add_u32 v18, 20, v19
    v_xor_b32 v21, v18, v22
    v_and_b32 v21, 15, v21
    v_lshlrev_b32 v21, 4, v21
    v_lshl_add_u32 v21, v18, 8, v21
    v_add_u32 v21, s30, v21
    ds_read_b128 v[52:55], v21
    v_add_u32 v18, 24, v19
    v_xor_b32 v21, v18, v22
    v_and_b32 v21, 15, v21
    v_lshlrev_b32 v21, 4, v21
    v_lshl_add_u32 v21, v18, 8, v21
    v_add_u32 v21, s30, v21
    ds_read_b128 v[56:59], v21
    v_add_u32 v18, 28, v19
    v_xor_b32 v21, v18, v22
    v_and_b32 v21, 15, v21
    v_lshlrev_b32 v21, 4, v21
    v_lshl_add_u32 v21, v18, 8, v21
    v_add_u32 v21, s30, v21
    ds_read_b128 v[60:63], v21
    v_lshlrev_b32 v22, 4, v22
    v_lshl_add_u32 v22, v19, 10, v22
    s_waitcnt lgkmcnt(7)
    s_add_u32 s48, s31, 0
    buffer_store_dwordx4 v[32:35], v22, s[24:27], s48 offen
    s_waitcnt lgkmcnt(6)
    s_add_u32 s48, s31, 4096
    buffer_store_dwordx4 v[36:39], v22, s[24:27], s48 offen
    s_waitcnt lgkmcnt(5)
    s_add_u32 s48, s31, 8192
    buffer_store_dwordx4 v[40:43], v22, s[24:27], s48 offen
    s_waitcnt lgkmcnt(4)
    s_add_u32 s48, s31, 12288
    buffer_store_dwordx4 v[44:47], v22, s[24:27], s48 offen
    s_waitcnt lgkmcnt(3)
    s_add_u32 s48, s31, 16384
    buffer_store_dwordx4 v[48:51], v22, s[24:27], s48 offen
    s_waitcnt lgkmcnt(2)
    s_add_u32 s48, s31, 20480
    buffer_store_dwordx4 v[52:55], v22, s[24:27], s48 offen
    s_waitcnt lgkmcnt(1)
    s_add_u32 s48, s31, 24576
    buffer_store_dwordx4 v[56:59], v22, s[24:27], s48 offen
    s_waitcnt lgkmcnt(0)
    s_add_u32 s48, s31, 28672
    buffer_store_dwordx4 v[60:63], v22, s[24:27], s48 offen
L_attn_done:
    s_endpgm
.globl oproj_kernel
.p2align 8
.type oproj_kernel,@function
oproj_kernel:
    s_cmp_ge_u32 s2, 192
    s_cbranch_scc1 L_oproj_done
    s_load_dwordx16 s[32:47], s[0:1], 0
    v_lshrrev_b32 v1, 6, v0
    s_nop 0
    v_readfirstlane_b32 s3, v1
    v_and_b32 v0, 63, v0
    s_and_b32 s6, s2, 7
    s_lshr_b32 s7, s2, 3
    s_mul_i32 s4, s7, 21846
    s_lshr_b32 s4, s4, 16
    s_mul_i32 s5, s4, 3
    s_sub_u32 s5, s7, s5
    s_waitcnt lgkmcnt(0)
    s_lshl_b32 s28, s4, 20
    s_lshl_b32 s29, s6, 17
    s_add_u32 s28, s28, s29
    s_add_u32 s8, s46, s28
    s_addc_u32 s9, s47, 0
    s_mov_b32 s10, 131072
    s_mov_b32 s11, 0x00020000
    s_mul_i32 s28, s6, 589824
    s_mul_i32 s29, s5, 384
    s_add_u32 s28, s28, s29
    s_add_u32 s12, s40, s28
    s_addc_u32 s13, s41, 0
    s_mov_b32 s14, 589056
    s_mov_b32 s15, 0x00020000
    s_mul_i32 s28, s6, 2359296
    s_mul_i32 s29, s4, 294912
    s_add_u32 s28, s28, s29
    s_mul_i32 s29, s5, 768
    s_add_u32 s28, s28, s29
    s_add_u32 s28, s28, 0x1000000
    s_add_u32 s16, s46, s28
    s_addc_u32 s17, s47, 0
    s_mov_b32 s18, 293376
    s_mov_b32 s19, 0x00020000
    v_and_b32 v31, 31, v0
    v_lshrrev_b32 v30, 5, v0
    v_lshrrev_b32 v21, 3, v0
    v_and_b32 v20, 7, v0
    v_xor_b32 v20, v20, v21
    v_lshlrev_b32 v20, 4, v20
    v_lshl_add_u32 v10, v21, 10, v20
    v_add_u32 v19, 0, v0
    v_mul_u32_u24 v18, 2731, v19
    v_lshrrev_b32 v18, 16, v18
    v_mul_u32_u24 v17, 24, v18
    v_sub_u32 v17, v19, v17
    v_bfe_u32 v16, v18, 1, 1
    v_lshlrev_b32 v16, 2, v16
    v_xor_b32 v17, v17, v16
    v_lshlrev_b32 v17, 4, v17
    v_mul_u32_u24 v18, 1152, v18
    v_add_u32 v11, v18, v17
    v_add_u32 v19, 64, v0
    v_mul_u32_u24 v18, 2731, v19
    v_lshrrev_b32 v18, 16, v18
    v_mul_u32_u24 v17, 24, v18
    v_sub_u32 v17, v19, v17
    v_bfe_u32 v16, v18, 1, 1
    v_lshlrev_b32 v16, 2, v16
    v_xor_b32 v17, v17, v16
    v_lshlrev_b32 v17, 4, v17
    v_mul_u32_u24 v18, 1152, v18
    v_add_u32 v12, v18, v17
    v_add_u32 v19, 128, v0
    v_mul_u32_u24 v18, 2731, v19
    v_lshrrev_b32 v18, 16, v18
    v_mul_u32_u24 v17, 24, v18
    v_sub_u32 v17, v19, v17
    v_bfe_u32 v16, v18, 1, 1
    v_lshlrev_b32 v16, 2, v16
    v_xor_b32 v17, v17, v16
    v_lshlrev_b32 v17, 4, v17
    v_mul_u32_u24 v18, 1152, v18
    v_add_u32 v13, v18, v17
    s_lshl_b32 s29, s3, 12
    s_lshl_b32 s30, s3, 15
    s_mul_i32 s31, s3, 6144
    s_mul_i32 s49, s3, 18432
    s_mul_i32 s50, s5, 3
    s_add_u32 s50, s50, s4
    s_add_u32 s51, s50, 0
    s_and_b32 s51, s51, 7
    s_lshl_b32 s52, s51, 7
    s_add_u32 s52, s52, s30
    s_mul_i32 s53, s51, 73728
    s_add_u32 s53, s53, s49
    s_add_u32 s48, s29, 0
    s_mov_b32 m0, s48
    s_add_u32 s48, s52, 0
    buffer_load_dwordx4 v10, s[8:11], s48 offen lds
    s_add_u32 s48, s29, 1024
    s_mov_b32 m0, s48
    s_add_u32 s48, s52, 8192
    buffer_load_dwordx4 v10, s[8:11], s48 offen lds
    s_add_u32 s48, s29, 2048
    s_mov_b32 m0, s48
    s_add_u32 s48, s52, 16384
    buffer_load_dwordx4 v10, s[8:11], s48 offen lds
    s_add_u32 s48, s29, 3072
    s_mov_b32 m0, s48
    s_add_u32 s48, s52, 24576
    buffer_load_dwordx4 v10, s[8:11], s48 offen lds
    s_add_u32 s48, s31, 65536
    s_mov_b32 m0, s48
    s_add_u32 s48, s53, 0
    buffer_load_dwordx4 v11, s[12:15], s48 offen lds
    s_add_u32 s48, s31, 66560
    s_mov_b32 m0, s48
    s_add_u32 s48, s53, 0
    buffer_load_dwordx4 v12, s[12:15], s48 offen lds
    s_add_u32 s48, s31, 67584
    s_mov_b32 m0, s48
    s_add_u32 s48, s53, 0
    buffer_load_dwordx4 v13, s[12:15], s48 offen lds
    s_add_u32 s48, s31, 68608
    s_mov_b32 m0, s48
    s_add_u32 s48, s53, 9216
    buffer_load_dwordx4 v11, s[12:15], s48 offen lds
    s_add_u32 s48, s31, 69632
    s_mov_b32 m0, s48
    s_add_u32 s48, s53, 9216
    buffer_load_dwordx4 v12, s[12:15], s48 offen lds
    s_add_u32 s48, s31, 70656
    s_mov_b32 m0, s48
    s_add_u32 s48, s53, 9216
    buffer_load_dwordx4 v13, s[12:15], s48 offen lds
    s_add_u32 s51, s50, 1
    s_and_b32 s51, s51, 7
    s_lshl_b32 s52, s51, 7
    s_add_u32 s52, s52, s30
    s_mul_i32 s53, s51, 73728
    s_add_u32 s53, s53, s49
    s_add_u32 s48, s29, 16384
    s_mov_b32 m0, s48
    s_add_u32 s48, s52, 0
    buffer_load_dwordx4 v10, s[8:11], s48 offen lds
    s_add_u32 s48, s29, 17408
    s_mov_b32 m0, s48
    s_add_u32 s48, s52, 8192
    buffer_load_dwordx4 v10, s[8:11], s48 offen lds
    s_add_u32 s48, s29, 18432
    s_mov_b32 m0, s48
    s_add_u32 s48, s52, 16384
    buffer_load_dwordx4 v10, s[8:11], s48 offen lds
    s_add_u32 s48, s29, 19456
    s_mov_b32 m0, s48
    s_add_u32 s48, s52, 24576
    buffer_load_dwordx4 v10, s[8:11], s48 offen lds
    s_add_u32 s48, s31, 90112
    s_mov_b32 m0, s48
    s_add_u32 s48, s53, 0
    buffer_load_dwordx4 v11, s[12:15], s48 offen lds
    s_add_u32 s48, s31, 91136
    s_mov_b32 m0, s48
    s_add_u32 s48, s53, 0
    buffer_load_dwordx4 v12, s[12:15], s48 offen lds
    s_add_u32 s48, s31, 92160
    s_mov_b32 m0, s48
    s_add_u32 s48, s53, 0
    buffer_load_dwordx4 v13, s[12:15], s48 offen lds
    s_add_u32 s48, s31, 93184
    s_mov_b32 m0, s48
    s_add_u32 s48, s53, 9216
    buffer_load_dwordx4 v11, s[12:15], s48 offen lds
    s_add_u32 s48, s31, 94208
    s_mov_b32 m0, s48
    s_add_u32 s48, s53, 9216
    buffer_load_dwordx4 v12, s[12:15], s48 offen lds
    s_add_u32 s48, s31, 95232
    s_mov_b32 m0, s48
    s_add_u32 s48, s53, 9216
    buffer_load_dwordx4 v13, s[12:15], s48 offen lds
    s_add_u32 s51, s50, 2
    s_and_b32 s51, s51, 7
    s_lshl_b32 s52, s51, 7
    s_add_u32 s52, s52, s30
    s_mul_i32 s53, s51, 73728
    s_add_u32 s53, s53, s49
    s_add_u32 s48, s29, 32768
    s_mov_b32 m0, s48
    s_add_u32 s48, s52, 0
    buffer_load_dwordx4 v10, s[8:11], s48 offen lds
    s_add_u32 s48, s29, 33792
    s_mov_b32 m0, s48
    s_add_u32 s48, s52, 8192
    buffer_load_dwordx4 v10, s[8:11], s48 offen lds
    s_add_u32 s48, s29, 34816
    s_mov_b32 m0, s48
    s_add_u32 s48, s52, 16384
    buffer_load_dwordx4 v10, s[8:11], s48 offen lds
    s_add_u32 s48, s29, 35840
    s_mov_b32 m0, s48
    s_add_u32 s48, s52, 24576
    buffer_load_dwordx4 v10, s[8:11], s48 offen lds
    s_add_u32 s48, s31, 114688
    s_mov_b32 m0, s48
    s_add_u32 s48, s53, 0
    buffer_load_dwordx4 v11, s[12:15], s48 offen lds
    s_add_u32 s48, s31, 115712
    s_mov_b32 m0, s48
    s_add_u32 s48, s53, 0
    buffer_load_dwordx4 v12, s[12:15], s48 offen lds
    s_add_u32 s48, s31, 116736
    s_mov_b32 m0, s48
    s_add_u32 s48, s53, 0
    buffer_load_dwordx4 v13, s[12:15], s48 offen lds
    s_add_u32 s48, s31, 117760
    s_mov_b32 m0, s48
    s_add_u32 s48, s53, 9216
    buffer_load_dwordx4 v11, s[12:15], s48 offen lds
    s_add_u32 s48, s31, 118784
    s_mov_b32 m0, s48
    s_add_u32 s48, s53, 9216
    buffer_load_dwordx4 v12, s[12:15], s48 offen lds
    s_add_u32 s48, s31, 119808
    s_mov_b32 m0, s48
    s_add_u32 s48, s53, 9216
    buffer_load_dwordx4 v13, s[12:15], s48 offen lds
    s_lshr_b32 s6, s3, 1
    s_and_b32 s7, s3, 1
    s_lshl_b32 s28, s6, 6
    v_add_u32 v29, s28, v31
    v_and_b32 v28, 7, v31
    v_or_b32 v27, 0, v30
    v_xor_b32 v27, v27, v28
    v_lshlrev_b32 v27, 4, v27
    v_lshl_add_u32 v1, v29, 7, v27
    v_or_b32 v27, 2, v30
    v_xor_b32 v27, v27, v28
    v_lshlrev_b32 v27, 4, v27
    v_lshl_add_u32 v2, v29, 7, v27
    v_or_b32 v27, 4, v30
    v_xor_b32 v27, v27, v28
    v_lshlrev_b32 v27, 4, v27
    v_lshl_add_u32 v3, v29, 7, v27
    v_or_b32 v27, 6, v30
    v_xor_b32 v27, v27, v28
    v_lshlrev_b32 v27, 4, v27
    v_lshl_add_u32 v4, v29, 7, v27
    v_bfe_u32 v27, v0, 2, 2
    v_bfe_u32 v26, v0, 4, 1
    v_and_b32 v25, 3, v0
    v_lshrrev_b32 v24, 1, v25
    v_lshl_add_u32 v24, v26, 1, v24
    s_mul_i32 s28, s7, 12
    v_add_u32 v24, s28, v24
    v_lshrrev_b32 v23, 1, v27
    v_lshlrev_b32 v23, 2, v23
    v_lshl_add_u32 v22, v30, 3, v27
    v_mul_u32_u24 v22, 384, v22
    v_and_b32 v21, 1, v25
    v_lshl_add_u32 v22, v21, 3, v22
    v_add_u32 v22, 65536, v22
    v_add_u32 v21, 0, v24
    v_xor_b32 v21, v21, v23
    v_lshl_add_u32 v5, v21, 4, v22
    v_add_u32 v14, 49152, v5
    v_add_u32 v21, 4, v24
    v_xor_b32 v21, v21, v23
    v_lshl_add_u32 v6, v21, 4, v22
    v_add_u32 v15, 49152, v6
    v_add_u32 v21, 8, v24
    v_xor_b32 v21, v21, v23
    v_lshl_add_u32 v7, v21, 4, v22
    v_add_u32 v16, 49152, v7
    s_waitcnt vmcnt(20)
    s_barrier
    s_add_u32 s51, s50, 3
    s_and_b32 s51, s51, 7
    s_lshl_b32 s52, s51, 7
    s_add_u32 s52, s52, s30
    s_mul_i32 s53, s51, 73728
    s_add_u32 s53, s53, s49
    s_add_u32 s48, s29, 49152
    s_mov_b32 m0, s48
    s_add_u32 s48, s52, 0
    buffer_load_dwordx4 v10, s[8:11], s48 offen lds
    s_add_u32 s48, s29, 50176
    s_mov_b32 m0, s48
    s_add_u32 s48, s52, 8192
    buffer_load_dwordx4 v10, s[8:11], s48 offen lds
    s_add_u32 s48, s29, 51200
    s_mov_b32 m0, s48
    s_add_u32 s48, s52, 16384
    buffer_load_dwordx4 v10, s[8:11], s48 offen lds
    s_add_u32 s48, s29, 52224
    s_mov_b32 m0, s48
    s_add_u32 s48, s52, 24576
    buffer_load_dwordx4 v10, s[8:11], s48 offen lds
    s_add_u32 s48, s31, 139264
    s_mov_b32 m0, s48
    s_add_u32 s48, s53, 0
    buffer_load_dwordx4 v11, s[12:15], s48 offen lds
    s_add_u32 s48, s31, 140288
    s_mov_b32 m0, s48
    s_add_u32 s48, s53, 0
    buffer_load_dwordx4 v12, s[12:15], s48 offen lds
    s_add_u32 s48, s31, 141312
    s_mov_b32 m0, s48
    s_add_u32 s48, s53, 0
    buffer_load_dwordx4 v13, s[12:15], s48 offen lds
    s_add_u32 s48, s31, 142336
    s_mov_b32 m0, s48
    s_add_u32 s48, s53, 9216
    buffer_load_dwordx4 v11, s[12:15], s48 offen lds
    s_add_u32 s48, s31, 143360
    s_mov_b32 m0, s48
    s_add_u32 s48, s53, 9216
    buffer_load_dwordx4 v12, s[12:15], s48 offen lds
    s_add_u32 s48, s31, 144384
    s_mov_b32 m0, s48
    s_add_u32 s48, s53, 9216
    buffer_load_dwordx4 v13, s[12:15], s48 offen lds
    ds_read_b128 v[128:131], v1 offset:0
    ds_read_b128 v[132:135], v1 offset:4096
    ds_read_b64_tr_b16 v[144:145], v5 offset:0
    ds_read_b64_tr_b16 v[146:147], v5 offset:1536
    ds_read_b64_tr_b16 v[148:149], v6 offset:0
    ds_read_b64_tr_b16 v[150:151], v6 offset:1536
    ds_read_b64_tr_b16 v[152:153], v7 offset:0
    ds_read_b64_tr_b16 v[154:155], v7 offset:1536
    ds_read_b128 v[136:139], v2 offset:0
    ds_read_b128 v[140:143], v2 offset:4096
    ds_read_b64_tr_b16 v[156:157], v5 offset:6144
    ds_read_b64_tr_b16 v[158:159], v5 offset:7680
    ds_read_b64_tr_b16 v[160:161], v6 offset:6144
    ds_read_b64_tr_b16 v[162:163], v6 offset:7680
    ds_read_b64_tr_b16 v[164:165], v7 offset:6144
    ds_read_b64_tr_b16 v[166:167], v7 offset:7680
    s_waitcnt lgkmcnt(8)
    v_mfma_f32_32x32x16_bf16 v[32:47], v[128:131], v[144:147], 0
    v_mfma_f32_32x32x16_bf16 v[48:63], v[128:131], v[148:151], 0
    v_mfma_f32_32x32x16_bf16 v[64:79], v[128:131], v[152:155], 0
    v_mfma_f32_32x32x16_bf16 v[80:95], v[132:135], v[144:147], 0
    v_mfma_f32_32x32x16_bf16 v[96:111], v[132:135], v[148:151], 0
    v_mfma_f32_32x32x16_bf16 v[112:127], v[132:135], v[152:155], 0
    ds_read_b128 v[128:131], v3 offset:0
    ds_read_b128 v[132:135], v3 offset:4096
    ds_read_b64_tr_b16 v[144:145], v5 offset:12288
    ds_read_b64_tr_b16 v[146:147], v5 offset:13824
    ds_read_b64_tr_b16 v[148:149], v6 offset:12288
    ds_read_b64_tr_b16 v[150:151], v6 offset:13824
    ds_read_b64_tr_b16 v[152:153], v7 offset:12288
    ds_read_b64_tr_b16 v[154:155], v7 offset:13824
    s_waitcnt lgkmcnt(8)
    v_mfma_f32_32x32x16_bf16 v[32:47], v[136:139], v[156:159], v[32:47]
    v_mfma_f32_32x32x16_bf16 v[48:63], v[136:139], v[160:163], v[48:63]
    v_mfma_f32_32x32x16_bf16 v[64:79], v[136:139], v[164:167], v[64:79]
    v_mfma_f32_32x32x16_bf16 v[80:95], v[140:143], v[156:159], v[80:95]
    v_mfma_f32_32x32x16_bf16 v[96:111], v[140:143], v[160:163], v[96:111]
    v_mfma_f32_32x32x16_bf16 v[112:127], v[140:143], v[164:167], v[112:127]
    ds_read_b128 v[136:139], v4 offset:0
    ds_read_b128 v[140:143], v4 offset:4096
    ds_read_b64_tr_b16 v[156:157], v5 offset:18432
    ds_read_b64_tr_b16 v[158:159], v5 offset:19968
    ds_read_b64_tr_b16 v[160:161], v6 offset:18432
    ds_read_b64_tr_b16 v[162:163], v6 offset:19968
    ds_read_b64_tr_b16 v[164:165], v7 offset:18432
    ds_read_b64_tr_b16 v[166:167], v7 offset:19968
    s_waitcnt lgkmcnt(8)
    v_mfma_f32_32x32x16_bf16 v[32:47], v[128:131], v[144:147], v[32:47]
    v_mfma_f32_32x32x16_bf16 v[48:63], v[128:131], v[148:151], v[48:63]
    v_mfma_f32_32x32x16_bf16 v[64:79], v[128:131], v[152:155], v[64:79]
    v_mfma_f32_32x32x16_bf16 v[80:95], v[132:135], v[144:147], v[80:95]
    v_mfma_f32_32x32x16_bf16 v[96:111], v[132:135], v[148:151], v[96:111]
    v_mfma_f32_32x32x16_bf16 v[112:127], v[132:135], v[152:155], v[112:127]
    s_waitcnt lgkmcnt(0)
    v_mfma_f32_32x32x16_bf16 v[32:47], v[136:139], v[156:159], v[32:47]
    v_mfma_f32_32x32x16_bf16 v[48:63], v[136:139], v[160:163], v[48:63]
    v_mfma_f32_32x32x16_bf16 v[64:79], v[136:139], v[164:167], v[64:79]
    v_mfma_f32_32x32x16_bf16 v[80:95], v[140:143], v[156:159], v[80:95]
    v_mfma_f32_32x32x16_bf16 v[96:111], v[140:143], v[160:163], v[96:111]
    v_mfma_f32_32x32x16_bf16 v[112:127], v[140:143], v[164:167], v[112:127]
    s_waitcnt vmcnt(20)
    s_barrier
    s_add_u32 s51, s50, 4
    s_and_b32 s51, s51, 7
    s_lshl_b32 s52, s51, 7
    s_add_u32 s52, s52, s30
    s_mul_i32 s53, s51, 73728
    s_add_u32 s53, s53, s49
    s_add_u32 s48, s29, 0
    s_mov_b32 m0, s48
    s_add_u32 s48, s52, 0
    buffer_load_dwordx4 v10, s[8:11], s48 offen lds
    s_add_u32 s48, s29, 1024
    s_mov_b32 m0, s48
    s_add_u32 s48, s52, 8192
    buffer_load_dwordx4 v10, s[8:11], s48 offen lds
    s_add_u32 s48, s29, 2048
    s_mov_b32 m0, s48
    s_add_u32 s48, s52, 16384
    buffer_load_dwordx4 v10, s[8:11], s48 offen lds
    s_add_u32 s48, s29, 3072
    s_mov_b32 m0, s48
    s_add_u32 s48, s52, 24576
    buffer_load_dwordx4 v10, s[8:11], s48 offen lds
    s_add_u32 s48, s31, 65536
    s_mov_b32 m0, s48
    s_add_u32 s48, s53, 0
    buffer_load_dwordx4 v11, s[12:15], s48 offen lds
    s_add_u32 s48, s31, 66560
    s_mov_b32 m0, s48
    s_add_u32 s48, s53, 0
    buffer_load_dwordx4 v12, s[12:15], s48 offen lds
    s_add_u32 s48, s31, 67584
    s_mov_b32 m0, s48
    s_add_u32 s48, s53, 0
    buffer_load_dwordx4 v13, s[12:15], s48 offen lds
    s_add_u32 s48, s31, 68608
    s_mov_b32 m0, s48
    s_add_u32 s48, s53, 9216
    buffer_load_dwordx4 v11, s[12:15], s48 offen lds
    s_add_u32 s48, s31, 69632
    s_mov_b32 m0, s48
    s_add_u32 s48, s53, 9216
    buffer_load_dwordx4 v12, s[12:15], s48 offen lds
    s_add_u32 s48, s31, 70656
    s_mov_b32 m0, s48
    s_add_u32 s48, s53, 9216
    buffer_load_dwordx4 v13, s[12:15], s48 offen lds
    ds_read_b128 v[128:131], v1 offset:16384
    ds_read_b128 v[132:135], v1 offset:20480
    ds_read_b64_tr_b16 v[144:145], v5 offset:24576
    ds_read_b64_tr_b16 v[146:147], v5 offset:26112
    ds_read_b64_tr_b16 v[148:149], v6 offset:24576
    ds_read_b64_tr_b16 v[150:151], v6 offset:26112
    ds_read_b64_tr_b16 v[152:153], v7 offset:24576
    ds_read_b64_tr_b16 v[154:155], v7 offset:26112
    ds_read_b128 v[136:139], v2 offset:16384
    ds_read_b128 v[140:143], v2 offset:20480
    ds_read_b64_tr_b16 v[156:157], v5 offset:30720
    ds_read_b64_tr_b16 v[158:159], v5 offset:32256
    ds_read_b64_tr_b16 v[160:161], v6 offset:30720
    ds_read_b64_tr_b16 v[162:163], v6 offset:32256
    ds_read_b64_tr_b16 v[164:165], v7 offset:30720
    ds_read_b64_tr_b16 v[166:167], v7 offset:32256
    s_waitcnt lgkmcnt(8)
    v_mfma_f32_32x32x16_bf16 v[32:47], v[128:131], v[144:147], v[32:47]
    v_mfma_f32_32x32x16_bf16 v[48:63], v[128:131], v[148:151], v[48:63]
    v_mfma_f32_32x32x16_bf16 v[64:79], v[128:131], v[152:155], v[64:79]
    v_mfma_f32_32x32x16_bf16 v[80:95], v[132:135], v[144:147], v[80:95]
    v_mfma_f32_32x32x16_bf16 v[96:111], v[132:135], v[148:151], v[96:111]
    v_mfma_f32_32x32x16_bf16 v[112:127], v[132:135], v[152:155], v[112:127]
    ds_read_b128 v[128:131], v3 offset:16384
    ds_read_b128 v[132:135], v3 offset:20480
    ds_read_b64_tr_b16 v[144:145], v5 offset:36864
    ds_read_b64_tr_b16 v[146:147], v5 offset:38400
    ds_read_b64_tr_b16 v[148:149], v6 offset:36864
    ds_read_b64_tr_b16 v[150:151], v6 offset:38400
    ds_read_b64_tr_b16 v[152:153], v7 offset:36864
    ds_read_b64_tr_b16 v[154:155], v7 offset:38400
    s_waitcnt lgkmcnt(8)
    v_mfma_f32_32x32x16_bf16 v[32:47], v[136:139], v[156:159], v[32:47]
    v_mfma_f32_32x32x16_bf16 v[48:63], v[136:139], v[160:163], v[48:63]
    v_mfma_f32_32x32x16_bf16 v[64:79], v[136:139], v[164:167], v[64:79]
    v_mfma_f32_32x32x16_bf16 v[80:95], v[140:143], v[156:159], v[80:95]
    v_mfma_f32_32x32x16_bf16 v[96:111], v[140:143], v[160:163], v[96:111]
    v_mfma_f32_32x32x16_bf16 v[112:127], v[140:143], v[164:167], v[112:127]
    ds_read_b128 v[136:139], v4 offset:16384
    ds_read_b128 v[140:143], v4 offset:20480
    ds_read_b64_tr_b16 v[156:157], v5 offset:43008
    ds_read_b64_tr_b16 v[158:159], v5 offset:44544
    ds_read_b64_tr_b16 v[160:161], v6 offset:43008
    ds_read_b64_tr_b16 v[162:163], v6 offset:44544
    ds_read_b64_tr_b16 v[164:165], v7 offset:43008
    ds_read_b64_tr_b16 v[166:167], v7 offset:44544
    s_waitcnt lgkmcnt(8)
    v_mfma_f32_32x32x16_bf16 v[32:47], v[128:131], v[144:147], v[32:47]
    v_mfma_f32_32x32x16_bf16 v[48:63], v[128:131], v[148:151], v[48:63]
    v_mfma_f32_32x32x16_bf16 v[64:79], v[128:131], v[152:155], v[64:79]
    v_mfma_f32_32x32x16_bf16 v[80:95], v[132:135], v[144:147], v[80:95]
    v_mfma_f32_32x32x16_bf16 v[96:111], v[132:135], v[148:151], v[96:111]
    v_mfma_f32_32x32x16_bf16 v[112:127], v[132:135], v[152:155], v[112:127]
    s_waitcnt lgkmcnt(0)
    v_mfma_f32_32x32x16_bf16 v[32:47], v[136:139], v[156:159], v[32:47]
    v_mfma_f32_32x32x16_bf16 v[48:63], v[136:139], v[160:163], v[48:63]
    v_mfma_f32_32x32x16_bf16 v[64:79], v[136:139], v[164:167], v[64:79]
    v_mfma_f32_32x32x16_bf16 v[80:95], v[140:143], v[156:159], v[80:95]
    v_mfma_f32_32x32x16_bf16 v[96:111], v[140:143], v[160:163], v[96:111]
    v_mfma_f32_32x32x16_bf16 v[112:127], v[140:143], v[164:167], v[112:127]
    s_waitcnt vmcnt(20)
    s_barrier
    s_add_u32 s51, s50, 5
    s_and_b32 s51, s51, 7
    s_lshl_b32 s52, s51, 7
    s_add_u32 s52, s52, s30
    s_mul_i32 s53, s51, 73728
    s_add_u32 s53, s53, s49
    s_add_u32 s48, s29, 16384
    s_mov_b32 m0, s48
    s_add_u32 s48, s52, 0
    buffer_load_dwordx4 v10, s[8:11], s48 offen lds
    s_add_u32 s48, s29, 17408
    s_mov_b32 m0, s48
    s_add_u32 s48, s52, 8192
    buffer_load_dwordx4 v10, s[8:11], s48 offen lds
    s_add_u32 s48, s29, 18432
    s_mov_b32 m0, s48
    s_add_u32 s48, s52, 16384
    buffer_load_dwordx4 v10, s[8:11], s48 offen lds
    s_add_u32 s48, s29, 19456
    s_mov_b32 m0, s48
    s_add_u32 s48, s52, 24576
    buffer_load_dwordx4 v10, s[8:11], s48 offen lds
    s_add_u32 s48, s31, 90112
    s_mov_b32 m0, s48
    s_add_u32 s48, s53, 0
    buffer_load_dwordx4 v11, s[12:15], s48 offen lds
    s_add_u32 s48, s31, 91136
    s_mov_b32 m0, s48
    s_add_u32 s48, s53, 0
    buffer_load_dwordx4 v12, s[12:15], s48 offen lds
    s_add_u32 s48, s31, 92160
    s_mov_b32 m0, s48
    s_add_u32 s48, s53, 0
    buffer_load_dwordx4 v13, s[12:15], s48 offen lds
    s_add_u32 s48, s31, 93184
    s_mov_b32 m0, s48
    s_add_u32 s48, s53, 9216
    buffer_load_dwordx4 v11, s[12:15], s48 offen lds
    s_add_u32 s48, s31, 94208
    s_mov_b32 m0, s48
    s_add_u32 s48, s53, 9216
    buffer_load_dwordx4 v12, s[12:15], s48 offen lds
    s_add_u32 s48, s31, 95232
    s_mov_b32 m0, s48
    s_add_u32 s48, s53, 9216
    buffer_load_dwordx4 v13, s[12:15], s48 offen lds
    ds_read_b128 v[128:131], v1 offset:32768
    ds_read_b128 v[132:135], v1 offset:36864
    ds_read_b64_tr_b16 v[144:145], v14 offset:0
    ds_read_b64_tr_b16 v[146:147], v14 offset:1536
    ds_read_b64_tr_b16 v[148:149], v15 offset:0
    ds_read_b64_tr_b16 v[150:151], v15 offset:1536
    ds_read_b64_tr_b16 v[152:153], v16 offset:0
    ds_read_b64_tr_b16 v[154:155], v16 offset:1536
    ds_read_b128 v[136:139], v2 offset:32768
    ds_read_b128 v[140:143], v2 offset:36864
    ds_read_b64_tr_b16 v[156:157], v14 offset:6144
    ds_read_b64_tr_b16 v[158:159], v14 offset:7680
    ds_read_b64_tr_b16 v[160:161], v15 offset:6144
    ds_read_b64_tr_b16 v[162:163], v15 offset:7680
    ds_read_b64_tr_b16 v[164:165], v16 offset:6144
    ds_read_b64_tr_b16 v[166:167], v16 offset:7680
    s_waitcnt lgkmcnt(8)
    v_mfma_f32_32x32x16_bf16 v[32:47], v[128:131], v[144:147], v[32:47]
    v_mfma_f32_32x32x16_bf16 v[48:63], v[128:131], v[148:151], v[48:63]
    v_mfma_f32_32x32x16_bf16 v[64:79], v[128:131], v[152:155], v[64:79]
    v_mfma_f32_32x32x16_bf16 v[80:95], v[132:135], v[144:147], v[80:95]
    v_mfma_f32_32x32x16_bf16 v[96:111], v[132:135], v[148:151], v[96:111]
    v_mfma_f32_32x32x16_bf16 v[112:127], v[132:135], v[152:155], v[112:127]
    ds_read_b128 v[128:131], v3 offset:32768
    ds_read_b128 v[132:135], v3 offset:36864
    ds_read_b64_tr_b16 v[144:145], v14 offset:12288
    ds_read_b64_tr_b16 v[146:147], v14 offset:13824
    ds_read_b64_tr_b16 v[148:149], v15 offset:12288
    ds_read_b64_tr_b16 v[150:151], v15 offset:13824
    ds_read_b64_tr_b16 v[152:153], v16 offset:12288
    ds_read_b64_tr_b16 v[154:155], v16 offset:13824
    s_waitcnt lgkmcnt(8)
    v_mfma_f32_32x32x16_bf16 v[32:47], v[136:139], v[156:159], v[32:47]
    v_mfma_f32_32x32x16_bf16 v[48:63], v[136:139], v[160:163], v[48:63]
    v_mfma_f32_32x32x16_bf16 v[64:79], v[136:139], v[164:167], v[64:79]
    v_mfma_f32_32x32x16_bf16 v[80:95], v[140:143], v[156:159], v[80:95]
    v_mfma_f32_32x32x16_bf16 v[96:111], v[140:143], v[160:163], v[96:111]
    v_mfma_f32_32x32x16_bf16 v[112:127], v[140:143], v[164:167], v[112:127]
    ds_read_b128 v[136:139], v4 offset:32768
    ds_read_b128 v[140:143], v4 offset:36864
    ds_read_b64_tr_b16 v[156:157], v14 offset:18432
    ds_read_b64_tr_b16 v[158:159], v14 offset:19968
    ds_read_b64_tr_b16 v[160:161], v15 offset:18432
    ds_read_b64_tr_b16 v[162:163], v15 offset:19968
    ds_read_b64_tr_b16 v[164:165], v16 offset:18432
    ds_read_b64_tr_b16 v[166:167], v16 offset:19968
    s_waitcnt lgkmcnt(8)
    v_mfma_f32_32x32x16_bf16 v[32:47], v[128:131], v[144:147], v[32:47]
    v_mfma_f32_32x32x16_bf16 v[48:63], v[128:131], v[148:151], v[48:63]
    v_mfma_f32_32x32x16_bf16 v[64:79], v[128:131], v[152:155], v[64:79]
    v_mfma_f32_32x32x16_bf16 v[80:95], v[132:135], v[144:147], v[80:95]
    v_mfma_f32_32x32x16_bf16 v[96:111], v[132:135], v[148:151], v[96:111]
    v_mfma_f32_32x32x16_bf16 v[112:127], v[132:135], v[152:155], v[112:127]
    s_waitcnt lgkmcnt(0)
    v_mfma_f32_32x32x16_bf16 v[32:47], v[136:139], v[156:159], v[32:47]
    v_mfma_f32_32x32x16_bf16 v[48:63], v[136:139], v[160:163], v[48:63]
    v_mfma_f32_32x32x16_bf16 v[64:79], v[136:139], v[164:167], v[64:79]
    v_mfma_f32_32x32x16_bf16 v[80:95], v[140:143], v[156:159], v[80:95]
    v_mfma_f32_32x32x16_bf16 v[96:111], v[140:143], v[160:163], v[96:111]
    v_mfma_f32_32x32x16_bf16 v[112:127], v[140:143], v[164:167], v[112:127]
    s_waitcnt vmcnt(20)
    s_barrier
    s_add_u32 s51, s50, 6
    s_and_b32 s51, s51, 7
    s_lshl_b32 s52, s51, 7
    s_add_u32 s52, s52, s30
    s_mul_i32 s53, s51, 73728
    s_add_u32 s53, s53, s49
    s_add_u32 s48, s29, 32768
    s_mov_b32 m0, s48
    s_add_u32 s48, s52, 0
    buffer_load_dwordx4 v10, s[8:11], s48 offen lds
    s_add_u32 s48, s29, 33792
    s_mov_b32 m0, s48
    s_add_u32 s48, s52, 8192
    buffer_load_dwordx4 v10, s[8:11], s48 offen lds
    s_add_u32 s48, s29, 34816
    s_mov_b32 m0, s48
    s_add_u32 s48, s52, 16384
    buffer_load_dwordx4 v10, s[8:11], s48 offen lds
    s_add_u32 s48, s29, 35840
    s_mov_b32 m0, s48
    s_add_u32 s48, s52, 24576
    buffer_load_dwordx4 v10, s[8:11], s48 offen lds
    s_add_u32 s48, s31, 114688
    s_mov_b32 m0, s48
    s_add_u32 s48, s53, 0
    buffer_load_dwordx4 v11, s[12:15], s48 offen lds
    s_add_u32 s48, s31, 115712
    s_mov_b32 m0, s48
    s_add_u32 s48, s53, 0
    buffer_load_dwordx4 v12, s[12:15], s48 offen lds
    s_add_u32 s48, s31, 116736
    s_mov_b32 m0, s48
    s_add_u32 s48, s53, 0
    buffer_load_dwordx4 v13, s[12:15], s48 offen lds
    s_add_u32 s48, s31, 117760
    s_mov_b32 m0, s48
    s_add_u32 s48, s53, 9216
    buffer_load_dwordx4 v11, s[12:15], s48 offen lds
    s_add_u32 s48, s31, 118784
    s_mov_b32 m0, s48
    s_add_u32 s48, s53, 9216
    buffer_load_dwordx4 v12, s[12:15], s48 offen lds
    s_add_u32 s48, s31, 119808
    s_mov_b32 m0, s48
    s_add_u32 s48, s53, 9216
    buffer_load_dwordx4 v13, s[12:15], s48 offen lds
    ds_read_b128 v[128:131], v1 offset:49152
    ds_read_b128 v[132:135], v1 offset:53248
    ds_read_b64_tr_b16 v[144:145], v14 offset:24576
    ds_read_b64_tr_b16 v[146:147], v14 offset:26112
    ds_read_b64_tr_b16 v[148:149], v15 offset:24576
    ds_read_b64_tr_b16 v[150:151], v15 offset:26112
    ds_read_b64_tr_b16 v[152:153], v16 offset:24576
    ds_read_b64_tr_b16 v[154:155], v16 offset:26112
    ds_read_b128 v[136:139], v2 offset:49152
    ds_read_b128 v[140:143], v2 offset:53248
    ds_read_b64_tr_b16 v[156:157], v14 offset:30720
    ds_read_b64_tr_b16 v[158:159], v14 offset:32256
    ds_read_b64_tr_b16 v[160:161], v15 offset:30720
    ds_read_b64_tr_b16 v[162:163], v15 offset:32256
    ds_read_b64_tr_b16 v[164:165], v16 offset:30720
    ds_read_b64_tr_b16 v[166:167], v16 offset:32256
    s_waitcnt lgkmcnt(8)
    v_mfma_f32_32x32x16_bf16 v[32:47], v[128:131], v[144:147], v[32:47]
    v_mfma_f32_32x32x16_bf16 v[48:63], v[128:131], v[148:151], v[48:63]
    v_mfma_f32_32x32x16_bf16 v[64:79], v[128:131], v[152:155], v[64:79]
    v_mfma_f32_32x32x16_bf16 v[80:95], v[132:135], v[144:147], v[80:95]
    v_mfma_f32_32x32x16_bf16 v[96:111], v[132:135], v[148:151], v[96:111]
    v_mfma_f32_32x32x16_bf16 v[112:127], v[132:135], v[152:155], v[112:127]
    ds_read_b128 v[128:131], v3 offset:49152
    ds_read_b128 v[132:135], v3 offset:53248
    ds_read_b64_tr_b16 v[144:145], v14 offset:36864
    ds_read_b64_tr_b16 v[146:147], v14 offset:38400
    ds_read_b64_tr_b16 v[148:149], v15 offset:36864
    ds_read_b64_tr_b16 v[150:151], v15 offset:38400
    ds_read_b64_tr_b16 v[152:153], v16 offset:36864
    ds_read_b64_tr_b16 v[154:155], v16 offset:38400
    s_waitcnt lgkmcnt(8)
    v_mfma_f32_32x32x16_bf16 v[32:47], v[136:139], v[156:159], v[32:47]
    v_mfma_f32_32x32x16_bf16 v[48:63], v[136:139], v[160:163], v[48:63]
    v_mfma_f32_32x32x16_bf16 v[64:79], v[136:139], v[164:167], v[64:79]
    v_mfma_f32_32x32x16_bf16 v[80:95], v[140:143], v[156:159], v[80:95]
    v_mfma_f32_32x32x16_bf16 v[96:111], v[140:143], v[160:163], v[96:111]
    v_mfma_f32_32x32x16_bf16 v[112:127], v[140:143], v[164:167], v[112:127]
    ds_read_b128 v[136:139], v4 offset:49152
    ds_read_b128 v[140:143], v4 offset:53248
    ds_read_b64_tr_b16 v[156:157], v14 offset:43008
    ds_read_b64_tr_b16 v[158:159], v14 offset:44544
    ds_read_b64_tr_b16 v[160:161], v15 offset:43008
    ds_read_b64_tr_b16 v[162:163], v15 offset:44544
    ds_read_b64_tr_b16 v[164:165], v16 offset:43008
    ds_read_b64_tr_b16 v[166:167], v16 offset:44544
    s_waitcnt lgkmcnt(8)
    v_mfma_f32_32x32x16_bf16 v[32:47], v[128:131], v[144:147], v[32:47]
    v_mfma_f32_32x32x16_bf16 v[48:63], v[128:131], v[148:151], v[48:63]
    v_mfma_f32_32x32x16_bf16 v[64:79], v[128:131], v[152:155], v[64:79]
    v_mfma_f32_32x32x16_bf16 v[80:95], v[132:135], v[144:147], v[80:95]
    v_mfma_f32_32x32x16_bf16 v[96:111], v[132:135], v[148:151], v[96:111]
    v_mfma_f32_32x32x16_bf16 v[112:127], v[132:135], v[152:155], v[112:127]
    s_waitcnt lgkmcnt(0)
    v_mfma_f32_32x32x16_bf16 v[32:47], v[136:139], v[156:159], v[32:47]
    v_mfma_f32_32x32x16_bf16 v[48:63], v[136:139], v[160:163], v[48:63]
    v_mfma_f32_32x32x16_bf16 v[64:79], v[136:139], v[164:167], v[64:79]
    v_mfma_f32_32x32x16_bf16 v[80:95], v[140:143], v[156:159], v[80:95]
    v_mfma_f32_32x32x16_bf16 v[96:111], v[140:143], v[160:163], v[96:111]
    v_mfma_f32_32x32x16_bf16 v[112:127], v[140:143], v[164:167], v[112:127]
    s_waitcnt vmcnt(20)
    s_barrier
    s_add_u32 s51, s50, 7
    s_and_b32 s51, s51, 7
    s_lshl_b32 s52, s51, 7
    s_add_u32 s52, s52, s30
    s_mul_i32 s53, s51, 73728
    s_add_u32 s53, s53, s49
    s_add_u32 s48, s29, 49152
    s_mov_b32 m0, s48
    s_add_u32 s48, s52, 0
    buffer_load_dwordx4 v10, s[8:11], s48 offen lds
    s_add_u32 s48, s29, 50176
    s_mov_b32 m0, s48
    s_add_u32 s48, s52, 8192
    buffer_load_dwordx4 v10, s[8:11], s48 offen lds
    s_add_u32 s48, s29, 51200
    s_mov_b32 m0, s48
    s_add_u32 s48, s52, 16384
    buffer_load_dwordx4 v10, s[8:11], s48 offen lds
    s_add_u32 s48, s29, 52224
    s_mov_b32 m0, s48
    s_add_u32 s48, s52, 24576
    buffer_load_dwordx4 v10, s[8:11], s48 offen lds
    s_add_u32 s48, s31, 139264
    s_mov_b32 m0, s48
    s_add_u32 s48, s53, 0
    buffer_load_dwordx4 v11, s[12:15], s48 offen lds
    s_add_u32 s48, s31, 140288
    s_mov_b32 m0, s48
    s_add_u32 s48, s53, 0
    buffer_load_dwordx4 v12, s[12:15], s48 offen lds
    s_add_u32 s48, s31, 141312
    s_mov_b32 m0, s48
    s_add_u32 s48, s53, 0
    buffer_load_dwordx4 v13, s[12:15], s48 offen lds
    s_add_u32 s48, s31, 142336
    s_mov_b32 m0, s48
    s_add_u32 s48, s53, 9216
    buffer_load_dwordx4 v11, s[12:15], s48 offen lds
    s_add_u32 s48, s31, 143360
    s_mov_b32 m0, s48
    s_add_u32 s48, s53, 9216
    buffer_load_dwordx4 v12, s[12:15], s48 offen lds
    s_add_u32 s48, s31, 144384
    s_mov_b32 m0, s48
    s_add_u32 s48, s53, 9216
    buffer_load_dwordx4 v13, s[12:15], s48 offen lds
    ds_read_b128 v[128:131], v1 offset:0
    ds_read_b128 v[132:135], v1 offset:4096
    ds_read_b64_tr_b16 v[144:145], v5 offset:0
    ds_read_b64_tr_b16 v[146:147], v5 offset:1536
    ds_read_b64_tr_b16 v[148:149], v6 offset:0
    ds_read_b64_tr_b16 v[150:151], v6 offset:1536
    ds_read_b64_tr_b16 v[152:153], v7 offset:0
    ds_read_b64_tr_b16 v[154:155], v7 offset:1536
    ds_read_b128 v[136:139], v2 offset:0
    ds_read_b128 v[140:143], v2 offset:4096
    ds_read_b64_tr_b16 v[156:157], v5 offset:6144
    ds_read_b64_tr_b16 v[158:159], v5 offset:7680
    ds_read_b64_tr_b16 v[160:161], v6 offset:6144
    ds_read_b64_tr_b16 v[162:163], v6 offset:7680
    ds_read_b64_tr_b16 v[164:165], v7 offset:6144
    ds_read_b64_tr_b16 v[166:167], v7 offset:7680
    s_waitcnt lgkmcnt(8)
    v_mfma_f32_32x32x16_bf16 v[32:47], v[128:131], v[144:147], v[32:47]
    v_mfma_f32_32x32x16_bf16 v[48:63], v[128:131], v[148:151], v[48:63]
    v_mfma_f32_32x32x16_bf16 v[64:79], v[128:131], v[152:155], v[64:79]
    v_mfma_f32_32x32x16_bf16 v[80:95], v[132:135], v[144:147], v[80:95]
    v_mfma_f32_32x32x16_bf16 v[96:111], v[132:135], v[148:151], v[96:111]
    v_mfma_f32_32x32x16_bf16 v[112:127], v[132:135], v[152:155], v[112:127]
    ds_read_b128 v[128:131], v3 offset:0
    ds_read_b128 v[132:135], v3 offset:4096
    ds_read_b64_tr_b16 v[144:145], v5 offset:12288
    ds_read_b64_tr_b16 v[146:147], v5 offset:13824
    ds_read_b64_tr_b16 v[148:149], v6 offset:12288
    ds_read_b64_tr_b16 v[150:151], v6 offset:13824
    ds_read_b64_tr_b16 v[152:153], v7 offset:12288
    ds_read_b64_tr_b16 v[154:155], v7 offset:13824
    s_waitcnt lgkmcnt(8)
    v_mfma_f32_32x32x16_bf16 v[32:47], v[136:139], v[156:159], v[32:47]
    v_mfma_f32_32x32x16_bf16 v[48:63], v[136:139], v[160:163], v[48:63]
    v_mfma_f32_32x32x16_bf16 v[64:79], v[136:139], v[164:167], v[64:79]
    v_mfma_f32_32x32x16_bf16 v[80:95], v[140:143], v[156:159], v[80:95]
    v_mfma_f32_32x32x16_bf16 v[96:111], v[140:143], v[160:163], v[96:111]
    v_mfma_f32_32x32x16_bf16 v[112:127], v[140:143], v[164:167], v[112:127]
    ds_read_b128 v[136:139], v4 offset:0
    ds_read_b128 v[140:143], v4 offset:4096
    ds_read_b64_tr_b16 v[156:157], v5 offset:18432
    ds_read_b64_tr_b16 v[158:159], v5 offset:19968
    ds_read_b64_tr_b16 v[160:161], v6 offset:18432
    ds_read_b64_tr_b16 v[162:163], v6 offset:19968
    ds_read_b64_tr_b16 v[164:165], v7 offset:18432
    ds_read_b64_tr_b16 v[166:167], v7 offset:19968
    s_waitcnt lgkmcnt(8)
    v_mfma_f32_32x32x16_bf16 v[32:47], v[128:131], v[144:147], v[32:47]
    v_mfma_f32_32x32x16_bf16 v[48:63], v[128:131], v[148:151], v[48:63]
    v_mfma_f32_32x32x16_bf16 v[64:79], v[128:131], v[152:155], v[64:79]
    v_mfma_f32_32x32x16_bf16 v[80:95], v[132:135], v[144:147], v[80:95]
    v_mfma_f32_32x32x16_bf16 v[96:111], v[132:135], v[148:151], v[96:111]
    v_mfma_f32_32x32x16_bf16 v[112:127], v[132:135], v[152:155], v[112:127]
    s_waitcnt lgkmcnt(0)
    v_mfma_f32_32x32x16_bf16 v[32:47], v[136:139], v[156:159], v[32:47]
    v_mfma_f32_32x32x16_bf16 v[48:63], v[136:139], v[160:163], v[48:63]
    v_mfma_f32_32x32x16_bf16 v[64:79], v[136:139], v[164:167], v[64:79]
    v_mfma_f32_32x32x16_bf16 v[80:95], v[140:143], v[156:159], v[80:95]
    v_mfma_f32_32x32x16_bf16 v[96:111], v[140:143], v[160:163], v[96:111]
    v_mfma_f32_32x32x16_bf16 v[112:127], v[140:143], v[164:167], v[112:127]
    s_waitcnt vmcnt(20)
    s_barrier
    ds_read_b128 v[128:131], v1 offset:16384
    ds_read_b128 v[132:135], v1 offset:20480
    ds_read_b64_tr_b16 v[144:145], v5 offset:24576
    ds_read_b64_tr_b16 v[146:147], v5 offset:26112
    ds_read_b64_tr_b16 v[148:149], v6 offset:24576
    ds_read_b64_tr_b16 v[150:151], v6 offset:26112
    ds_read_b64_tr_b16 v[152:153], v7 offset:24576
    ds_read_b64_tr_b16 v[154:155], v7 offset:26112
    ds_read_b128 v[136:139], v2 offset:16384
    ds_read_b128 v[140:143], v2 offset:20480
    ds_read_b64_tr_b16 v[156:157], v5 offset:30720
    ds_read_b64_tr_b16 v[158:159], v5 offset:32256
    ds_read_b64_tr_b16 v[160:161], v6 offset:30720
    ds_read_b64_tr_b16 v[162:163], v6 offset:32256
    ds_read_b64_tr_b16 v[164:165], v7 offset:30720
    ds_read_b64_tr_b16 v[166:167], v7 offset:32256
    s_waitcnt lgkmcnt(8)
    v_mfma_f32_32x32x16_bf16 v[32:47], v[128:131], v[144:147], v[32:47]
    v_mfma_f32_32x32x16_bf16 v[48:63], v[128:131], v[148:151], v[48:63]
    v_mfma_f32_32x32x16_bf16 v[64:79], v[128:131], v[152:155], v[64:79]
    v_mfma_f32_32x32x16_bf16 v[80:95], v[132:135], v[144:147], v[80:95]
    v_mfma_f32_32x32x16_bf16 v[96:111], v[132:135], v[148:151], v[96:111]
    v_mfma_f32_32x32x16_bf16 v[112:127], v[132:135], v[152:155], v[112:127]
    ds_read_b128 v[128:131], v3 offset:16384
    ds_read_b128 v[132:135], v3 offset:20480
    ds_read_b64_tr_b16 v[144:145], v5 offset:36864
    ds_read_b64_tr_b16 v[146:147], v5 offset:38400
    ds_read_b64_tr_b16 v[148:149], v6 offset:36864
    ds_read_b64_tr_b16 v[150:151], v6 offset:38400
    ds_read_b64_tr_b16 v[152:153], v7 offset:36864
    ds_read_b64_tr_b16 v[154:155], v7 offset:38400
    s_waitcnt lgkmcnt(8)
    v_mfma_f32_32x32x16_bf16 v[32:47], v[136:139], v[156:159], v[32:47]
    v_mfma_f32_32x32x16_bf16 v[48:63], v[136:139], v[160:163], v[48:63]
    v_mfma_f32_32x32x16_bf16 v[64:79], v[136:139], v[164:167], v[64:79]
    v_mfma_f32_32x32x16_bf16 v[80:95], v[140:143], v[156:159], v[80:95]
    v_mfma_f32_32x32x16_bf16 v[96:111], v[140:143], v[160:163], v[96:111]
    v_mfma_f32_32x32x16_bf16 v[112:127], v[140:143], v[164:167], v[112:127]
    ds_read_b128 v[136:139], v4 offset:16384
    ds_read_b128 v[140:143], v4 offset:20480
    ds_read_b64_tr_b16 v[156:157], v5 offset:43008
    ds_read_b64_tr_b16 v[158:159], v5 offset:44544
    ds_read_b64_tr_b16 v[160:161], v6 offset:43008
    ds_read_b64_tr_b16 v[162:163], v6 offset:44544
    ds_read_b64_tr_b16 v[164:165], v7 offset:43008
    ds_read_b64_tr_b16 v[166:167], v7 offset:44544
    s_waitcnt lgkmcnt(8)
    v_mfma_f32_32x32x16_bf16 v[32:47], v[128:131], v[144:147], v[32:47]
    v_mfma_f32_32x32x16_bf16 v[48:63], v[128:131], v[148:151], v[48:63]
    v_mfma_f32_32x32x16_bf16 v[64:79], v[128:131], v[152:155], v[64:79]
    v_mfma_f32_32x32x16_bf16 v[80:95], v[132:135], v[144:147], v[80:95]
    v_mfma_f32_32x32x16_bf16 v[96:111], v[132:135], v[148:151], v[96:111]
    v_mfma_f32_32x32x16_bf16 v[112:127], v[132:135], v[152:155], v[112:127]
    s_waitcnt lgkmcnt(0)
    v_mfma_f32_32x32x16_bf16 v[32:47], v[136:139], v[156:159], v[32:47]
    v_mfma_f32_32x32x16_bf16 v[48:63], v[136:139], v[160:163], v[48:63]
    v_mfma_f32_32x32x16_bf16 v[64:79], v[136:139], v[164:167], v[64:79]
    v_mfma_f32_32x32x16_bf16 v[80:95], v[140:143], v[156:159], v[80:95]
    v_mfma_f32_32x32x16_bf16 v[96:111], v[140:143], v[160:163], v[96:111]
    v_mfma_f32_32x32x16_bf16 v[112:127], v[140:143], v[164:167], v[112:127]
    s_waitcnt vmcnt(10)
    s_barrier
    ds_read_b128 v[128:131], v1 offset:32768
    ds_read_b128 v[132:135], v1 offset:36864
    ds_read_b64_tr_b16 v[144:145], v14 offset:0
    ds_read_b64_tr_b16 v[146:147], v14 offset:1536
    ds_read_b64_tr_b16 v[148:149], v15 offset:0
    ds_read_b64_tr_b16 v[150:151], v15 offset:1536
    ds_read_b64_tr_b16 v[152:153], v16 offset:0
    ds_read_b64_tr_b16 v[154:155], v16 offset:1536
    ds_read_b128 v[136:139], v2 offset:32768
    ds_read_b128 v[140:143], v2 offset:36864
    ds_read_b64_tr_b16 v[156:157], v14 offset:6144
    ds_read_b64_tr_b16 v[158:159], v14 offset:7680
    ds_read_b64_tr_b16 v[160:161], v15 offset:6144
    ds_read_b64_tr_b16 v[162:163], v15 offset:7680
    ds_read_b64_tr_b16 v[164:165], v16 offset:6144
    ds_read_b64_tr_b16 v[166:167], v16 offset:7680
    s_waitcnt lgkmcnt(8)
    v_mfma_f32_32x32x16_bf16 v[32:47], v[128:131], v[144:147], v[32:47]
    v_mfma_f32_32x32x16_bf16 v[48:63], v[128:131], v[148:151], v[48:63]
    v_mfma_f32_32x32x16_bf16 v[64:79], v[128:131], v[152:155], v[64:79]
    v_mfma_f32_32x32x16_bf16 v[80:95], v[132:135], v[144:147], v[80:95]
    v_mfma_f32_32x32x16_bf16 v[96:111], v[132:135], v[148:151], v[96:111]
    v_mfma_f32_32x32x16_bf16 v[112:127], v[132:135], v[152:155], v[112:127]
    ds_read_b128 v[128:131], v3 offset:32768
    ds_read_b128 v[132:135], v3 offset:36864
    ds_read_b64_tr_b16 v[144:145], v14 offset:12288
    ds_read_b64_tr_b16 v[146:147], v14 offset:13824
    ds_read_b64_tr_b16 v[148:149], v15 offset:12288
    ds_read_b64_tr_b16 v[150:151], v15 offset:13824
    ds_read_b64_tr_b16 v[152:153], v16 offset:12288
    ds_read_b64_tr_b16 v[154:155], v16 offset:13824
    s_waitcnt lgkmcnt(8)
    v_mfma_f32_32x32x16_bf16 v[32:47], v[136:139], v[156:159], v[32:47]
    v_mfma_f32_32x32x16_bf16 v[48:63], v[136:139], v[160:163], v[48:63]
    v_mfma_f32_32x32x16_bf16 v[64:79], v[136:139], v[164:167], v[64:79]
    v_mfma_f32_32x32x16_bf16 v[80:95], v[140:143], v[156:159], v[80:95]
    v_mfma_f32_32x32x16_bf16 v[96:111], v[140:143], v[160:163], v[96:111]
    v_mfma_f32_32x32x16_bf16 v[112:127], v[140:143], v[164:167], v[112:127]
    ds_read_b128 v[136:139], v4 offset:32768
    ds_read_b128 v[140:143], v4 offset:36864
    ds_read_b64_tr_b16 v[156:157], v14 offset:18432
    ds_read_b64_tr_b16 v[158:159], v14 offset:19968
    ds_read_b64_tr_b16 v[160:161], v15 offset:18432
    ds_read_b64_tr_b16 v[162:163], v15 offset:19968
    ds_read_b64_tr_b16 v[164:165], v16 offset:18432
    ds_read_b64_tr_b16 v[166:167], v16 offset:19968
    s_waitcnt lgkmcnt(8)
    v_mfma_f32_32x32x16_bf16 v[32:47], v[128:131], v[144:147], v[32:47]
    v_mfma_f32_32x32x16_bf16 v[48:63], v[128:131], v[148:151], v[48:63]
    v_mfma_f32_32x32x16_bf16 v[64:79], v[128:131], v[152:155], v[64:79]
    v_mfma_f32_32x32x16_bf16 v[80:95], v[132:135], v[144:147], v[80:95]
    v_mfma_f32_32x32x16_bf16 v[96:111], v[132:135], v[148:151], v[96:111]
    v_mfma_f32_32x32x16_bf16 v[112:127], v[132:135], v[152:155], v[112:127]
    s_waitcnt lgkmcnt(0)
    v_mfma_f32_32x32x16_bf16 v[32:47], v[136:139], v[156:159], v[32:47]
    v_mfma_f32_32x32x16_bf16 v[48:63], v[136:139], v[160:163], v[48:63]
    v_mfma_f32_32x32x16_bf16 v[64:79], v[136:139], v[164:167], v[64:79]
    v_mfma_f32_32x32x16_bf16 v[80:95], v[140:143], v[156:159], v[80:95]
    v_mfma_f32_32x32x16_bf16 v[96:111], v[140:143], v[160:163], v[96:111]
    v_mfma_f32_32x32x16_bf16 v[112:127], v[140:143], v[164:167], v[112:127]
    s_waitcnt vmcnt(0)
    s_barrier
    ds_read_b128 v[128:131], v1 offset:49152
    ds_read_b128 v[132:135], v1 offset:53248
    ds_read_b64_tr_b16 v[144:145], v14 offset:24576
    ds_read_b64_tr_b16 v[146:147], v14 offset:26112
    ds_read_b64_tr_b16 v[148:149], v15 offset:24576
    ds_read_b64_tr_b16 v[150:151], v15 offset:26112
    ds_read_b64_tr_b16 v[152:153], v16 offset:24576
    ds_read_b64_tr_b16 v[154:155], v16 offset:26112
    ds_read_b128 v[136:139], v2 offset:49152
    ds_read_b128 v[140:143], v2 offset:53248
    ds_read_b64_tr_b16 v[156:157], v14 offset:30720
    ds_read_b64_tr_b16 v[158:159], v14 offset:32256
    ds_read_b64_tr_b16 v[160:161], v15 offset:30720
    ds_read_b64_tr_b16 v[162:163], v15 offset:32256
    ds_read_b64_tr_b16 v[164:165], v16 offset:30720
    ds_read_b64_tr_b16 v[166:167], v16 offset:32256
    s_waitcnt lgkmcnt(8)
    v_mfma_f32_32x32x16_bf16 v[32:47], v[128:131], v[144:147], v[32:47]
    v_mfma_f32_32x32x16_bf16 v[48:63], v[128:131], v[148:151], v[48:63]
    v_mfma_f32_32x32x16_bf16 v[64:79], v[128:131], v[152:155], v[64:79]
    v_mfma_f32_32x32x16_bf16 v[80:95], v[132:135], v[144:147], v[80:95]
    v_mfma_f32_32x32x16_bf16 v[96:111], v[132:135], v[148:151], v[96:111]
    v_mfma_f32_32x32x16_bf16 v[112:127], v[132:135], v[152:155], v[112:127]
    ds_read_b128 v[128:131], v3 offset:49152
    ds_read_b128 v[132:135], v3 offset:53248
    ds_read_b64_tr_b16 v[144:145], v14 offset:36864
    ds_read_b64_tr_b16 v[146:147], v14 offset:38400
    ds_read_b64_tr_b16 v[148:149], v15 offset:36864
    ds_read_b64_tr_b16 v[150:151], v15 offset:38400
    ds_read_b64_tr_b16 v[152:153], v16 offset:36864
    ds_read_b64_tr_b16 v[154:155], v16 offset:38400
    s_waitcnt lgkmcnt(8)
    v_mfma_f32_32x32x16_bf16 v[32:47], v[136:139], v[156:159], v[32:47]
    v_mfma_f32_32x32x16_bf16 v[48:63], v[136:139], v[160:163], v[48:63]
    v_mfma_f32_32x32x16_bf16 v[64:79], v[136:139], v[164:167], v[64:79]
    v_mfma_f32_32x32x16_bf16 v[80:95], v[140:143], v[156:159], v[80:95]
    v_mfma_f32_32x32x16_bf16 v[96:111], v[140:143], v[160:163], v[96:111]
    v_mfma_f32_32x32x16_bf16 v[112:127], v[140:143], v[164:167], v[112:127]
    ds_read_b128 v[136:139], v4 offset:49152
    ds_read_b128 v[140:143], v4 offset:53248
    ds_read_b64_tr_b16 v[156:157], v14 offset:43008
    ds_read_b64_tr_b16 v[158:159], v14 offset:44544
    ds_read_b64_tr_b16 v[160:161], v15 offset:43008
    ds_read_b64_tr_b16 v[162:163], v15 offset:44544
    ds_read_b64_tr_b16 v[164:165], v16 offset:43008
    ds_read_b64_tr_b16 v[166:167], v16 offset:44544
    s_waitcnt lgkmcnt(8)
    v_mfma_f32_32x32x16_bf16 v[32:47], v[128:131], v[144:147], v[32:47]
    v_mfma_f32_32x32x16_bf16 v[48:63], v[128:131], v[148:151], v[48:63]
    v_mfma_f32_32x32x16_bf16 v[64:79], v[128:131], v[152:155], v[64:79]
    v_mfma_f32_32x32x16_bf16 v[80:95], v[132:135], v[144:147], v[80:95]
    v_mfma_f32_32x32x16_bf16 v[96:111], v[132:135], v[148:151], v[96:111]
    v_mfma_f32_32x32x16_bf16 v[112:127], v[132:135], v[152:155], v[112:127]
    s_waitcnt lgkmcnt(0)
    v_mfma_f32_32x32x16_bf16 v[32:47], v[136:139], v[156:159], v[32:47]
    v_mfma_f32_32x32x16_bf16 v[48:63], v[136:139], v[160:163], v[48:63]
    v_mfma_f32_32x32x16_bf16 v[64:79], v[136:139], v[164:167], v[64:79]
    v_mfma_f32_32x32x16_bf16 v[80:95], v[140:143], v[156:159], v[80:95]
    v_mfma_f32_32x32x16_bf16 v[96:111], v[140:143], v[160:163], v[96:111]
    v_mfma_f32_32x32x16_bf16 v[112:127], v[140:143], v[164:167], v[112:127]
    s_nop 15
    v_mul_u32_u24 v29, 9216, v30
    v_lshl_add_u32 v29, v31, 2, v29
    s_mul_i32 s28, s7, 384
    s_mul_i32 s48, s6, 147456
    s_add_u32 s28, s28, s48
    s_add_u32 s48, s28, 0
    buffer_store_dword v32, v29, s[16:19], s48 offen offset:0
    buffer_store_dword v48, v29, s[16:19], s48 offen offset:128
    buffer_store_dword v64, v29, s[16:19], s48 offen offset:256
    s_add_u32 s48, s28, 2304
    buffer_store_dword v33, v29, s[16:19], s48 offen offset:0
    buffer_store_dword v49, v29, s[16:19], s48 offen offset:128
    buffer_store_dword v65, v29, s[16:19], s48 offen offset:256
    s_add_u32 s48, s28, 4608
    buffer_store_dword v34, v29, s[16:19], s48 offen offset:0
    buffer_store_dword v50, v29, s[16:19], s48 offen offset:128
    buffer_store_dword v66, v29, s[16:19], s48 offen offset:256
    s_add_u32 s48, s28, 6912
    buffer_store_dword v35, v29, s[16:19], s48 offen offset:0
    buffer_store_dword v51, v29, s[16:19], s48 offen offset:128
    buffer_store_dword v67, v29, s[16:19], s48 offen offset:256
    s_add_u32 s48, s28, 18432
    buffer_store_dword v36, v29, s[16:19], s48 offen offset:0
    buffer_store_dword v52, v29, s[16:19], s48 offen offset:128
    buffer_store_dword v68, v29, s[16:19], s48 offen offset:256
    s_add_u32 s48, s28, 20736
    buffer_store_dword v37, v29, s[16:19], s48 offen offset:0
    buffer_store_dword v53, v29, s[16:19], s48 offen offset:128
    buffer_store_dword v69, v29, s[16:19], s48 offen offset:256
    s_add_u32 s48, s28, 23040
    buffer_store_dword v38, v29, s[16:19], s48 offen offset:0
    buffer_store_dword v54, v29, s[16:19], s48 offen offset:128
    buffer_store_dword v70, v29, s[16:19], s48 offen offset:256
    s_add_u32 s48, s28, 25344
    buffer_store_dword v39, v29, s[16:19], s48 offen offset:0
    buffer_store_dword v55, v29, s[16:19], s48 offen offset:128
    buffer_store_dword v71, v29, s[16:19], s48 offen offset:256
    s_add_u32 s48, s28, 36864
    buffer_store_dword v40, v29, s[16:19], s48 offen offset:0
    buffer_store_dword v56, v29, s[16:19], s48 offen offset:128
    buffer_store_dword v72, v29, s[16:19], s48 offen offset:256
    s_add_u32 s48, s28, 39168
    buffer_store_dword v41, v29, s[16:19], s48 offen offset:0
    buffer_store_dword v57, v29, s[16:19], s48 offen offset:128
    buffer_store_dword v73, v29, s[16:19], s48 offen offset:256
    s_add_u32 s48, s28, 41472
    buffer_store_dword v42, v29, s[16:19], s48 offen offset:0
    buffer_store_dword v58, v29, s[16:19], s48 offen offset:128
    buffer_store_dword v74, v29, s[16:19], s48 offen offset:256
    s_add_u32 s48, s28, 43776
    buffer_store_dword v43, v29, s[16:19], s48 offen offset:0
    buffer_store_dword v59, v29, s[16:19], s48 offen offset:128
    buffer_store_dword v75, v29, s[16:19], s48 offen offset:256
    s_add_u32 s48, s28, 55296
    buffer_store_dword v44, v29, s[16:19], s48 offen offset:0
    buffer_store_dword v60, v29, s[16:19], s48 offen offset:128
    buffer_store_dword v76, v29, s[16:19], s48 offen offset:256
    s_add_u32 s48, s28, 57600
    buffer_store_dword v45, v29, s[16:19], s48 offen offset:0
    buffer_store_dword v61, v29, s[16:19], s48 offen offset:128
    buffer_store_dword v77, v29, s[16:19], s48 offen offset:256
    s_add_u32 s48, s28, 59904
    buffer_store_dword v46, v29, s[16:19], s48 offen offset:0
    buffer_store_dword v62, v29, s[16:19], s48 offen offset:128
    buffer_store_dword v78, v29, s[16:19], s48 offen offset:256
    s_add_u32 s48, s28, 62208
    buffer_store_dword v47, v29, s[16:19], s48 offen offset:0
    buffer_store_dword v63, v29, s[16:19], s48 offen offset:128
    buffer_store_dword v79, v29, s[16:19], s48 offen offset:256
    s_add_u32 s48, s28, 73728
    buffer_store_dword v80, v29, s[16:19], s48 offen offset:0
    buffer_store_dword v96, v29, s[16:19], s48 offen offset:128
    buffer_store_dword v112, v29, s[16:19], s48 offen offset:256
    s_add_u32 s48, s28, 76032
    buffer_store_dword v81, v29, s[16:19], s48 offen offset:0
    buffer_store_dword v97, v29, s[16:19], s48 offen offset:128
    buffer_store_dword v113, v29, s[16:19], s48 offen offset:256
    s_add_u32 s48, s28, 78336
    buffer_store_dword v82, v29, s[16:19], s48 offen offset:0
    buffer_store_dword v98, v29, s[16:19], s48 offen offset:128
    buffer_store_dword v114, v29, s[16:19], s48 offen offset:256
    s_add_u32 s48, s28, 80640
    buffer_store_dword v83, v29, s[16:19], s48 offen offset:0
    buffer_store_dword v99, v29, s[16:19], s48 offen offset:128
    buffer_store_dword v115, v29, s[16:19], s48 offen offset:256
    s_add_u32 s48, s28, 92160
    buffer_store_dword v84, v29, s[16:19], s48 offen offset:0
    buffer_store_dword v100, v29, s[16:19], s48 offen offset:128
    buffer_store_dword v116, v29, s[16:19], s48 offen offset:256
    s_add_u32 s48, s28, 94464
    buffer_store_dword v85, v29, s[16:19], s48 offen offset:0
    buffer_store_dword v101, v29, s[16:19], s48 offen offset:128
    buffer_store_dword v117, v29, s[16:19], s48 offen offset:256
    s_add_u32 s48, s28, 96768
    buffer_store_dword v86, v29, s[16:19], s48 offen offset:0
    buffer_store_dword v102, v29, s[16:19], s48 offen offset:128
    buffer_store_dword v118, v29, s[16:19], s48 offen offset:256
    s_add_u32 s48, s28, 99072
    buffer_store_dword v87, v29, s[16:19], s48 offen offset:0
    buffer_store_dword v103, v29, s[16:19], s48 offen offset:128
    buffer_store_dword v119, v29, s[16:19], s48 offen offset:256
    s_add_u32 s48, s28, 110592
    buffer_store_dword v88, v29, s[16:19], s48 offen offset:0
    buffer_store_dword v104, v29, s[16:19], s48 offen offset:128
    buffer_store_dword v120, v29, s[16:19], s48 offen offset:256
    s_add_u32 s48, s28, 112896
    buffer_store_dword v89, v29, s[16:19], s48 offen offset:0
    buffer_store_dword v105, v29, s[16:19], s48 offen offset:128
    buffer_store_dword v121, v29, s[16:19], s48 offen offset:256
    s_add_u32 s48, s28, 115200
    buffer_store_dword v90, v29, s[16:19], s48 offen offset:0
    buffer_store_dword v106, v29, s[16:19], s48 offen offset:128
    buffer_store_dword v122, v29, s[16:19], s48 offen offset:256
    s_add_u32 s48, s28, 117504
    buffer_store_dword v91, v29, s[16:19], s48 offen offset:0
    buffer_store_dword v107, v29, s[16:19], s48 offen offset:128
    buffer_store_dword v123, v29, s[16:19], s48 offen offset:256
    s_add_u32 s48, s28, 129024
    buffer_store_dword v92, v29, s[16:19], s48 offen offset:0
    buffer_store_dword v108, v29, s[16:19], s48 offen offset:128
    buffer_store_dword v124, v29, s[16:19], s48 offen offset:256
    s_add_u32 s48, s28, 131328
    buffer_store_dword v93, v29, s[16:19], s48 offen offset:0
    buffer_store_dword v109, v29, s[16:19], s48 offen offset:128
    buffer_store_dword v125, v29, s[16:19], s48 offen offset:256
    s_add_u32 s48, s28, 133632
    buffer_store_dword v94, v29, s[16:19], s48 offen offset:0
    buffer_store_dword v110, v29, s[16:19], s48 offen offset:128
    buffer_store_dword v126, v29, s[16:19], s48 offen offset:256
    s_add_u32 s48, s28, 135936
    buffer_store_dword v95, v29, s[16:19], s48 offen offset:0
    buffer_store_dword v111, v29, s[16:19], s48 offen offset:128
    buffer_store_dword v127, v29, s[16:19], s48 offen offset:256
L_oproj_done:
    s_endpgm
.globl reduce_kernel
.p2align 8
.type reduce_kernel,@function
reduce_kernel:
    s_cmp_ge_u32 s2, 576
    s_cbranch_scc1 L_red_done
    s_load_dwordx4 s[32:35], s[0:1], 40
    s_load_dwordx2 s[36:37], s[0:1], 56
    s_lshl_b32 s4, s2, 12
    v_lshl_add_u32 v1, v0, 4, s4
    s_waitcnt lgkmcnt(0)
    s_add_u32 s8, s36, 0x1000000
    s_addc_u32 s9, s37, 0
    s_mov_b32 s10, 18874368
    s_mov_b32 s11, 0x00020000
    s_mov_b32 s12, s32
    s_mov_b32 s13, s33
    s_mov_b32 s14, 1179648
    s_mov_b32 s15, 0x00020000
    s_mov_b32 s16, 0
    buffer_load_dwordx4 v[4:7], v1, s[8:11], s16 offen
    s_mov_b32 s16, 2359296
    buffer_load_dwordx4 v[8:11], v1, s[8:11], s16 offen
    s_mov_b32 s16, 4718592
    buffer_load_dwordx4 v[12:15], v1, s[8:11], s16 offen
    s_mov_b32 s16, 7077888
    buffer_load_dwordx4 v[16:19], v1, s[8:11], s16 offen
    s_mov_b32 s16, 9437184
    buffer_load_dwordx4 v[20:23], v1, s[8:11], s16 offen
    s_mov_b32 s16, 11796480
    buffer_load_dwordx4 v[24:27], v1, s[8:11], s16 offen
    s_mov_b32 s16, 14155776
    buffer_load_dwordx4 v[28:31], v1, s[8:11], s16 offen
    s_mov_b32 s16, 16515072
    buffer_load_dwordx4 v[32:35], v1, s[8:11], s16 offen
    s_waitcnt vmcnt(6)
    v_add_f32 v4, v4, v8
    v_add_f32 v5, v5, v9
    v_add_f32 v6, v6, v10
    v_add_f32 v7, v7, v11
    s_waitcnt vmcnt(5)
    v_add_f32 v4, v4, v12
    v_add_f32 v5, v5, v13
    v_add_f32 v6, v6, v14
    v_add_f32 v7, v7, v15
    s_waitcnt vmcnt(4)
    v_add_f32 v4, v4, v16
    v_add_f32 v5, v5, v17
    v_add_f32 v6, v6, v18
    v_add_f32 v7, v7, v19
    s_waitcnt vmcnt(3)
    v_add_f32 v4, v4, v20
    v_add_f32 v5, v5, v21
    v_add_f32 v6, v6, v22
    v_add_f32 v7, v7, v23
    s_waitcnt vmcnt(2)
    v_add_f32 v4, v4, v24
    v_add_f32 v5, v5, v25
    v_add_f32 v6, v6, v26
    v_add_f32 v7, v7, v27
    s_waitcnt vmcnt(1)
    v_add_f32 v4, v4, v28
    v_add_f32 v5, v5, v29
    v_add_f32 v6, v6, v30
    v_add_f32 v7, v7, v31
    s_waitcnt vmcnt(0)
    v_add_f32 v4, v4, v32
    v_add_f32 v5, v5, v33
    v_add_f32 v6, v6, v34
    v_add_f32 v7, v7, v35
    v_cvt_pk_bf16_f32 v2, v4, v5
    v_cvt_pk_bf16_f32 v3, v6, v7
    v_lshrrev_b32 v1, 1, v1
    buffer_store_dwordx2 v[2:3], v1, s[12:15], 0 offen
L_red_done:
    s_endpgm
.section .rodata,"a"
.p2align 6
.amdhsa_kernel attn_kernel
  .amdhsa_next_free_vgpr 336
  .amdhsa_next_free_sgpr 100
  .amdhsa_accum_offset 176
  .amdhsa_group_segment_fixed_size 0
  .amdhsa_kernarg_size 64
  .amdhsa_user_sgpr_count 2
  .amdhsa_user_sgpr_kernarg_segment_ptr 1
  .amdhsa_system_sgpr_workgroup_id_x 1
.end_amdhsa_kernel
.p2align 6
.amdhsa_kernel oproj_kernel
  .amdhsa_next_free_vgpr 168
  .amdhsa_next_free_sgpr 100
  .amdhsa_accum_offset 168
  .amdhsa_group_segment_fixed_size 0
  .amdhsa_kernarg_size 64
  .amdhsa_user_sgpr_count 2
  .amdhsa_user_sgpr_kernarg_segment_ptr 1
  .amdhsa_system_sgpr_workgroup_id_x 1
.end_amdhsa_kernel
.p2align 6
.amdhsa_kernel reduce_kernel
  .amdhsa_next_free_vgpr 40
  .amdhsa_next_free_sgpr 64
  .amdhsa_accum_offset 40
  .amdhsa_group_segment_fixed_size 0
  .amdhsa_kernarg_size 64
  .amdhsa_user_sgpr_count 2
  .amdhsa_user_sgpr_kernarg_segment_ptr 1
  .amdhsa_system_sgpr_workgroup_id_x 1
.end_amdhsa_kernel
```
